```python
import torch

def _softmax(x, axis=-1):
    return torch.softmax(x, dim=axis)

def _gelu(x):
    return torch.nn.functional.gelu(x, approximate='tanh')

def _silu(x):
    return torch.nn.functional.silu(x)

def _sigmoid(x):
    return torch.sigmoid(x)

def _layernorm(x, axis=-1, eps=1e-05):
    m = x.mean(dim=axis, keepdim=True)
    v = x.var(dim=axis, keepdim=True, unbiased=False)
    return (x - m) / torch.sqrt(v + eps)

def _scatter_add(tgt, idx, src, axis=0):
    return tgt.clone().index_add_(axis, idx, src)

def _segment_sum(src, seg, n):
    out = torch.zeros((n,) + src.shape[1:], dtype=src.dtype)
    return out.index_add_(0, seg, src)

def _pad(x, pw):
    flat = tuple((v for pair in reversed(pw) for v in pair))
    return torch.nn.functional.pad(x, flat)
kernel_name = 'parallel_sum__memory_aug_recurrent_mem_tr__glu_gated_geglu__prompt'

def setup_inputs():

    _w = lambda a: (lambda t: t.to(torch.bfloat16) if t.is_floating_point() else t)(torch.as_tensor(a))

    def _A_setup():
        B, S, Dm = (1, 2048, 512)
        H, Dh = (32, 128)
        M, seg = (8, 32)
        seg = min(seg, S)
        S = S // seg * seg
        return {'x': _w((lambda *s: torch.randn(*s, dtype=torch.bfloat16) * 0.05)(B, S, Dm)), 'mem0': _w((lambda *s: torch.randn(*s, dtype=torch.bfloat16) * 0.2)(B, M, Dm)), 'Wq': _w((lambda *s: torch.randn(*s, dtype=torch.bfloat16) * 1.6)(Dm, H, Dh) * Dm ** (-0.5)), 'Wk': _w((lambda *s: torch.randn(*s, dtype=torch.bfloat16) * 1.6)(Dm, H, Dh) * Dm ** (-0.5)), 'Wv': _w((lambda *s: torch.randn(*s, dtype=torch.bfloat16) * 0.2)(Dm, H, Dh) * Dm ** (-0.5)), 'Wo': _w((lambda *s: torch.randn(*s, dtype=torch.bfloat16) * 0.2)(H, Dh, Dm) * (H * Dh) ** (-0.5)), 'seg_len': seg}
    _A_in = _A_setup()

    def _B_setup():
        B, S, Dm, Df = (1, 2048, 512, 1792)
        return {'x': _w((lambda *s: torch.randn(*s, dtype=torch.bfloat16) * 0.05)(B, S, Dm)), 'w_gate': _w((lambda *s: torch.randn(*s, dtype=torch.bfloat16) * 0.4)(Dm, Df) * Dm ** (-0.5)), 'w_up': _w((lambda *s: torch.randn(*s, dtype=torch.bfloat16) * 0.4)(Dm, Df) * Dm ** (-0.5)), 'w_down': _w((lambda *s: torch.randn(*s, dtype=torch.bfloat16) * 0.4)(Df, Dm) * Df ** (-0.5))}
    _B_in = _B_setup()
    return {'A_x': _A_in['x'], 'A_mem0': _A_in['mem0'], 'A_Wq': _A_in['Wq'], 'A_Wk': _A_in['Wk'], 'A_Wv': _A_in['Wv'], 'A_Wo': _A_in['Wo'], 'A_seg_len': _A_in['seg_len'], 'B_x': _B_in['x'], 'B_w_gate': _B_in['w_gate'], 'B_w_up': _B_in['w_up'], 'B_w_down': _B_in['w_down']}

def reference(A_x, A_mem0, A_Wq, A_Wk, A_Wv, A_Wo, A_seg_len, B_x, B_w_gate, B_w_up, B_w_down):

    def _A_ref(x, mem0, Wq, Wk, Wv, Wo, seg_len):
        B, S, Dm = x.shape
        H, Dh = (Wq.shape[1], Wq.shape[2])
        M = mem0.shape[1]
        scale = Dh ** (-0.5)
        n_seg = S // seg_len
        L = M + seg_len
        idx = torch.arange(L)
        mask = (idx[:, None] < M) | (idx[:, None] >= idx[None, :])
        mem = mem0
        outs = []
        for s in range(n_seg):
            xs = x[:, s * seg_len:(s + 1) * seg_len, :].clone()
            h = torch.concatenate([mem, xs], axis=1)
            q = torch.einsum('btd,dhe->bhte', h, Wq)
            k = torch.einsum('btd,dhe->bhte', h, Wk)
            v = torch.einsum('btd,dhe->bhte', h, Wv)
            scores = torch.einsum('bhqe,bhke->bhqk', q, k) * scale
            scores = torch.where(mask[None, None], scores, -1000000000.0)
            p = _softmax(scores, axis=-1)
            o = torch.einsum('bhqk,bhke->bhqe', p, v)
            o = torch.einsum('bhte,hed->btd', o, Wo)
            mem = o[:, :M, :].clone()
            outs.append(o[:, M:, :])
        return torch.concatenate(outs, axis=1)

    def _B_ref(x, w_gate, w_up, w_down):
        g = torch.einsum('bsd,df->bsf', x, w_gate)
        u = torch.einsum('bsd,df->bsf', x, w_up)
        h = _gelu(g) * u
        return torch.einsum('bsf,fd->bsd', h, w_down)
    x = A_x
    xn = _layernorm(x, axis=-1)
    return x + _A_ref(xn, A_mem0, A_Wq, A_Wk, A_Wv, A_Wo, A_seg_len) + _B_ref(xn, B_w_gate, B_w_up, B_w_down)
```

```asm
; @launch grid=(256,1,1) block=(256,1,1) lds=163840
.amdgcn_target "amdgcn-amd-amdhsa--gfx950"
.text
.globl parallel_sum__memory_aug_recurrent_mem_tr__glu_gated_geglu__prompt_kernel
.p2align 8
.type parallel_sum__memory_aug_recurrent_mem_tr__glu_gated_geglu__prompt_kernel,@function
parallel_sum__memory_aug_recurrent_mem_tr__glu_gated_geglu__prompt_kernel:
  s_cmp_ge_u32 s2, 256
  s_cbranch_scc1 EXIT
  s_load_dwordx16 s[4:19], s[0:1], 0
  s_load_dwordx8 s[20:27], s[0:1], 64
  s_load_dwordx4 s[28:31], s[0:1], 96
  v_lshrrev_b32 v3, 6, v0
  v_and_b32 v1, 63, v0
  v_lshlrev_b32 v2, 4, v1
  v_readfirstlane_b32 s48, v3
  s_mov_b32 s64, 0x05040100
  s_mov_b32 s65, 0x07060302
  s_waitcnt lgkmcnt(0)
  s_mov_b32 s32, s30
  s_mov_b32 s33, s31
  s_mov_b32 s34, 268435456
  s_mov_b32 s35, 0x00020000
  s_mov_b32 s44, s28
  s_mov_b32 s45, s29
  s_mov_b32 s46, 256
  s_mov_b32 s47, 0x00020000
  s_mov_b32 s50, 1
  s_getreg_b32 s60, hwreg(HW_REG_XCC_ID)
  s_and_b32 s60, s60, 7
  s_xor_b32 s60, s60, 0
  s_max_u32 s60, s60, 0
  s_cmp_lg_u32 s48, 0
  s_cbranch_scc1 Lts_1
  s_cmp_eq_u32 s60, 0
  s_cselect_b32 s52, 160, 0
  v_mov_b32 v48, 1
  v_mov_b32 v50, s52
  s_mov_b64 exec, 1
  buffer_atomic_add v48, v50, s[44:47], 0 offen sc0
  s_mov_b64 exec, -1
Lts_1:
  s_cmp_lg_u32 s48, 2
  s_cbranch_scc1 Ltc_2
  s_getpc_b64 s[54:55]
Lpc_3:
  s_add_u32 s54, s54, EXIT-Lpc_3
  s_addc_u32 s55, s55, 0
  v_lshlrev_b32 v66, 3, v2
  v_add_u32 v67, 0, v66
  v_min_u32 v67, TEAM_FOREIGN-EXIT-4, v67
  v_mov_b32 v65, s55
  v_add_co_u32 v64, vcc, s54, v67
  s_nop 1
  v_addc_co_u32 v65, vcc, 0, v65, vcc
  global_load_dword v68, v[64:65], off
  v_add_u32 v67, 8192, v66
  v_min_u32 v67, TEAM_FOREIGN-EXIT-4, v67
  v_mov_b32 v65, s55
  v_add_co_u32 v64, vcc, s54, v67
  s_nop 1
  v_addc_co_u32 v65, vcc, 0, v65, vcc
  global_load_dword v69, v[64:65], off
  v_add_u32 v67, 16384, v66
  v_min_u32 v67, TEAM_FOREIGN-EXIT-4, v67
  v_mov_b32 v65, s55
  v_add_co_u32 v64, vcc, s54, v67
  s_nop 1
  v_addc_co_u32 v65, vcc, 0, v65, vcc
  global_load_dword v70, v[64:65], off
  v_add_u32 v67, 24576, v66
  v_min_u32 v67, TEAM_FOREIGN-EXIT-4, v67
  v_mov_b32 v65, s55
  v_add_co_u32 v64, vcc, s54, v67
  s_nop 1
  v_addc_co_u32 v65, vcc, 0, v65, vcc
  global_load_dword v71, v[64:65], off
  v_add_u32 v67, 32768, v66
  v_min_u32 v67, TEAM_FOREIGN-EXIT-4, v67
  v_mov_b32 v65, s55
  v_add_co_u32 v64, vcc, s54, v67
  s_nop 1
  v_addc_co_u32 v65, vcc, 0, v65, vcc
  global_load_dword v72, v[64:65], off
  v_add_u32 v67, 40960, v66
  v_min_u32 v67, TEAM_FOREIGN-EXIT-4, v67
  v_mov_b32 v65, s55
  v_add_co_u32 v64, vcc, s54, v67
  s_nop 1
  v_addc_co_u32 v65, vcc, 0, v65, vcc
  global_load_dword v73, v[64:65], off
  v_add_u32 v67, 49152, v66
  v_min_u32 v67, TEAM_FOREIGN-EXIT-4, v67
  v_mov_b32 v65, s55
  v_add_co_u32 v64, vcc, s54, v67
  s_nop 1
  v_addc_co_u32 v65, vcc, 0, v65, vcc
  global_load_dword v74, v[64:65], off
Ltc_2:
  s_cmp_ge_u32 s2, 48
  s_cbranch_scc1 Linit_4
  s_lshl_b32 s52, s2, 10
  v_lshlrev_b32 v52, 2, v0
  v_mov_b32 v53, 0
  buffer_store_dword v53, v52, s[32:35], s52 offen sc1
  s_waitcnt vmcnt(0)
  s_barrier
  s_cmp_lg_u32 s48, 0
  s_cbranch_scc1 Linit_4
  v_mov_b32 v52, 128
  v_mov_b32 v53, 1
  s_mov_b64 exec, 1
  buffer_atomic_add v53, v52, s[44:47], 0 offen
  s_mov_b64 exec, -1
Linit_4:
  s_cmp_lg_u32 s48, 0
  s_cbranch_scc1 Ltf_5
  s_waitcnt vmcnt(0)
  v_readfirstlane_b32 s61, v48
  s_cmp_lg_u32 s60, 0
  s_cbranch_scc1 Ltfw_6
  s_cmp_lt_u32 s61, 32
  s_cbranch_scc1 Ltfd_7
  v_mov_b32 v48, 1
  v_mov_b32 v50, 0
  s_mov_b64 exec, 1
  buffer_atomic_add v48, v50, s[44:47], 0 offen sc0
  s_mov_b64 exec, -1
  s_waitcnt vmcnt(0)
  v_readfirstlane_b32 s61, v48
Ltfw_6:
  s_add_u32 s61, s61, 32
  s_cmp_lt_u32 s61, 256
  s_cbranch_scc1 Ltfd_7
  s_sub_u32 s61, 543, s61
Ltfd_7:
  v_mov_b32 v50, s61
  v_mov_b32 v49, 40704
  ds_write_b32 v49, v50
  s_waitcnt lgkmcnt(0)
Ltf_5:
  s_barrier
  v_mov_b32 v49, 40704
  ds_read_b32 v50, v49
  s_waitcnt lgkmcnt(0)
  v_readfirstlane_b32 s61, v50
  s_barrier
  s_lshr_b32 s63, s61, 8
  s_and_b32 s61, s61, 0xff
  s_sub_u32 s62, s61, 96
  s_cmp_ge_u32 s62, 96
  s_cbranch_scc1 Lnoln_8
LN_LOOP:
  s_mov_b32 s36, s4
  s_mov_b32 s37, s5
  s_mov_b32 s38, 2097152
  s_mov_b32 s39, 0x00020000
  s_lshl_b32 s52, s62, 3
  s_lshl_b32 s53, s48, 1
  s_add_u32 s52, s52, s53
  s_lshl_b32 s52, s52, 10
  v_lshlrev_b32 v4, 5, v1
  buffer_load_dwordx4 v[8:11], v4, s[36:39], s52 offen
  buffer_load_dwordx4 v[12:15], v4, s[36:39], s52 offen offset:16
  s_waitcnt vmcnt(0)
  v_lshlrev_b32 v16, 16, v8
  v_and_b32 v17, 0xffff0000, v8
  v_lshlrev_b32 v18, 16, v9
  v_and_b32 v19, 0xffff0000, v9
  v_lshlrev_b32 v20, 16, v10
  v_and_b32 v21, 0xffff0000, v10
  v_lshlrev_b32 v22, 16, v11
  v_and_b32 v23, 0xffff0000, v11
  v_lshlrev_b32 v24, 16, v12
  v_and_b32 v25, 0xffff0000, v12
  v_lshlrev_b32 v26, 16, v13
  v_and_b32 v27, 0xffff0000, v13
  v_lshlrev_b32 v28, 16, v14
  v_and_b32 v29, 0xffff0000, v14
  v_lshlrev_b32 v30, 16, v15
  v_and_b32 v31, 0xffff0000, v15
  v_add_f32 v32, v16, v17
  v_add_f32 v33, v18, v19
  v_add_f32 v34, v20, v21
  v_add_f32 v35, v22, v23
  v_add_f32 v36, v24, v25
  v_add_f32 v37, v26, v27
  v_add_f32 v38, v28, v29
  v_add_f32 v39, v30, v31
  v_add_f32 v32, v32, v36
  v_add_f32 v33, v33, v37
  v_add_f32 v34, v34, v38
  v_add_f32 v35, v35, v39
  v_add_f32 v32, v32, v34
  v_add_f32 v33, v33, v35
  v_add_f32 v32, v32, v33
  s_nop 1
  v_add_f32_dpp v32, v32, v32 quad_perm:[1,0,3,2] row_mask:0xf bank_mask:0xf
  s_nop 1
  v_add_f32_dpp v32, v32, v32 quad_perm:[2,3,0,1] row_mask:0xf bank_mask:0xf
  s_nop 1
  v_add_f32_dpp v32, v32, v32 row_half_mirror row_mask:0xf bank_mask:0xf
  s_nop 1
  v_add_f32_dpp v32, v32, v32 row_mirror row_mask:0xf bank_mask:0xf
  v_mov_b32 v33, v32
  s_nop 1
  v_permlane16_swap_b32 v32, v33
  s_nop 1
  v_add_f32 v32, v32, v33
  v_mul_f32 v32, 0x3b000000, v32
  v_sub_f32 v34, v16, v32
  v_mul_f32 v33, v34, v34
  v_sub_f32 v34, v17, v32
  v_fmac_f32 v33, v34, v34
  v_sub_f32 v34, v18, v32
  v_fmac_f32 v33, v34, v34
  v_sub_f32 v34, v19, v32
  v_fmac_f32 v33, v34, v34
  v_sub_f32 v34, v20, v32
  v_fmac_f32 v33, v34, v34
  v_sub_f32 v34, v21, v32
  v_fmac_f32 v33, v34, v34
  v_sub_f32 v34, v22, v32
  v_fmac_f32 v33, v34, v34
  v_sub_f32 v34, v23, v32
  v_fmac_f32 v33, v34, v34
  v_sub_f32 v34, v24, v32
  v_fmac_f32 v33, v34, v34
  v_sub_f32 v34, v25, v32
  v_fmac_f32 v33, v34, v34
  v_sub_f32 v34, v26, v32
  v_fmac_f32 v33, v34, v34
  v_sub_f32 v34, v27, v32
  v_fmac_f32 v33, v34, v34
  v_sub_f32 v34, v28, v32
  v_fmac_f32 v33, v34, v34
  v_sub_f32 v34, v29, v32
  v_fmac_f32 v33, v34, v34
  v_sub_f32 v34, v30, v32
  v_fmac_f32 v33, v34, v34
  v_sub_f32 v34, v31, v32
  v_fmac_f32 v33, v34, v34
  s_nop 1
  v_add_f32_dpp v33, v33, v33 quad_perm:[1,0,3,2] row_mask:0xf bank_mask:0xf
  s_nop 1
  v_add_f32_dpp v33, v33, v33 quad_perm:[2,3,0,1] row_mask:0xf bank_mask:0xf
  s_nop 1
  v_add_f32_dpp v33, v33, v33 row_half_mirror row_mask:0xf bank_mask:0xf
  s_nop 1
  v_add_f32_dpp v33, v33, v33 row_mirror row_mask:0xf bank_mask:0xf
  v_mov_b32 v34, v33
  s_nop 1
  v_permlane16_swap_b32 v33, v34
  s_nop 1
  v_add_f32 v33, v33, v34
  v_mul_f32 v33, 0x3b000000, v33
  v_cvt_pk_bf16_f32 v34, v32, v32
  v_lshlrev_b32 v32, 16, v34
  v_cvt_pk_bf16_f32 v34, v33, v33
  v_lshlrev_b32 v33, 16, v34
  v_add_f32 v33, 0x3727c5ac, v33
  v_cvt_pk_bf16_f32 v34, v33, v33
  v_lshlrev_b32 v33, 16, v34
  v_sqrt_f32 v33, v33
  s_nop 0
  v_cvt_pk_bf16_f32 v34, v33, v33
  v_lshlrev_b32 v33, 16, v34
  v_rcp_f32 v33, v33
  v_sub_f32 v16, v16, v32
  v_sub_f32 v17, v17, v32
  v_sub_f32 v18, v18, v32
  v_sub_f32 v19, v19, v32
  v_sub_f32 v20, v20, v32
  v_sub_f32 v21, v21, v32
  v_sub_f32 v22, v22, v32
  v_sub_f32 v23, v23, v32
  v_sub_f32 v24, v24, v32
  v_sub_f32 v25, v25, v32
  v_sub_f32 v26, v26, v32
  v_sub_f32 v27, v27, v32
  v_sub_f32 v28, v28, v32
  v_sub_f32 v29, v29, v32
  v_sub_f32 v30, v30, v32
  v_sub_f32 v31, v31, v32
  v_cvt_pk_bf16_f32 v8, v16, v17
  v_cvt_pk_bf16_f32 v9, v18, v19
  v_cvt_pk_bf16_f32 v10, v20, v21
  v_cvt_pk_bf16_f32 v11, v22, v23
  v_cvt_pk_bf16_f32 v12, v24, v25
  v_cvt_pk_bf16_f32 v13, v26, v27
  v_cvt_pk_bf16_f32 v14, v28, v29
  v_cvt_pk_bf16_f32 v15, v30, v31
  v_lshlrev_b32 v16, 16, v8
  v_and_b32 v17, 0xffff0000, v8
  v_lshlrev_b32 v18, 16, v9
  v_and_b32 v19, 0xffff0000, v9
  v_lshlrev_b32 v20, 16, v10
  v_and_b32 v21, 0xffff0000, v10
  v_lshlrev_b32 v22, 16, v11
  v_and_b32 v23, 0xffff0000, v11
  v_lshlrev_b32 v24, 16, v12
  v_and_b32 v25, 0xffff0000, v12
  v_lshlrev_b32 v26, 16, v13
  v_and_b32 v27, 0xffff0000, v13
  v_lshlrev_b32 v28, 16, v14
  v_and_b32 v29, 0xffff0000, v14
  v_lshlrev_b32 v30, 16, v15
  v_and_b32 v31, 0xffff0000, v15
  v_mul_f32 v16, v16, v33
  v_mul_f32 v17, v17, v33
  v_mul_f32 v18, v18, v33
  v_mul_f32 v19, v19, v33
  v_mul_f32 v20, v20, v33
  v_mul_f32 v21, v21, v33
  v_mul_f32 v22, v22, v33
  v_mul_f32 v23, v23, v33
  v_mul_f32 v24, v24, v33
  v_mul_f32 v25, v25, v33
  v_mul_f32 v26, v26, v33
  v_mul_f32 v27, v27, v33
  v_mul_f32 v28, v28, v33
  v_mul_f32 v29, v29, v33
  v_mul_f32 v30, v30, v33
  v_mul_f32 v31, v31, v33
  v_cvt_pk_bf16_f32 v40, v16, v17
  v_cvt_pk_bf16_f32 v41, v18, v19
  v_cvt_pk_bf16_f32 v44, v20, v21
  v_cvt_pk_bf16_f32 v45, v22, v23
  v_cvt_pk_bf16_f32 v42, v24, v25
  v_cvt_pk_bf16_f32 v43, v26, v27
  v_cvt_pk_bf16_f32 v46, v28, v29
  v_cvt_pk_bf16_f32 v47, v30, v31
  v_and_b32 v4, 31, v1
  v_lshlrev_b32 v4, 8, v4
  v_lshrrev_b32 v5, 5, v1
  v_lshl_add_u32 v4, v5, 4, v4
  s_lshl_b32 s52, s48, 5
  v_add_u32 v4, s52, v4
  ds_write_b128 v4, v[40:43]
  ds_write_b128 v4, v[44:47] offset:128
  v_lshlrev_b32 v5, 4, v0
  s_waitcnt lgkmcnt(0)
  s_barrier
  ds_read_b128 v[8:11], v5
  ds_read_b128 v[12:15], v5 offset:4096
  v_lshrrev_b32 v6, 3, v0
  v_lshlrev_b32 v6, 9, v6
  v_and_b32 v7, 7, v0
  v_lshl_add_u32 v6, v7, 4, v6
  s_lshr_b32 s52, s62, 2
  s_lshl_b32 s52, s52, 15
  s_and_b32 s53, s62, 3
  s_lshl_b32 s53, s53, 7
  s_add_u32 s52, s52, s53
  s_add_u32 s52, s52, 1048576
  s_add_u32 s53, s52, 16384
  s_waitcnt lgkmcnt(0)
  buffer_store_dwordx4 v[8:11], v6, s[32:35], s52 offen sc1
  buffer_store_dwordx4 v[12:15], v6, s[32:35], s53 offen sc1
  s_waitcnt vmcnt(0)
  s_barrier
  s_cmp_lg_u32 s48, 0
  s_cbranch_scc1 Llnsig_9
  v_mov_b32 v4, 0
  s_mov_b32 s56, 128
  s_mov_b32 s57, 47
  s_cmp_eq_u32 s50, 0
  s_cbranch_scc1 Lwaitd_11
  s_mov_b32 s52, 0
  s_mov_b32 s54, 1
  s_mov_b32 s55, 0
Lwait_10:
  buffer_load_dword v5, v4, s[44:47], s56 offen sc1
  s_add_u32 s52, s52, 1
  s_cmp_gt_u32 s52, 65536
  s_cbranch_scc1 Lwaitd_11
  s_waitcnt vmcnt(0)
  v_cmp_gt_u32 vcc, v5, s57
  s_and_b64 vcc, vcc, s[54:55]
  s_cmp_eq_u64 vcc, s[54:55]
  s_cbranch_scc1 Lwaitd_11
  s_sleep 2
  s_branch Lwait_10
Lwaitd_11:
  s_waitcnt vmcnt(0)
  s_lshl_b32 s56, s62, 6
  s_add_u32 s56, s56, 32768
  s_mov_b32 s57, 1
  s_waitcnt vmcnt(0)
  s_cmp_eq_u32 s50, 0
  s_cbranch_scc1 Lsig_12
  v_mov_b32 v4, s57
  v_mov_b32 v5, 0
  s_mov_b64 exec, 1
  buffer_store_dword v4, v5, s[32:35], s56 offen sc1
  s_mov_b64 exec, -1
Lsig_12:
Llnsig_9:
  s_barrier
  s_add_u32 s62, s62, 96
  s_cmp_lt_u32 s62, 256
  s_cbranch_scc1 LN_LOOP
Lnoln_8:
  s_sub_u32 s49, s61, 0
  s_cmp_lt_u32 s61, 32
  s_cbranch_scc1 ROLE_TEAM
  s_sub_u32 s49, s61, 32
  s_cmp_lt_u32 s61, 64
  s_cbranch_scc1 ROLE_K
  s_sub_u32 s49, s61, 64
  s_cmp_lt_u32 s61, 96
  s_cbranch_scc1 ROLE_V
  s_sub_u32 s49, s61, 96
  s_cmp_lt_u32 s61, 124
  s_cbranch_scc1 ROLE_GU
  s_sub_u32 s49, s61, 124
  s_cmp_lt_u32 s61, 140
  s_cbranch_scc1 ROLE_DOWN
  s_sub_u32 s49, s61, 140
  s_cmp_lt_u32 s61, 192
  s_cbranch_scc1 ROLE_RED
  s_sub_u32 s49, s61, 192
  s_cmp_lt_u32 s61, 224
  s_cbranch_scc1 ROLE_QA
  s_sub_u32 s49, s61, 224
  s_cmp_lt_u32 s61, 256
  s_cbranch_scc1 ROLE_WO
  s_endpgm
EXIT:
  s_endpgm
ROLE_K:
  s_mov_b32 s36, s10
  s_mov_b32 s37, s11
  s_mov_b32 s38, 4194304
  s_mov_b32 s39, 0x00020000
  s_lshl_b32 s62, s49, 8
  v_and_b32 v7, 15, v1
  v_lshlrev_b32 v4, 4, v7
  v_lshrrev_b32 v7, 5, v1
  v_mul_u32_u24 v8, 131072, v7
  v_add_u32 v4, v4, v8
  v_bfe_u32 v9, v1, 4, 1
  v_mul_u32_u24 v8, 32768, v9
  v_add_u32 v4, v4, v8
  v_lshlrev_b32 v5, 12, v7
  v_lshl_add_u32 v5, v9, 9, v5
  v_bfe_u32 v8, v1, 2, 2
  v_lshl_add_u32 v5, v8, 10, v5
  v_and_b32 v8, 3, v1
  v_lshl_add_u32 v5, v8, 7, v5
  s_lshl_b32 s52, s48, 13
  v_add_u32 v5, s52, v5
  v_add_u32 v6, 0x10000, v5
  s_mul_i32 s52, s48, 262144
  s_add_u32 s52, s52, s62
  s_add_u32 s53, s52, 0
  buffer_load_dwordx4 v[16:19], v4, s[36:39], s53 offen
  s_add_u32 s53, s52, 8192
  buffer_load_dwordx4 v[20:23], v4, s[36:39], s53 offen
  s_add_u32 s53, s52, 16384
  buffer_load_dwordx4 v[24:27], v4, s[36:39], s53 offen
  s_add_u32 s53, s52, 24576
  buffer_load_dwordx4 v[28:31], v4, s[36:39], s53 offen
  s_add_u32 s53, s52, 65536
  buffer_load_dwordx4 v[32:35], v4, s[36:39], s53 offen
  s_add_u32 s53, s52, 73728
  buffer_load_dwordx4 v[36:39], v4, s[36:39], s53 offen
  s_add_u32 s53, s52, 81920
  buffer_load_dwordx4 v[40:43], v4, s[36:39], s53 offen
  s_add_u32 s53, s52, 90112
  buffer_load_dwordx4 v[44:47], v4, s[36:39], s53 offen
  s_add_u32 s53, s52, 1048576
  buffer_load_dwordx4 v[48:51], v4, s[36:39], s53 offen
  s_add_u32 s53, s52, 1056768
  buffer_load_dwordx4 v[52:55], v4, s[36:39], s53 offen
  s_add_u32 s53, s52, 1064960
  buffer_load_dwordx4 v[56:59], v4, s[36:39], s53 offen
  s_add_u32 s53, s52, 1073152
  buffer_load_dwordx4 v[60:63], v4, s[36:39], s53 offen
  s_add_u32 s53, s52, 1114112
  buffer_load_dwordx4 v[64:67], v4, s[36:39], s53 offen
  s_add_u32 s53, s52, 1122304
  buffer_load_dwordx4 v[68:71], v4, s[36:39], s53 offen
  s_add_u32 s53, s52, 1130496
  buffer_load_dwordx4 v[72:75], v4, s[36:39], s53 offen
  s_add_u32 s53, s52, 1138688
  buffer_load_dwordx4 v[76:79], v4, s[36:39], s53 offen
  s_add_u32 s53, s52, 2097152
  buffer_load_dwordx4 v[80:83], v4, s[36:39], s53 offen
  s_add_u32 s53, s52, 2105344
  buffer_load_dwordx4 v[84:87], v4, s[36:39], s53 offen
  s_add_u32 s53, s52, 2113536
  buffer_load_dwordx4 v[88:91], v4, s[36:39], s53 offen
  s_add_u32 s53, s52, 2121728
  buffer_load_dwordx4 v[92:95], v4, s[36:39], s53 offen
  s_add_u32 s53, s52, 2162688
  buffer_load_dwordx4 v[96:99], v4, s[36:39], s53 offen
  s_add_u32 s53, s52, 2170880
  buffer_load_dwordx4 v[100:103], v4, s[36:39], s53 offen
  s_add_u32 s53, s52, 2179072
  buffer_load_dwordx4 v[104:107], v4, s[36:39], s53 offen
  s_add_u32 s53, s52, 2187264
  buffer_load_dwordx4 v[108:111], v4, s[36:39], s53 offen
  s_add_u32 s53, s52, 3145728
  buffer_load_dwordx4 v[112:115], v4, s[36:39], s53 offen
  s_add_u32 s53, s52, 3153920
  buffer_load_dwordx4 v[116:119], v4, s[36:39], s53 offen
  s_add_u32 s53, s52, 3162112
  buffer_load_dwordx4 v[120:123], v4, s[36:39], s53 offen
  s_add_u32 s53, s52, 3170304
  buffer_load_dwordx4 v[124:127], v4, s[36:39], s53 offen
  s_add_u32 s53, s52, 3211264
  buffer_load_dwordx4 v[128:131], v4, s[36:39], s53 offen
  s_add_u32 s53, s52, 3219456
  buffer_load_dwordx4 v[132:135], v4, s[36:39], s53 offen
  s_add_u32 s53, s52, 3227648
  buffer_load_dwordx4 v[136:139], v4, s[36:39], s53 offen
  s_add_u32 s53, s52, 3235840
  buffer_load_dwordx4 v[140:143], v4, s[36:39], s53 offen
Lwl_skip_13:
  s_waitcnt vmcnt(0)
  v_perm_b32 v144, v20, v16, s64
  v_perm_b32 v145, v28, v24, s64
  v_perm_b32 v146, v36, v32, s64
  v_perm_b32 v147, v44, v40, s64
  ds_write_b128 v5, v[144:147] offset:0
  v_perm_b32 v148, v20, v16, s65
  v_perm_b32 v149, v28, v24, s65
  v_perm_b32 v150, v36, v32, s65
  v_perm_b32 v151, v44, v40, s65
  ds_write_b128 v5, v[148:151] offset:16
  v_perm_b32 v152, v21, v17, s64
  v_perm_b32 v153, v29, v25, s64
  v_perm_b32 v154, v37, v33, s64
  v_perm_b32 v155, v45, v41, s64
  ds_write_b128 v5, v[152:155] offset:32
  v_perm_b32 v156, v21, v17, s65
  v_perm_b32 v157, v29, v25, s65
  v_perm_b32 v158, v37, v33, s65
  v_perm_b32 v159, v45, v41, s65
  ds_write_b128 v5, v[156:159] offset:48
  s_waitcnt lgkmcnt(0)
  v_perm_b32 v144, v22, v18, s64
  v_perm_b32 v145, v30, v26, s64
  v_perm_b32 v146, v38, v34, s64
  v_perm_b32 v147, v46, v42, s64
  ds_write_b128 v5, v[144:147] offset:64
  v_perm_b32 v148, v22, v18, s65
  v_perm_b32 v149, v30, v26, s65
  v_perm_b32 v150, v38, v34, s65
  v_perm_b32 v151, v46, v42, s65
  ds_write_b128 v5, v[148:151] offset:80
  v_perm_b32 v152, v23, v19, s64
  v_perm_b32 v153, v31, v27, s64
  v_perm_b32 v154, v39, v35, s64
  v_perm_b32 v155, v47, v43, s64
  ds_write_b128 v5, v[152:155] offset:96
  v_perm_b32 v156, v23, v19, s65
  v_perm_b32 v157, v31, v27, s65
  v_perm_b32 v158, v39, v35, s65
  v_perm_b32 v159, v47, v43, s65
  ds_write_b128 v5, v[156:159] offset:112
  s_waitcnt lgkmcnt(0)
  v_perm_b32 v144, v52, v48, s64
  v_perm_b32 v145, v60, v56, s64
  v_perm_b32 v146, v68, v64, s64
  v_perm_b32 v147, v76, v72, s64
  ds_write_b128 v5, v[144:147] offset:32768
  v_perm_b32 v148, v52, v48, s65
  v_perm_b32 v149, v60, v56, s65
  v_perm_b32 v150, v68, v64, s65
  v_perm_b32 v151, v76, v72, s65
  ds_write_b128 v5, v[148:151] offset:32784
  v_perm_b32 v152, v53, v49, s64
  v_perm_b32 v153, v61, v57, s64
  v_perm_b32 v154, v69, v65, s64
  v_perm_b32 v155, v77, v73, s64
  ds_write_b128 v5, v[152:155] offset:32800
  v_perm_b32 v156, v53, v49, s65
  v_perm_b32 v157, v61, v57, s65
  v_perm_b32 v158, v69, v65, s65
  v_perm_b32 v159, v77, v73, s65
  ds_write_b128 v5, v[156:159] offset:32816
  s_waitcnt lgkmcnt(0)
  v_perm_b32 v144, v54, v50, s64
  v_perm_b32 v145, v62, v58, s64
  v_perm_b32 v146, v70, v66, s64
  v_perm_b32 v147, v78, v74, s64
  ds_write_b128 v5, v[144:147] offset:32832
  v_perm_b32 v148, v54, v50, s65
  v_perm_b32 v149, v62, v58, s65
  v_perm_b32 v150, v70, v66, s65
  v_perm_b32 v151, v78, v74, s65
  ds_write_b128 v5, v[148:151] offset:32848
  v_perm_b32 v152, v55, v51, s64
  v_perm_b32 v153, v63, v59, s64
  v_perm_b32 v154, v71, v67, s64
  v_perm_b32 v155, v79, v75, s64
  ds_write_b128 v5, v[152:155] offset:32864
  v_perm_b32 v156, v55, v51, s65
  v_perm_b32 v157, v63, v59, s65
  v_perm_b32 v158, v71, v67, s65
  v_perm_b32 v159, v79, v75, s65
  ds_write_b128 v5, v[156:159] offset:32880
  s_waitcnt lgkmcnt(0)
  v_perm_b32 v144, v84, v80, s64
  v_perm_b32 v145, v92, v88, s64
  v_perm_b32 v146, v100, v96, s64
  v_perm_b32 v147, v108, v104, s64
  ds_write_b128 v6, v[144:147] offset:0
  v_perm_b32 v148, v84, v80, s65
  v_perm_b32 v149, v92, v88, s65
  v_perm_b32 v150, v100, v96, s65
  v_perm_b32 v151, v108, v104, s65
  ds_write_b128 v6, v[148:151] offset:16
  v_perm_b32 v152, v85, v81, s64
  v_perm_b32 v153, v93, v89, s64
  v_perm_b32 v154, v101, v97, s64
  v_perm_b32 v155, v109, v105, s64
  ds_write_b128 v6, v[152:155] offset:32
  v_perm_b32 v156, v85, v81, s65
  v_perm_b32 v157, v93, v89, s65
  v_perm_b32 v158, v101, v97, s65
  v_perm_b32 v159, v109, v105, s65
  ds_write_b128 v6, v[156:159] offset:48
  s_waitcnt lgkmcnt(0)
  v_perm_b32 v144, v86, v82, s64
  v_perm_b32 v145, v94, v90, s64
  v_perm_b32 v146, v102, v98, s64
  v_perm_b32 v147, v110, v106, s64
  ds_write_b128 v6, v[144:147] offset:64
  v_perm_b32 v148, v86, v82, s65
  v_perm_b32 v149, v94, v90, s65
  v_perm_b32 v150, v102, v98, s65
  v_perm_b32 v151, v110, v106, s65
  ds_write_b128 v6, v[148:151] offset:80
  v_perm_b32 v152, v87, v83, s64
  v_perm_b32 v153, v95, v91, s64
  v_perm_b32 v154, v103, v99, s64
  v_perm_b32 v155, v111, v107, s64
  ds_write_b128 v6, v[152:155] offset:96
  v_perm_b32 v156, v87, v83, s65
  v_perm_b32 v157, v95, v91, s65
  v_perm_b32 v158, v103, v99, s65
  v_perm_b32 v159, v111, v107, s65
  ds_write_b128 v6, v[156:159] offset:112
  s_waitcnt lgkmcnt(0)
  v_perm_b32 v144, v116, v112, s64
  v_perm_b32 v145, v124, v120, s64
  v_perm_b32 v146, v132, v128, s64
  v_perm_b32 v147, v140, v136, s64
  ds_write_b128 v6, v[144:147] offset:32768
  v_perm_b32 v148, v116, v112, s65
  v_perm_b32 v149, v124, v120, s65
  v_perm_b32 v150, v132, v128, s65
  v_perm_b32 v151, v140, v136, s65
  ds_write_b128 v6, v[148:151] offset:32784
  v_perm_b32 v152, v117, v113, s64
  v_perm_b32 v153, v125, v121, s64
  v_perm_b32 v154, v133, v129, s64
  v_perm_b32 v155, v141, v137, s64
  ds_write_b128 v6, v[152:155] offset:32800
  v_perm_b32 v156, v117, v113, s65
  v_perm_b32 v157, v125, v121, s65
  v_perm_b32 v158, v133, v129, s65
  v_perm_b32 v159, v141, v137, s65
  ds_write_b128 v6, v[156:159] offset:32816
  s_waitcnt lgkmcnt(0)
  v_perm_b32 v144, v118, v114, s64
  v_perm_b32 v145, v126, v122, s64
  v_perm_b32 v146, v134, v130, s64
  v_perm_b32 v147, v142, v138, s64
  ds_write_b128 v6, v[144:147] offset:32832
  v_perm_b32 v148, v118, v114, s65
  v_perm_b32 v149, v126, v122, s65
  v_perm_b32 v150, v134, v130, s65
  v_perm_b32 v151, v142, v138, s65
  ds_write_b128 v6, v[148:151] offset:32848
  v_perm_b32 v152, v119, v115, s64
  v_perm_b32 v153, v127, v123, s64
  v_perm_b32 v154, v135, v131, s64
  v_perm_b32 v155, v143, v139, s64
  ds_write_b128 v6, v[152:155] offset:32864
  v_perm_b32 v156, v119, v115, s65
  v_perm_b32 v157, v127, v123, s65
  v_perm_b32 v158, v135, v131, s65
  v_perm_b32 v159, v143, v139, s65
  ds_write_b128 v6, v[156:159] offset:32880
  s_waitcnt lgkmcnt(0)
Lwl_skip2_14:
  s_cmp_lg_u32 s48, 0
  s_cbranch_scc1 Lwi_15
  v_mov_b32 v4, 0
  s_mov_b32 s56, 128
  s_mov_b32 s57, 47
  s_cmp_eq_u32 s50, 0
  s_cbranch_scc1 Lwaitd_17
  s_mov_b32 s52, 0
  s_mov_b32 s54, 1
  s_mov_b32 s55, 0
Lwait_16:
  buffer_load_dword v5, v4, s[44:47], s56 offen sc1
  s_add_u32 s52, s52, 1
  s_cmp_gt_u32 s52, 65536
  s_cbranch_scc1 Lwaitd_17
  s_waitcnt vmcnt(0)
  v_cmp_gt_u32 vcc, v5, s57
  s_and_b64 vcc, vcc, s[54:55]
  s_cmp_eq_u64 vcc, s[54:55]
  s_cbranch_scc1 Lwaitd_17
  s_sleep 2
  s_branch Lwait_16
Lwaitd_17:
  s_waitcnt vmcnt(0)
Lwi_15:
  s_waitcnt lgkmcnt(0)
  s_barrier
  v_add_u32 v3, 0x10000, v2
  s_mov_b32 s51, s48
LOOP_K:
  s_lshl_b32 s56, s51, 8
  s_add_u32 s56, s56, 32768
  s_mov_b32 s57, 0
  v_min_u32 v4, 3, v1
  v_lshlrev_b32 v4, 6, v4
  s_cmp_eq_u32 s50, 0
  s_cbranch_scc1 Lwaitd_19
  s_mov_b32 s52, 0
  s_mov_b32 s54, 15
  s_mov_b32 s55, 0
Lwait_18:
  buffer_load_dword v5, v4, s[32:35], s56 offen sc1
  s_add_u32 s52, s52, 1
  s_cmp_gt_u32 s52, 65536
  s_cbranch_scc1 Lwaitd_19
  s_waitcnt vmcnt(0)
  v_cmp_gt_u32 vcc, v5, s57
  s_and_b64 vcc, vcc, s[54:55]
  s_cmp_eq_u64 vcc, s[54:55]
  s_cbranch_scc1 Lwaitd_19
  s_sleep 2
  s_branch Lwait_18
Lwaitd_19:
  s_waitcnt vmcnt(0)
  s_lshl_b32 s60, s51, 15
  s_add_u32 s60, s60, 1048576
  buffer_load_dwordx4 a[0:3], v2, s[32:35], s60 offen offset:0 sc1
  buffer_load_dwordx4 a[4:7], v2, s[32:35], s60 offen offset:1024 sc1
  buffer_load_dwordx4 a[8:11], v2, s[32:35], s60 offen offset:2048 sc1
  buffer_load_dwordx4 a[12:15], v2, s[32:35], s60 offen offset:3072 sc1
  s_add_u32 s60, s60, 4096
  buffer_load_dwordx4 a[16:19], v2, s[32:35], s60 offen offset:0 sc1
  buffer_load_dwordx4 a[20:23], v2, s[32:35], s60 offen offset:1024 sc1
  buffer_load_dwordx4 a[24:27], v2, s[32:35], s60 offen offset:2048 sc1
  buffer_load_dwordx4 a[28:31], v2, s[32:35], s60 offen offset:3072 sc1
  s_add_u32 s60, s60, 4096
  buffer_load_dwordx4 a[32:35], v2, s[32:35], s60 offen offset:0 sc1
  buffer_load_dwordx4 a[36:39], v2, s[32:35], s60 offen offset:1024 sc1
  buffer_load_dwordx4 a[40:43], v2, s[32:35], s60 offen offset:2048 sc1
  buffer_load_dwordx4 a[44:47], v2, s[32:35], s60 offen offset:3072 sc1
  s_add_u32 s60, s60, 4096
  buffer_load_dwordx4 a[48:51], v2, s[32:35], s60 offen offset:0 sc1
  buffer_load_dwordx4 a[52:55], v2, s[32:35], s60 offen offset:1024 sc1
  buffer_load_dwordx4 a[56:59], v2, s[32:35], s60 offen offset:2048 sc1
  buffer_load_dwordx4 a[60:63], v2, s[32:35], s60 offen offset:3072 sc1
  s_add_u32 s60, s60, 4096
  buffer_load_dwordx4 a[64:67], v2, s[32:35], s60 offen offset:0 sc1
  buffer_load_dwordx4 a[68:71], v2, s[32:35], s60 offen offset:1024 sc1
  buffer_load_dwordx4 a[72:75], v2, s[32:35], s60 offen offset:2048 sc1
  buffer_load_dwordx4 a[76:79], v2, s[32:35], s60 offen offset:3072 sc1
  s_add_u32 s60, s60, 4096
  buffer_load_dwordx4 a[80:83], v2, s[32:35], s60 offen offset:0 sc1
  buffer_load_dwordx4 a[84:87], v2, s[32:35], s60 offen offset:1024 sc1
  buffer_load_dwordx4 a[88:91], v2, s[32:35], s60 offen offset:2048 sc1
  buffer_load_dwordx4 a[92:95], v2, s[32:35], s60 offen offset:3072 sc1
  s_add_u32 s60, s60, 4096
  buffer_load_dwordx4 a[96:99], v2, s[32:35], s60 offen offset:0 sc1
  buffer_load_dwordx4 a[100:103], v2, s[32:35], s60 offen offset:1024 sc1
  buffer_load_dwordx4 a[104:107], v2, s[32:35], s60 offen offset:2048 sc1
  buffer_load_dwordx4 a[108:111], v2, s[32:35], s60 offen offset:3072 sc1
  s_add_u32 s60, s60, 4096
  buffer_load_dwordx4 a[112:115], v2, s[32:35], s60 offen offset:0 sc1
  buffer_load_dwordx4 a[116:119], v2, s[32:35], s60 offen offset:1024 sc1
  buffer_load_dwordx4 a[120:123], v2, s[32:35], s60 offen offset:2048 sc1
  buffer_load_dwordx4 a[124:127], v2, s[32:35], s60 offen offset:3072 sc1
  ds_read_b128 v[128:131], v2 offset:0
  ds_read_b128 v[132:135], v2 offset:1024
  ds_read_b128 v[136:139], v2 offset:2048
  ds_read_b128 v[140:143], v2 offset:3072
  ds_read_b128 v[144:147], v2 offset:4096
  ds_read_b128 v[148:151], v2 offset:5120
  ds_read_b128 v[152:155], v2 offset:6144
  ds_read_b128 v[156:159], v2 offset:7168
  s_waitcnt vmcnt(31) lgkmcnt(7)
  v_mfma_f32_32x32x16_bf16 v[64:79], v[128:131], a[0:3], 0
  ds_read_b128 v[128:131], v2 offset:8192
  s_waitcnt lgkmcnt(7)
  v_mfma_f32_32x32x16_bf16 v[80:95], v[132:135], a[0:3], 0
  ds_read_b128 v[132:135], v2 offset:9216
  s_waitcnt lgkmcnt(7)
  v_mfma_f32_32x32x16_bf16 v[96:111], v[136:139], a[0:3], 0
  ds_read_b128 v[136:139], v2 offset:10240
  s_waitcnt lgkmcnt(7)
  v_mfma_f32_32x32x16_bf16 v[112:127], v[140:143], a[0:3], 0
  ds_read_b128 v[140:143], v2 offset:11264
  s_waitcnt vmcnt(30) lgkmcnt(7)
  v_mfma_f32_32x32x16_bf16 v[64:79], v[144:147], a[4:7], v[64:79]
  ds_read_b128 v[144:147], v2 offset:12288
  s_waitcnt lgkmcnt(7)
  v_mfma_f32_32x32x16_bf16 v[80:95], v[148:151], a[4:7], v[80:95]
  ds_read_b128 v[148:151], v2 offset:13312
  s_waitcnt lgkmcnt(7)
  v_mfma_f32_32x32x16_bf16 v[96:111], v[152:155], a[4:7], v[96:111]
  ds_read_b128 v[152:155], v2 offset:14336
  s_waitcnt lgkmcnt(7)
  v_mfma_f32_32x32x16_bf16 v[112:127], v[156:159], a[4:7], v[112:127]
  ds_read_b128 v[156:159], v2 offset:15360
  s_waitcnt vmcnt(29) lgkmcnt(7)
  v_mfma_f32_32x32x16_bf16 v[64:79], v[128:131], a[8:11], v[64:79]
  ds_read_b128 v[128:131], v2 offset:16384
  s_waitcnt lgkmcnt(7)
  v_mfma_f32_32x32x16_bf16 v[80:95], v[132:135], a[8:11], v[80:95]
  ds_read_b128 v[132:135], v2 offset:17408
  s_waitcnt lgkmcnt(7)
  v_mfma_f32_32x32x16_bf16 v[96:111], v[136:139], a[8:11], v[96:111]
  ds_read_b128 v[136:139], v2 offset:18432
  s_waitcnt lgkmcnt(7)
  v_mfma_f32_32x32x16_bf16 v[112:127], v[140:143], a[8:11], v[112:127]
  ds_read_b128 v[140:143], v2 offset:19456
  s_waitcnt vmcnt(28) lgkmcnt(7)
  v_mfma_f32_32x32x16_bf16 v[64:79], v[144:147], a[12:15], v[64:79]
  ds_read_b128 v[144:147], v2 offset:20480
  s_waitcnt lgkmcnt(7)
  v_mfma_f32_32x32x16_bf16 v[80:95], v[148:151], a[12:15], v[80:95]
  ds_read_b128 v[148:151], v2 offset:21504
  s_waitcnt lgkmcnt(7)
  v_mfma_f32_32x32x16_bf16 v[96:111], v[152:155], a[12:15], v[96:111]
  ds_read_b128 v[152:155], v2 offset:22528
  s_waitcnt lgkmcnt(7)
  v_mfma_f32_32x32x16_bf16 v[112:127], v[156:159], a[12:15], v[112:127]
  ds_read_b128 v[156:159], v2 offset:23552
  s_waitcnt vmcnt(27) lgkmcnt(7)
  v_mfma_f32_32x32x16_bf16 v[64:79], v[128:131], a[16:19], v[64:79]
  ds_read_b128 v[128:131], v2 offset:24576
  s_waitcnt lgkmcnt(7)
  v_mfma_f32_32x32x16_bf16 v[80:95], v[132:135], a[16:19], v[80:95]
  ds_read_b128 v[132:135], v2 offset:25600
  s_waitcnt lgkmcnt(7)
  v_mfma_f32_32x32x16_bf16 v[96:111], v[136:139], a[16:19], v[96:111]
  ds_read_b128 v[136:139], v2 offset:26624
  s_waitcnt lgkmcnt(7)
  v_mfma_f32_32x32x16_bf16 v[112:127], v[140:143], a[16:19], v[112:127]
  ds_read_b128 v[140:143], v2 offset:27648
  s_waitcnt vmcnt(26) lgkmcnt(7)
  v_mfma_f32_32x32x16_bf16 v[64:79], v[144:147], a[20:23], v[64:79]
  ds_read_b128 v[144:147], v2 offset:28672
  s_waitcnt lgkmcnt(7)
  v_mfma_f32_32x32x16_bf16 v[80:95], v[148:151], a[20:23], v[80:95]
  ds_read_b128 v[148:151], v2 offset:29696
  s_waitcnt lgkmcnt(7)
  v_mfma_f32_32x32x16_bf16 v[96:111], v[152:155], a[20:23], v[96:111]
  ds_read_b128 v[152:155], v2 offset:30720
  s_waitcnt lgkmcnt(7)
  v_mfma_f32_32x32x16_bf16 v[112:127], v[156:159], a[20:23], v[112:127]
  ds_read_b128 v[156:159], v2 offset:31744
  s_waitcnt vmcnt(25) lgkmcnt(7)
  v_mfma_f32_32x32x16_bf16 v[64:79], v[128:131], a[24:27], v[64:79]
  ds_read_b128 v[128:131], v2 offset:32768
  s_waitcnt lgkmcnt(7)
  v_mfma_f32_32x32x16_bf16 v[80:95], v[132:135], a[24:27], v[80:95]
  ds_read_b128 v[132:135], v2 offset:33792
  s_waitcnt lgkmcnt(7)
  v_mfma_f32_32x32x16_bf16 v[96:111], v[136:139], a[24:27], v[96:111]
  ds_read_b128 v[136:139], v2 offset:34816
  s_waitcnt lgkmcnt(7)
  v_mfma_f32_32x32x16_bf16 v[112:127], v[140:143], a[24:27], v[112:127]
  ds_read_b128 v[140:143], v2 offset:35840
  s_waitcnt vmcnt(24) lgkmcnt(7)
  v_mfma_f32_32x32x16_bf16 v[64:79], v[144:147], a[28:31], v[64:79]
  ds_read_b128 v[144:147], v2 offset:36864
  s_waitcnt lgkmcnt(7)
  v_mfma_f32_32x32x16_bf16 v[80:95], v[148:151], a[28:31], v[80:95]
  ds_read_b128 v[148:151], v2 offset:37888
  s_waitcnt lgkmcnt(7)
  v_mfma_f32_32x32x16_bf16 v[96:111], v[152:155], a[28:31], v[96:111]
  ds_read_b128 v[152:155], v2 offset:38912
  s_waitcnt lgkmcnt(7)
  v_mfma_f32_32x32x16_bf16 v[112:127], v[156:159], a[28:31], v[112:127]
  ds_read_b128 v[156:159], v2 offset:39936
  s_waitcnt vmcnt(23) lgkmcnt(7)
  v_mfma_f32_32x32x16_bf16 v[64:79], v[128:131], a[32:35], v[64:79]
  ds_read_b128 v[128:131], v2 offset:40960
  s_waitcnt lgkmcnt(7)
  v_mfma_f32_32x32x16_bf16 v[80:95], v[132:135], a[32:35], v[80:95]
  ds_read_b128 v[132:135], v2 offset:41984
  s_waitcnt lgkmcnt(7)
  v_mfma_f32_32x32x16_bf16 v[96:111], v[136:139], a[32:35], v[96:111]
  ds_read_b128 v[136:139], v2 offset:43008
  s_waitcnt lgkmcnt(7)
  v_mfma_f32_32x32x16_bf16 v[112:127], v[140:143], a[32:35], v[112:127]
  ds_read_b128 v[140:143], v2 offset:44032
  s_waitcnt vmcnt(22) lgkmcnt(7)
  v_mfma_f32_32x32x16_bf16 v[64:79], v[144:147], a[36:39], v[64:79]
  ds_read_b128 v[144:147], v2 offset:45056
  s_waitcnt lgkmcnt(7)
  v_mfma_f32_32x32x16_bf16 v[80:95], v[148:151], a[36:39], v[80:95]
  ds_read_b128 v[148:151], v2 offset:46080
  s_waitcnt lgkmcnt(7)
  v_mfma_f32_32x32x16_bf16 v[96:111], v[152:155], a[36:39], v[96:111]
  ds_read_b128 v[152:155], v2 offset:47104
  s_waitcnt lgkmcnt(7)
  v_mfma_f32_32x32x16_bf16 v[112:127], v[156:159], a[36:39], v[112:127]
  ds_read_b128 v[156:159], v2 offset:48128
  s_waitcnt vmcnt(21) lgkmcnt(7)
  v_mfma_f32_32x32x16_bf16 v[64:79], v[128:131], a[40:43], v[64:79]
  ds_read_b128 v[128:131], v2 offset:49152
  s_waitcnt lgkmcnt(7)
  v_mfma_f32_32x32x16_bf16 v[80:95], v[132:135], a[40:43], v[80:95]
  ds_read_b128 v[132:135], v2 offset:50176
  s_waitcnt lgkmcnt(7)
  v_mfma_f32_32x32x16_bf16 v[96:111], v[136:139], a[40:43], v[96:111]
  ds_read_b128 v[136:139], v2 offset:51200
  s_waitcnt lgkmcnt(7)
  v_mfma_f32_32x32x16_bf16 v[112:127], v[140:143], a[40:43], v[112:127]
  ds_read_b128 v[140:143], v2 offset:52224
  s_waitcnt vmcnt(20) lgkmcnt(7)
  v_mfma_f32_32x32x16_bf16 v[64:79], v[144:147], a[44:47], v[64:79]
  ds_read_b128 v[144:147], v2 offset:53248
  s_waitcnt lgkmcnt(7)
  v_mfma_f32_32x32x16_bf16 v[80:95], v[148:151], a[44:47], v[80:95]
  ds_read_b128 v[148:151], v2 offset:54272
  s_waitcnt lgkmcnt(7)
  v_mfma_f32_32x32x16_bf16 v[96:111], v[152:155], a[44:47], v[96:111]
  ds_read_b128 v[152:155], v2 offset:55296
  s_waitcnt lgkmcnt(7)
  v_mfma_f32_32x32x16_bf16 v[112:127], v[156:159], a[44:47], v[112:127]
  ds_read_b128 v[156:159], v2 offset:56320
  s_waitcnt vmcnt(19) lgkmcnt(7)
  v_mfma_f32_32x32x16_bf16 v[64:79], v[128:131], a[48:51], v[64:79]
  ds_read_b128 v[128:131], v2 offset:57344
  s_waitcnt lgkmcnt(7)
  v_mfma_f32_32x32x16_bf16 v[80:95], v[132:135], a[48:51], v[80:95]
  ds_read_b128 v[132:135], v2 offset:58368
  s_waitcnt lgkmcnt(7)
  v_mfma_f32_32x32x16_bf16 v[96:111], v[136:139], a[48:51], v[96:111]
  ds_read_b128 v[136:139], v2 offset:59392
  s_waitcnt lgkmcnt(7)
  v_mfma_f32_32x32x16_bf16 v[112:127], v[140:143], a[48:51], v[112:127]
  ds_read_b128 v[140:143], v2 offset:60416
  s_waitcnt vmcnt(18) lgkmcnt(7)
  v_mfma_f32_32x32x16_bf16 v[64:79], v[144:147], a[52:55], v[64:79]
  ds_read_b128 v[144:147], v2 offset:61440
  s_waitcnt lgkmcnt(7)
  v_mfma_f32_32x32x16_bf16 v[80:95], v[148:151], a[52:55], v[80:95]
  ds_read_b128 v[148:151], v2 offset:62464
  s_waitcnt lgkmcnt(7)
  v_mfma_f32_32x32x16_bf16 v[96:111], v[152:155], a[52:55], v[96:111]
  ds_read_b128 v[152:155], v2 offset:63488
  s_waitcnt lgkmcnt(7)
  v_mfma_f32_32x32x16_bf16 v[112:127], v[156:159], a[52:55], v[112:127]
  ds_read_b128 v[156:159], v2 offset:64512
  s_waitcnt vmcnt(17) lgkmcnt(7)
  v_mfma_f32_32x32x16_bf16 v[64:79], v[128:131], a[56:59], v[64:79]
  ds_read_b128 v[128:131], v3 offset:0
  s_waitcnt lgkmcnt(7)
  v_mfma_f32_32x32x16_bf16 v[80:95], v[132:135], a[56:59], v[80:95]
  ds_read_b128 v[132:135], v3 offset:1024
  s_waitcnt lgkmcnt(7)
  v_mfma_f32_32x32x16_bf16 v[96:111], v[136:139], a[56:59], v[96:111]
  ds_read_b128 v[136:139], v3 offset:2048
  s_waitcnt lgkmcnt(7)
  v_mfma_f32_32x32x16_bf16 v[112:127], v[140:143], a[56:59], v[112:127]
  ds_read_b128 v[140:143], v3 offset:3072
  s_waitcnt vmcnt(16) lgkmcnt(7)
  v_mfma_f32_32x32x16_bf16 v[64:79], v[144:147], a[60:63], v[64:79]
  ds_read_b128 v[144:147], v3 offset:4096
  s_waitcnt lgkmcnt(7)
  v_mfma_f32_32x32x16_bf16 v[80:95], v[148:151], a[60:63], v[80:95]
  ds_read_b128 v[148:151], v3 offset:5120
  s_waitcnt lgkmcnt(7)
  v_mfma_f32_32x32x16_bf16 v[96:111], v[152:155], a[60:63], v[96:111]
  ds_read_b128 v[152:155], v3 offset:6144
  s_waitcnt lgkmcnt(7)
  v_mfma_f32_32x32x16_bf16 v[112:127], v[156:159], a[60:63], v[112:127]
  ds_read_b128 v[156:159], v3 offset:7168
  s_waitcnt vmcnt(15) lgkmcnt(7)
  v_mfma_f32_32x32x16_bf16 v[64:79], v[128:131], a[64:67], v[64:79]
  ds_read_b128 v[128:131], v3 offset:8192
  s_waitcnt lgkmcnt(7)
  v_mfma_f32_32x32x16_bf16 v[80:95], v[132:135], a[64:67], v[80:95]
  ds_read_b128 v[132:135], v3 offset:9216
  s_waitcnt lgkmcnt(7)
  v_mfma_f32_32x32x16_bf16 v[96:111], v[136:139], a[64:67], v[96:111]
  ds_read_b128 v[136:139], v3 offset:10240
  s_waitcnt lgkmcnt(7)
  v_mfma_f32_32x32x16_bf16 v[112:127], v[140:143], a[64:67], v[112:127]
  ds_read_b128 v[140:143], v3 offset:11264
  s_waitcnt vmcnt(14) lgkmcnt(7)
  v_mfma_f32_32x32x16_bf16 v[64:79], v[144:147], a[68:71], v[64:79]
  ds_read_b128 v[144:147], v3 offset:12288
  s_waitcnt lgkmcnt(7)
  v_mfma_f32_32x32x16_bf16 v[80:95], v[148:151], a[68:71], v[80:95]
  ds_read_b128 v[148:151], v3 offset:13312
  s_waitcnt lgkmcnt(7)
  v_mfma_f32_32x32x16_bf16 v[96:111], v[152:155], a[68:71], v[96:111]
  ds_read_b128 v[152:155], v3 offset:14336
  s_waitcnt lgkmcnt(7)
  v_mfma_f32_32x32x16_bf16 v[112:127], v[156:159], a[68:71], v[112:127]
  ds_read_b128 v[156:159], v3 offset:15360
  s_waitcnt vmcnt(13) lgkmcnt(7)
  v_mfma_f32_32x32x16_bf16 v[64:79], v[128:131], a[72:75], v[64:79]
  ds_read_b128 v[128:131], v3 offset:16384
  s_waitcnt lgkmcnt(7)
  v_mfma_f32_32x32x16_bf16 v[80:95], v[132:135], a[72:75], v[80:95]
  ds_read_b128 v[132:135], v3 offset:17408
  s_waitcnt lgkmcnt(7)
  v_mfma_f32_32x32x16_bf16 v[96:111], v[136:139], a[72:75], v[96:111]
  ds_read_b128 v[136:139], v3 offset:18432
  s_waitcnt lgkmcnt(7)
  v_mfma_f32_32x32x16_bf16 v[112:127], v[140:143], a[72:75], v[112:127]
  ds_read_b128 v[140:143], v3 offset:19456
  s_waitcnt vmcnt(12) lgkmcnt(7)
  v_mfma_f32_32x32x16_bf16 v[64:79], v[144:147], a[76:79], v[64:79]
  ds_read_b128 v[144:147], v3 offset:20480
  s_waitcnt lgkmcnt(7)
  v_mfma_f32_32x32x16_bf16 v[80:95], v[148:151], a[76:79], v[80:95]
  ds_read_b128 v[148:151], v3 offset:21504
  s_waitcnt lgkmcnt(7)
  v_mfma_f32_32x32x16_bf16 v[96:111], v[152:155], a[76:79], v[96:111]
  ds_read_b128 v[152:155], v3 offset:22528
  s_waitcnt lgkmcnt(7)
  v_mfma_f32_32x32x16_bf16 v[112:127], v[156:159], a[76:79], v[112:127]
  ds_read_b128 v[156:159], v3 offset:23552
  s_waitcnt vmcnt(11) lgkmcnt(7)
  v_mfma_f32_32x32x16_bf16 v[64:79], v[128:131], a[80:83], v[64:79]
  ds_read_b128 v[128:131], v3 offset:24576
  s_waitcnt lgkmcnt(7)
  v_mfma_f32_32x32x16_bf16 v[80:95], v[132:135], a[80:83], v[80:95]
  ds_read_b128 v[132:135], v3 offset:25600
  s_waitcnt lgkmcnt(7)
  v_mfma_f32_32x32x16_bf16 v[96:111], v[136:139], a[80:83], v[96:111]
  ds_read_b128 v[136:139], v3 offset:26624
  s_waitcnt lgkmcnt(7)
  v_mfma_f32_32x32x16_bf16 v[112:127], v[140:143], a[80:83], v[112:127]
  ds_read_b128 v[140:143], v3 offset:27648
  s_waitcnt vmcnt(10) lgkmcnt(7)
  v_mfma_f32_32x32x16_bf16 v[64:79], v[144:147], a[84:87], v[64:79]
  ds_read_b128 v[144:147], v3 offset:28672
  s_waitcnt lgkmcnt(7)
  v_mfma_f32_32x32x16_bf16 v[80:95], v[148:151], a[84:87], v[80:95]
  ds_read_b128 v[148:151], v3 offset:29696
  s_waitcnt lgkmcnt(7)
  v_mfma_f32_32x32x16_bf16 v[96:111], v[152:155], a[84:87], v[96:111]
  ds_read_b128 v[152:155], v3 offset:30720
  s_waitcnt lgkmcnt(7)
  v_mfma_f32_32x32x16_bf16 v[112:127], v[156:159], a[84:87], v[112:127]
  ds_read_b128 v[156:159], v3 offset:31744
  s_waitcnt vmcnt(9) lgkmcnt(7)
  v_mfma_f32_32x32x16_bf16 v[64:79], v[128:131], a[88:91], v[64:79]
  ds_read_b128 v[128:131], v3 offset:32768
  s_waitcnt lgkmcnt(7)
  v_mfma_f32_32x32x16_bf16 v[80:95], v[132:135], a[88:91], v[80:95]
  ds_read_b128 v[132:135], v3 offset:33792
  s_waitcnt lgkmcnt(7)
  v_mfma_f32_32x32x16_bf16 v[96:111], v[136:139], a[88:91], v[96:111]
  ds_read_b128 v[136:139], v3 offset:34816
  s_waitcnt lgkmcnt(7)
  v_mfma_f32_32x32x16_bf16 v[112:127], v[140:143], a[88:91], v[112:127]
  ds_read_b128 v[140:143], v3 offset:35840
  s_waitcnt vmcnt(8) lgkmcnt(7)
  v_mfma_f32_32x32x16_bf16 v[64:79], v[144:147], a[92:95], v[64:79]
  ds_read_b128 v[144:147], v3 offset:36864
  s_waitcnt lgkmcnt(7)
  v_mfma_f32_32x32x16_bf16 v[80:95], v[148:151], a[92:95], v[80:95]
  ds_read_b128 v[148:151], v3 offset:37888
  s_waitcnt lgkmcnt(7)
  v_mfma_f32_32x32x16_bf16 v[96:111], v[152:155], a[92:95], v[96:111]
  ds_read_b128 v[152:155], v3 offset:38912
  s_waitcnt lgkmcnt(7)
  v_mfma_f32_32x32x16_bf16 v[112:127], v[156:159], a[92:95], v[112:127]
  ds_read_b128 v[156:159], v3 offset:39936
  s_waitcnt vmcnt(7) lgkmcnt(7)
  v_mfma_f32_32x32x16_bf16 v[64:79], v[128:131], a[96:99], v[64:79]
  ds_read_b128 v[128:131], v3 offset:40960
  s_waitcnt lgkmcnt(7)
  v_mfma_f32_32x32x16_bf16 v[80:95], v[132:135], a[96:99], v[80:95]
  ds_read_b128 v[132:135], v3 offset:41984
  s_waitcnt lgkmcnt(7)
  v_mfma_f32_32x32x16_bf16 v[96:111], v[136:139], a[96:99], v[96:111]
  ds_read_b128 v[136:139], v3 offset:43008
  s_waitcnt lgkmcnt(7)
  v_mfma_f32_32x32x16_bf16 v[112:127], v[140:143], a[96:99], v[112:127]
  ds_read_b128 v[140:143], v3 offset:44032
  s_waitcnt vmcnt(6) lgkmcnt(7)
  v_mfma_f32_32x32x16_bf16 v[64:79], v[144:147], a[100:103], v[64:79]
  ds_read_b128 v[144:147], v3 offset:45056
  s_waitcnt lgkmcnt(7)
  v_mfma_f32_32x32x16_bf16 v[80:95], v[148:151], a[100:103], v[80:95]
  ds_read_b128 v[148:151], v3 offset:46080
  s_waitcnt lgkmcnt(7)
  v_mfma_f32_32x32x16_bf16 v[96:111], v[152:155], a[100:103], v[96:111]
  ds_read_b128 v[152:155], v3 offset:47104
  s_waitcnt lgkmcnt(7)
  v_mfma_f32_32x32x16_bf16 v[112:127], v[156:159], a[100:103], v[112:127]
  ds_read_b128 v[156:159], v3 offset:48128
  s_waitcnt vmcnt(5) lgkmcnt(7)
  v_mfma_f32_32x32x16_bf16 v[64:79], v[128:131], a[104:107], v[64:79]
  ds_read_b128 v[128:131], v3 offset:49152
  s_waitcnt lgkmcnt(7)
  v_mfma_f32_32x32x16_bf16 v[80:95], v[132:135], a[104:107], v[80:95]
  ds_read_b128 v[132:135], v3 offset:50176
  s_waitcnt lgkmcnt(7)
  v_mfma_f32_32x32x16_bf16 v[96:111], v[136:139], a[104:107], v[96:111]
  ds_read_b128 v[136:139], v3 offset:51200
  s_waitcnt lgkmcnt(7)
  v_mfma_f32_32x32x16_bf16 v[112:127], v[140:143], a[104:107], v[112:127]
  ds_read_b128 v[140:143], v3 offset:52224
  s_waitcnt vmcnt(4) lgkmcnt(7)
  v_mfma_f32_32x32x16_bf16 v[64:79], v[144:147], a[108:111], v[64:79]
  ds_read_b128 v[144:147], v3 offset:53248
  s_waitcnt lgkmcnt(7)
  v_mfma_f32_32x32x16_bf16 v[80:95], v[148:151], a[108:111], v[80:95]
  ds_read_b128 v[148:151], v3 offset:54272
  s_waitcnt lgkmcnt(7)
  v_mfma_f32_32x32x16_bf16 v[96:111], v[152:155], a[108:111], v[96:111]
  ds_read_b128 v[152:155], v3 offset:55296
  s_waitcnt lgkmcnt(7)
  v_mfma_f32_32x32x16_bf16 v[112:127], v[156:159], a[108:111], v[112:127]
  ds_read_b128 v[156:159], v3 offset:56320
  s_waitcnt vmcnt(3) lgkmcnt(7)
  v_mfma_f32_32x32x16_bf16 v[64:79], v[128:131], a[112:115], v[64:79]
  ds_read_b128 v[128:131], v3 offset:57344
  s_waitcnt lgkmcnt(7)
  v_mfma_f32_32x32x16_bf16 v[80:95], v[132:135], a[112:115], v[80:95]
  ds_read_b128 v[132:135], v3 offset:58368
  s_waitcnt lgkmcnt(7)
  v_mfma_f32_32x32x16_bf16 v[96:111], v[136:139], a[112:115], v[96:111]
  ds_read_b128 v[136:139], v3 offset:59392
  s_waitcnt lgkmcnt(7)
  v_mfma_f32_32x32x16_bf16 v[112:127], v[140:143], a[112:115], v[112:127]
  ds_read_b128 v[140:143], v3 offset:60416
  s_waitcnt vmcnt(2) lgkmcnt(7)
  v_mfma_f32_32x32x16_bf16 v[64:79], v[144:147], a[116:119], v[64:79]
  ds_read_b128 v[144:147], v3 offset:61440
  s_waitcnt lgkmcnt(7)
  v_mfma_f32_32x32x16_bf16 v[80:95], v[148:151], a[116:119], v[80:95]
  ds_read_b128 v[148:151], v3 offset:62464
  s_waitcnt lgkmcnt(7)
  v_mfma_f32_32x32x16_bf16 v[96:111], v[152:155], a[116:119], v[96:111]
  ds_read_b128 v[152:155], v3 offset:63488
  s_waitcnt lgkmcnt(7)
  v_mfma_f32_32x32x16_bf16 v[112:127], v[156:159], a[116:119], v[112:127]
  ds_read_b128 v[156:159], v3 offset:64512
  s_waitcnt vmcnt(1) lgkmcnt(7)
  v_mfma_f32_32x32x16_bf16 v[64:79], v[128:131], a[120:123], v[64:79]
  s_waitcnt lgkmcnt(6)
  v_mfma_f32_32x32x16_bf16 v[80:95], v[132:135], a[120:123], v[80:95]
  s_waitcnt lgkmcnt(5)
  v_mfma_f32_32x32x16_bf16 v[96:111], v[136:139], a[120:123], v[96:111]
  s_waitcnt lgkmcnt(4)
  v_mfma_f32_32x32x16_bf16 v[112:127], v[140:143], a[120:123], v[112:127]
  s_waitcnt vmcnt(0) lgkmcnt(3)
  v_mfma_f32_32x32x16_bf16 v[64:79], v[144:147], a[124:127], v[64:79]
  s_waitcnt lgkmcnt(2)
  v_mfma_f32_32x32x16_bf16 v[80:95], v[148:151], a[124:127], v[80:95]
  s_waitcnt lgkmcnt(1)
  v_mfma_f32_32x32x16_bf16 v[96:111], v[152:155], a[124:127], v[96:111]
  s_waitcnt lgkmcnt(0)
  v_mfma_f32_32x32x16_bf16 v[112:127], v[156:159], a[124:127], v[112:127]
  s_nop 15
  v_cvt_pk_bf16_f32 v160, v64, v65
  v_cvt_pk_bf16_f32 v161, v66, v67
  v_cvt_pk_bf16_f32 v162, v68, v69
  v_cvt_pk_bf16_f32 v163, v70, v71
  v_cvt_pk_bf16_f32 v164, v72, v73
  v_cvt_pk_bf16_f32 v165, v74, v75
  v_cvt_pk_bf16_f32 v166, v76, v77
  v_cvt_pk_bf16_f32 v167, v78, v79
  v_cvt_pk_bf16_f32 v168, v80, v81
  v_cvt_pk_bf16_f32 v169, v82, v83
  v_cvt_pk_bf16_f32 v170, v84, v85
  v_cvt_pk_bf16_f32 v171, v86, v87
  v_cvt_pk_bf16_f32 v172, v88, v89
  v_cvt_pk_bf16_f32 v173, v90, v91
  v_cvt_pk_bf16_f32 v174, v92, v93
  v_cvt_pk_bf16_f32 v175, v94, v95
  v_cvt_pk_bf16_f32 v176, v96, v97
  v_cvt_pk_bf16_f32 v177, v98, v99
  v_cvt_pk_bf16_f32 v178, v100, v101
  v_cvt_pk_bf16_f32 v179, v102, v103
  v_cvt_pk_bf16_f32 v180, v104, v105
  v_cvt_pk_bf16_f32 v181, v106, v107
  v_cvt_pk_bf16_f32 v182, v108, v109
  v_cvt_pk_bf16_f32 v183, v110, v111
  v_cvt_pk_bf16_f32 v184, v112, v113
  v_cvt_pk_bf16_f32 v185, v114, v115
  v_cvt_pk_bf16_f32 v186, v116, v117
  v_cvt_pk_bf16_f32 v187, v118, v119
  v_cvt_pk_bf16_f32 v188, v120, v121
  v_cvt_pk_bf16_f32 v189, v122, v123
  v_cvt_pk_bf16_f32 v190, v124, v125
  v_cvt_pk_bf16_f32 v191, v126, v127
  s_lshl_b32 s61, s49, 6
  s_add_u32 s61, s61, s51
  s_lshl_b32 s61, s61, 13
  s_add_u32 s61, s61, 16777216
  buffer_store_dwordx4 v[160:163], v2, s[32:35], s61 offen offset:0 sc1
  buffer_store_dwordx4 v[164:167], v2, s[32:35], s61 offen offset:1024 sc1
  buffer_store_dwordx4 v[168:171], v2, s[32:35], s61 offen offset:2048 sc1
  buffer_store_dwordx4 v[172:175], v2, s[32:35], s61 offen offset:3072 sc1
  s_add_u32 s61, s61, 4096
  buffer_store_dwordx4 v[176:179], v2, s[32:35], s61 offen offset:0 sc1
  buffer_store_dwordx4 v[180:183], v2, s[32:35], s61 offen offset:1024 sc1
  buffer_store_dwordx4 v[184:187], v2, s[32:35], s61 offen offset:2048 sc1
  buffer_store_dwordx4 v[188:191], v2, s[32:35], s61 offen offset:3072 sc1
  s_lshl_b32 s56, s48, 2
  s_lshl_b32 s57, s49, 7
  s_add_u32 s56, s56, s57
  s_add_u32 s56, s56, 0
  s_lshr_b32 s57, s51, 2
  s_add_u32 s57, s57, 1
  s_waitcnt vmcnt(0)
  s_cmp_eq_u32 s50, 0
  s_cbranch_scc1 Lsig_20
  v_mov_b32 v4, s57
  v_mov_b32 v5, 0
  s_mov_b64 exec, 1
  buffer_store_dword v4, v5, s[32:35], s56 offen sc1
  s_mov_b64 exec, -1
Lsig_20:
  s_add_u32 s51, s51, 4
  s_cmp_lt_u32 s51, 64
  s_cbranch_scc1 LOOP_K
  s_waitcnt vmcnt(0)
  s_endpgm
ROLE_V:
  s_mov_b32 s36, s12
  s_mov_b32 s37, s13
  s_mov_b32 s38, 4194304
  s_mov_b32 s39, 0x00020000
  s_lshl_b32 s62, s49, 8
  v_and_b32 v7, 15, v1
  v_lshlrev_b32 v4, 4, v7
  v_lshrrev_b32 v7, 5, v1
  v_mul_u32_u24 v8, 131072, v7
  v_add_u32 v4, v4, v8
  v_bfe_u32 v9, v1, 4, 1
  v_mul_u32_u24 v8, 32768, v9
  v_add_u32 v4, v4, v8
  v_lshlrev_b32 v5, 12, v7
  v_lshl_add_u32 v5, v9, 9, v5
  v_bfe_u32 v8, v1, 2, 2
  v_lshl_add_u32 v5, v8, 10, v5
  v_and_b32 v8, 3, v1
  v_lshl_add_u32 v5, v8, 7, v5
  s_lshl_b32 s52, s48, 13
  v_add_u32 v5, s52, v5
  v_add_u32 v6, 0x10000, v5
  s_mul_i32 s52, s48, 262144
  s_add_u32 s52, s52, s62
  s_add_u32 s53, s52, 0
  buffer_load_dwordx4 v[16:19], v4, s[36:39], s53 offen
  s_add_u32 s53, s52, 8192
  buffer_load_dwordx4 v[20:23], v4, s[36:39], s53 offen
  s_add_u32 s53, s52, 16384
  buffer_load_dwordx4 v[24:27], v4, s[36:39], s53 offen
  s_add_u32 s53, s52, 24576
  buffer_load_dwordx4 v[28:31], v4, s[36:39], s53 offen
  s_add_u32 s53, s52, 65536
  buffer_load_dwordx4 v[32:35], v4, s[36:39], s53 offen
  s_add_u32 s53, s52, 73728
  buffer_load_dwordx4 v[36:39], v4, s[36:39], s53 offen
  s_add_u32 s53, s52, 81920
  buffer_load_dwordx4 v[40:43], v4, s[36:39], s53 offen
  s_add_u32 s53, s52, 90112
  buffer_load_dwordx4 v[44:47], v4, s[36:39], s53 offen
  s_add_u32 s53, s52, 1048576
  buffer_load_dwordx4 v[48:51], v4, s[36:39], s53 offen
  s_add_u32 s53, s52, 1056768
  buffer_load_dwordx4 v[52:55], v4, s[36:39], s53 offen
  s_add_u32 s53, s52, 1064960
  buffer_load_dwordx4 v[56:59], v4, s[36:39], s53 offen
  s_add_u32 s53, s52, 1073152
  buffer_load_dwordx4 v[60:63], v4, s[36:39], s53 offen
  s_add_u32 s53, s52, 1114112
  buffer_load_dwordx4 v[64:67], v4, s[36:39], s53 offen
  s_add_u32 s53, s52, 1122304
  buffer_load_dwordx4 v[68:71], v4, s[36:39], s53 offen
  s_add_u32 s53, s52, 1130496
  buffer_load_dwordx4 v[72:75], v4, s[36:39], s53 offen
  s_add_u32 s53, s52, 1138688
  buffer_load_dwordx4 v[76:79], v4, s[36:39], s53 offen
  s_add_u32 s53, s52, 2097152
  buffer_load_dwordx4 v[80:83], v4, s[36:39], s53 offen
  s_add_u32 s53, s52, 2105344
  buffer_load_dwordx4 v[84:87], v4, s[36:39], s53 offen
  s_add_u32 s53, s52, 2113536
  buffer_load_dwordx4 v[88:91], v4, s[36:39], s53 offen
  s_add_u32 s53, s52, 2121728
  buffer_load_dwordx4 v[92:95], v4, s[36:39], s53 offen
  s_add_u32 s53, s52, 2162688
  buffer_load_dwordx4 v[96:99], v4, s[36:39], s53 offen
  s_add_u32 s53, s52, 2170880
  buffer_load_dwordx4 v[100:103], v4, s[36:39], s53 offen
  s_add_u32 s53, s52, 2179072
  buffer_load_dwordx4 v[104:107], v4, s[36:39], s53 offen
  s_add_u32 s53, s52, 2187264
  buffer_load_dwordx4 v[108:111], v4, s[36:39], s53 offen
  s_add_u32 s53, s52, 3145728
  buffer_load_dwordx4 v[112:115], v4, s[36:39], s53 offen
  s_add_u32 s53, s52, 3153920
  buffer_load_dwordx4 v[116:119], v4, s[36:39], s53 offen
  s_add_u32 s53, s52, 3162112
  buffer_load_dwordx4 v[120:123], v4, s[36:39], s53 offen
  s_add_u32 s53, s52, 3170304
  buffer_load_dwordx4 v[124:127], v4, s[36:39], s53 offen
  s_add_u32 s53, s52, 3211264
  buffer_load_dwordx4 v[128:131], v4, s[36:39], s53 offen
  s_add_u32 s53, s52, 3219456
  buffer_load_dwordx4 v[132:135], v4, s[36:39], s53 offen
  s_add_u32 s53, s52, 3227648
  buffer_load_dwordx4 v[136:139], v4, s[36:39], s53 offen
  s_add_u32 s53, s52, 3235840
  buffer_load_dwordx4 v[140:143], v4, s[36:39], s53 offen
Lwl_skip_21:
  s_waitcnt vmcnt(0)
  v_perm_b32 v144, v20, v16, s64
  v_perm_b32 v145, v28, v24, s64
  v_perm_b32 v146, v36, v32, s64
  v_perm_b32 v147, v44, v40, s64
  ds_write_b128 v5, v[144:147] offset:0
  v_perm_b32 v148, v20, v16, s65
  v_perm_b32 v149, v28, v24, s65
  v_perm_b32 v150, v36, v32, s65
  v_perm_b32 v151, v44, v40, s65
  ds_write_b128 v5, v[148:151] offset:16
  v_perm_b32 v152, v21, v17, s64
  v_perm_b32 v153, v29, v25, s64
  v_perm_b32 v154, v37, v33, s64
  v_perm_b32 v155, v45, v41, s64
  ds_write_b128 v5, v[152:155] offset:32
  v_perm_b32 v156, v21, v17, s65
  v_perm_b32 v157, v29, v25, s65
  v_perm_b32 v158, v37, v33, s65
  v_perm_b32 v159, v45, v41, s65
  ds_write_b128 v5, v[156:159] offset:48
  s_waitcnt lgkmcnt(0)
  v_perm_b32 v144, v22, v18, s64
  v_perm_b32 v145, v30, v26, s64
  v_perm_b32 v146, v38, v34, s64
  v_perm_b32 v147, v46, v42, s64
  ds_write_b128 v5, v[144:147] offset:64
  v_perm_b32 v148, v22, v18, s65
  v_perm_b32 v149, v30, v26, s65
  v_perm_b32 v150, v38, v34, s65
  v_perm_b32 v151, v46, v42, s65
  ds_write_b128 v5, v[148:151] offset:80
  v_perm_b32 v152, v23, v19, s64
  v_perm_b32 v153, v31, v27, s64
  v_perm_b32 v154, v39, v35, s64
  v_perm_b32 v155, v47, v43, s64
  ds_write_b128 v5, v[152:155] offset:96
  v_perm_b32 v156, v23, v19, s65
  v_perm_b32 v157, v31, v27, s65
  v_perm_b32 v158, v39, v35, s65
  v_perm_b32 v159, v47, v43, s65
  ds_write_b128 v5, v[156:159] offset:112
  s_waitcnt lgkmcnt(0)
  v_perm_b32 v144, v52, v48, s64
  v_perm_b32 v145, v60, v56, s64
  v_perm_b32 v146, v68, v64, s64
  v_perm_b32 v147, v76, v72, s64
  ds_write_b128 v5, v[144:147] offset:32768
  v_perm_b32 v148, v52, v48, s65
  v_perm_b32 v149, v60, v56, s65
  v_perm_b32 v150, v68, v64, s65
  v_perm_b32 v151, v76, v72, s65
  ds_write_b128 v5, v[148:151] offset:32784
  v_perm_b32 v152, v53, v49, s64
  v_perm_b32 v153, v61, v57, s64
  v_perm_b32 v154, v69, v65, s64
  v_perm_b32 v155, v77, v73, s64
  ds_write_b128 v5, v[152:155] offset:32800
  v_perm_b32 v156, v53, v49, s65
  v_perm_b32 v157, v61, v57, s65
  v_perm_b32 v158, v69, v65, s65
  v_perm_b32 v159, v77, v73, s65
  ds_write_b128 v5, v[156:159] offset:32816
  s_waitcnt lgkmcnt(0)
  v_perm_b32 v144, v54, v50, s64
  v_perm_b32 v145, v62, v58, s64
  v_perm_b32 v146, v70, v66, s64
  v_perm_b32 v147, v78, v74, s64
  ds_write_b128 v5, v[144:147] offset:32832
  v_perm_b32 v148, v54, v50, s65
  v_perm_b32 v149, v62, v58, s65
  v_perm_b32 v150, v70, v66, s65
  v_perm_b32 v151, v78, v74, s65
  ds_write_b128 v5, v[148:151] offset:32848
  v_perm_b32 v152, v55, v51, s64
  v_perm_b32 v153, v63, v59, s64
  v_perm_b32 v154, v71, v67, s64
  v_perm_b32 v155, v79, v75, s64
  ds_write_b128 v5, v[152:155] offset:32864
  v_perm_b32 v156, v55, v51, s65
  v_perm_b32 v157, v63, v59, s65
  v_perm_b32 v158, v71, v67, s65
  v_perm_b32 v159, v79, v75, s65
  ds_write_b128 v5, v[156:159] offset:32880
  s_waitcnt lgkmcnt(0)
  v_perm_b32 v144, v84, v80, s64
  v_perm_b32 v145, v92, v88, s64
  v_perm_b32 v146, v100, v96, s64
  v_perm_b32 v147, v108, v104, s64
  ds_write_b128 v6, v[144:147] offset:0
  v_perm_b32 v148, v84, v80, s65
  v_perm_b32 v149, v92, v88, s65
  v_perm_b32 v150, v100, v96, s65
  v_perm_b32 v151, v108, v104, s65
  ds_write_b128 v6, v[148:151] offset:16
  v_perm_b32 v152, v85, v81, s64
  v_perm_b32 v153, v93, v89, s64
  v_perm_b32 v154, v101, v97, s64
  v_perm_b32 v155, v109, v105, s64
  ds_write_b128 v6, v[152:155] offset:32
  v_perm_b32 v156, v85, v81, s65
  v_perm_b32 v157, v93, v89, s65
  v_perm_b32 v158, v101, v97, s65
  v_perm_b32 v159, v109, v105, s65
  ds_write_b128 v6, v[156:159] offset:48
  s_waitcnt lgkmcnt(0)
  v_perm_b32 v144, v86, v82, s64
  v_perm_b32 v145, v94, v90, s64
  v_perm_b32 v146, v102, v98, s64
  v_perm_b32 v147, v110, v106, s64
  ds_write_b128 v6, v[144:147] offset:64
  v_perm_b32 v148, v86, v82, s65
  v_perm_b32 v149, v94, v90, s65
  v_perm_b32 v150, v102, v98, s65
  v_perm_b32 v151, v110, v106, s65
  ds_write_b128 v6, v[148:151] offset:80
  v_perm_b32 v152, v87, v83, s64
  v_perm_b32 v153, v95, v91, s64
  v_perm_b32 v154, v103, v99, s64
  v_perm_b32 v155, v111, v107, s64
  ds_write_b128 v6, v[152:155] offset:96
  v_perm_b32 v156, v87, v83, s65
  v_perm_b32 v157, v95, v91, s65
  v_perm_b32 v158, v103, v99, s65
  v_perm_b32 v159, v111, v107, s65
  ds_write_b128 v6, v[156:159] offset:112
  s_waitcnt lgkmcnt(0)
  v_perm_b32 v144, v116, v112, s64
  v_perm_b32 v145, v124, v120, s64
  v_perm_b32 v146, v132, v128, s64
  v_perm_b32 v147, v140, v136, s64
  ds_write_b128 v6, v[144:147] offset:32768
  v_perm_b32 v148, v116, v112, s65
  v_perm_b32 v149, v124, v120, s65
  v_perm_b32 v150, v132, v128, s65
  v_perm_b32 v151, v140, v136, s65
  ds_write_b128 v6, v[148:151] offset:32784
  v_perm_b32 v152, v117, v113, s64
  v_perm_b32 v153, v125, v121, s64
  v_perm_b32 v154, v133, v129, s64
  v_perm_b32 v155, v141, v137, s64
  ds_write_b128 v6, v[152:155] offset:32800
  v_perm_b32 v156, v117, v113, s65
  v_perm_b32 v157, v125, v121, s65
  v_perm_b32 v158, v133, v129, s65
  v_perm_b32 v159, v141, v137, s65
  ds_write_b128 v6, v[156:159] offset:32816
  s_waitcnt lgkmcnt(0)
  v_perm_b32 v144, v118, v114, s64
  v_perm_b32 v145, v126, v122, s64
  v_perm_b32 v146, v134, v130, s64
  v_perm_b32 v147, v142, v138, s64
  ds_write_b128 v6, v[144:147] offset:32832
  v_perm_b32 v148, v118, v114, s65
  v_perm_b32 v149, v126, v122, s65
  v_perm_b32 v150, v134, v130, s65
  v_perm_b32 v151, v142, v138, s65
  ds_write_b128 v6, v[148:151] offset:32848
  v_perm_b32 v152, v119, v115, s64
  v_perm_b32 v153, v127, v123, s64
  v_perm_b32 v154, v135, v131, s64
  v_perm_b32 v155, v143, v139, s64
  ds_write_b128 v6, v[152:155] offset:32864
  v_perm_b32 v156, v119, v115, s65
  v_perm_b32 v157, v127, v123, s65
  v_perm_b32 v158, v135, v131, s65
  v_perm_b32 v159, v143, v139, s65
  ds_write_b128 v6, v[156:159] offset:32880
  s_waitcnt lgkmcnt(0)
Lwl_skip2_22:
  s_cmp_lg_u32 s48, 0
  s_cbranch_scc1 Lwi_23
  v_mov_b32 v4, 0
  s_mov_b32 s56, 128
  s_mov_b32 s57, 47
  s_cmp_eq_u32 s50, 0
  s_cbranch_scc1 Lwaitd_25
  s_mov_b32 s52, 0
  s_mov_b32 s54, 1
  s_mov_b32 s55, 0
Lwait_24:
  buffer_load_dword v5, v4, s[44:47], s56 offen sc1
  s_add_u32 s52, s52, 1
  s_cmp_gt_u32 s52, 65536
  s_cbranch_scc1 Lwaitd_25
  s_waitcnt vmcnt(0)
  v_cmp_gt_u32 vcc, v5, s57
  s_and_b64 vcc, vcc, s[54:55]
  s_cmp_eq_u64 vcc, s[54:55]
  s_cbranch_scc1 Lwaitd_25
  s_sleep 2
  s_branch Lwait_24
Lwaitd_25:
  s_waitcnt vmcnt(0)
Lwi_23:
  s_waitcnt lgkmcnt(0)
  s_barrier
  v_add_u32 v3, 0x10000, v2
  s_mov_b32 s51, s48
LOOP_V:
  s_lshl_b32 s56, s51, 8
  s_add_u32 s56, s56, 32768
  s_mov_b32 s57, 0
  v_min_u32 v4, 3, v1
  v_lshlrev_b32 v4, 6, v4
  s_cmp_eq_u32 s50, 0
  s_cbranch_scc1 Lwaitd_27
  s_mov_b32 s52, 0
  s_mov_b32 s54, 15
  s_mov_b32 s55, 0
Lwait_26:
  buffer_load_dword v5, v4, s[32:35], s56 offen sc1
  s_add_u32 s52, s52, 1
  s_cmp_gt_u32 s52, 65536
  s_cbranch_scc1 Lwaitd_27
  s_waitcnt vmcnt(0)
  v_cmp_gt_u32 vcc, v5, s57
  s_and_b64 vcc, vcc, s[54:55]
  s_cmp_eq_u64 vcc, s[54:55]
  s_cbranch_scc1 Lwaitd_27
  s_sleep 2
  s_branch Lwait_26
Lwaitd_27:
  s_waitcnt vmcnt(0)
  s_lshl_b32 s60, s51, 15
  s_add_u32 s60, s60, 1048576
  buffer_load_dwordx4 a[0:3], v2, s[32:35], s60 offen offset:0 sc1
  buffer_load_dwordx4 a[4:7], v2, s[32:35], s60 offen offset:1024 sc1
  buffer_load_dwordx4 a[8:11], v2, s[32:35], s60 offen offset:2048 sc1
  buffer_load_dwordx4 a[12:15], v2, s[32:35], s60 offen offset:3072 sc1
  s_add_u32 s60, s60, 4096
  buffer_load_dwordx4 a[16:19], v2, s[32:35], s60 offen offset:0 sc1
  buffer_load_dwordx4 a[20:23], v2, s[32:35], s60 offen offset:1024 sc1
  buffer_load_dwordx4 a[24:27], v2, s[32:35], s60 offen offset:2048 sc1
  buffer_load_dwordx4 a[28:31], v2, s[32:35], s60 offen offset:3072 sc1
  s_add_u32 s60, s60, 4096
  buffer_load_dwordx4 a[32:35], v2, s[32:35], s60 offen offset:0 sc1
  buffer_load_dwordx4 a[36:39], v2, s[32:35], s60 offen offset:1024 sc1
  buffer_load_dwordx4 a[40:43], v2, s[32:35], s60 offen offset:2048 sc1
  buffer_load_dwordx4 a[44:47], v2, s[32:35], s60 offen offset:3072 sc1
  s_add_u32 s60, s60, 4096
  buffer_load_dwordx4 a[48:51], v2, s[32:35], s60 offen offset:0 sc1
  buffer_load_dwordx4 a[52:55], v2, s[32:35], s60 offen offset:1024 sc1
  buffer_load_dwordx4 a[56:59], v2, s[32:35], s60 offen offset:2048 sc1
  buffer_load_dwordx4 a[60:63], v2, s[32:35], s60 offen offset:3072 sc1
  s_add_u32 s60, s60, 4096
  buffer_load_dwordx4 a[64:67], v2, s[32:35], s60 offen offset:0 sc1
  buffer_load_dwordx4 a[68:71], v2, s[32:35], s60 offen offset:1024 sc1
  buffer_load_dwordx4 a[72:75], v2, s[32:35], s60 offen offset:2048 sc1
  buffer_load_dwordx4 a[76:79], v2, s[32:35], s60 offen offset:3072 sc1
  s_add_u32 s60, s60, 4096
  buffer_load_dwordx4 a[80:83], v2, s[32:35], s60 offen offset:0 sc1
  buffer_load_dwordx4 a[84:87], v2, s[32:35], s60 offen offset:1024 sc1
  buffer_load_dwordx4 a[88:91], v2, s[32:35], s60 offen offset:2048 sc1
  buffer_load_dwordx4 a[92:95], v2, s[32:35], s60 offen offset:3072 sc1
  s_add_u32 s60, s60, 4096
  buffer_load_dwordx4 a[96:99], v2, s[32:35], s60 offen offset:0 sc1
  buffer_load_dwordx4 a[100:103], v2, s[32:35], s60 offen offset:1024 sc1
  buffer_load_dwordx4 a[104:107], v2, s[32:35], s60 offen offset:2048 sc1
  buffer_load_dwordx4 a[108:111], v2, s[32:35], s60 offen offset:3072 sc1
  s_add_u32 s60, s60, 4096
  buffer_load_dwordx4 a[112:115], v2, s[32:35], s60 offen offset:0 sc1
  buffer_load_dwordx4 a[116:119], v2, s[32:35], s60 offen offset:1024 sc1
  buffer_load_dwordx4 a[120:123], v2, s[32:35], s60 offen offset:2048 sc1
  buffer_load_dwordx4 a[124:127], v2, s[32:35], s60 offen offset:3072 sc1
  ds_read_b128 v[128:131], v2 offset:0
  ds_read_b128 v[132:135], v2 offset:1024
  ds_read_b128 v[136:139], v2 offset:2048
  ds_read_b128 v[140:143], v2 offset:3072
  ds_read_b128 v[144:147], v2 offset:4096
  ds_read_b128 v[148:151], v2 offset:5120
  ds_read_b128 v[152:155], v2 offset:6144
  ds_read_b128 v[156:159], v2 offset:7168
  s_waitcnt vmcnt(31) lgkmcnt(7)
  v_mfma_f32_32x32x16_bf16 v[64:79], a[0:3], v[128:131], 0
  ds_read_b128 v[128:131], v2 offset:8192
  s_waitcnt lgkmcnt(7)
  v_mfma_f32_32x32x16_bf16 v[80:95], a[0:3], v[132:135], 0
  ds_read_b128 v[132:135], v2 offset:9216
  s_waitcnt lgkmcnt(7)
  v_mfma_f32_32x32x16_bf16 v[96:111], a[0:3], v[136:139], 0
  ds_read_b128 v[136:139], v2 offset:10240
  s_waitcnt lgkmcnt(7)
  v_mfma_f32_32x32x16_bf16 v[112:127], a[0:3], v[140:143], 0
  ds_read_b128 v[140:143], v2 offset:11264
  s_waitcnt vmcnt(30) lgkmcnt(7)
  v_mfma_f32_32x32x16_bf16 v[64:79], a[4:7], v[144:147], v[64:79]
  ds_read_b128 v[144:147], v2 offset:12288
  s_waitcnt lgkmcnt(7)
  v_mfma_f32_32x32x16_bf16 v[80:95], a[4:7], v[148:151], v[80:95]
  ds_read_b128 v[148:151], v2 offset:13312
  s_waitcnt lgkmcnt(7)
  v_mfma_f32_32x32x16_bf16 v[96:111], a[4:7], v[152:155], v[96:111]
  ds_read_b128 v[152:155], v2 offset:14336
  s_waitcnt lgkmcnt(7)
  v_mfma_f32_32x32x16_bf16 v[112:127], a[4:7], v[156:159], v[112:127]
  ds_read_b128 v[156:159], v2 offset:15360
  s_waitcnt vmcnt(29) lgkmcnt(7)
  v_mfma_f32_32x32x16_bf16 v[64:79], a[8:11], v[128:131], v[64:79]
  ds_read_b128 v[128:131], v2 offset:16384
  s_waitcnt lgkmcnt(7)
  v_mfma_f32_32x32x16_bf16 v[80:95], a[8:11], v[132:135], v[80:95]
  ds_read_b128 v[132:135], v2 offset:17408
  s_waitcnt lgkmcnt(7)
  v_mfma_f32_32x32x16_bf16 v[96:111], a[8:11], v[136:139], v[96:111]
  ds_read_b128 v[136:139], v2 offset:18432
  s_waitcnt lgkmcnt(7)
  v_mfma_f32_32x32x16_bf16 v[112:127], a[8:11], v[140:143], v[112:127]
  ds_read_b128 v[140:143], v2 offset:19456
  s_waitcnt vmcnt(28) lgkmcnt(7)
  v_mfma_f32_32x32x16_bf16 v[64:79], a[12:15], v[144:147], v[64:79]
  ds_read_b128 v[144:147], v2 offset:20480
  s_waitcnt lgkmcnt(7)
  v_mfma_f32_32x32x16_bf16 v[80:95], a[12:15], v[148:151], v[80:95]
  ds_read_b128 v[148:151], v2 offset:21504
  s_waitcnt lgkmcnt(7)
  v_mfma_f32_32x32x16_bf16 v[96:111], a[12:15], v[152:155], v[96:111]
  ds_read_b128 v[152:155], v2 offset:22528
  s_waitcnt lgkmcnt(7)
  v_mfma_f32_32x32x16_bf16 v[112:127], a[12:15], v[156:159], v[112:127]
  ds_read_b128 v[156:159], v2 offset:23552
  s_waitcnt vmcnt(27) lgkmcnt(7)
  v_mfma_f32_32x32x16_bf16 v[64:79], a[16:19], v[128:131], v[64:79]
  ds_read_b128 v[128:131], v2 offset:24576
  s_waitcnt lgkmcnt(7)
  v_mfma_f32_32x32x16_bf16 v[80:95], a[16:19], v[132:135], v[80:95]
  ds_read_b128 v[132:135], v2 offset:25600
  s_waitcnt lgkmcnt(7)
  v_mfma_f32_32x32x16_bf16 v[96:111], a[16:19], v[136:139], v[96:111]
  ds_read_b128 v[136:139], v2 offset:26624
  s_waitcnt lgkmcnt(7)
  v_mfma_f32_32x32x16_bf16 v[112:127], a[16:19], v[140:143], v[112:127]
  ds_read_b128 v[140:143], v2 offset:27648
  s_waitcnt vmcnt(26) lgkmcnt(7)
  v_mfma_f32_32x32x16_bf16 v[64:79], a[20:23], v[144:147], v[64:79]
  ds_read_b128 v[144:147], v2 offset:28672
  s_waitcnt lgkmcnt(7)
  v_mfma_f32_32x32x16_bf16 v[80:95], a[20:23], v[148:151], v[80:95]
  ds_read_b128 v[148:151], v2 offset:29696
  s_waitcnt lgkmcnt(7)
  v_mfma_f32_32x32x16_bf16 v[96:111], a[20:23], v[152:155], v[96:111]
  ds_read_b128 v[152:155], v2 offset:30720
  s_waitcnt lgkmcnt(7)
  v_mfma_f32_32x32x16_bf16 v[112:127], a[20:23], v[156:159], v[112:127]
  ds_read_b128 v[156:159], v2 offset:31744
  s_waitcnt vmcnt(25) lgkmcnt(7)
  v_mfma_f32_32x32x16_bf16 v[64:79], a[24:27], v[128:131], v[64:79]
  ds_read_b128 v[128:131], v2 offset:32768
  s_waitcnt lgkmcnt(7)
  v_mfma_f32_32x32x16_bf16 v[80:95], a[24:27], v[132:135], v[80:95]
  ds_read_b128 v[132:135], v2 offset:33792
  s_waitcnt lgkmcnt(7)
  v_mfma_f32_32x32x16_bf16 v[96:111], a[24:27], v[136:139], v[96:111]
  ds_read_b128 v[136:139], v2 offset:34816
  s_waitcnt lgkmcnt(7)
  v_mfma_f32_32x32x16_bf16 v[112:127], a[24:27], v[140:143], v[112:127]
  ds_read_b128 v[140:143], v2 offset:35840
  s_waitcnt vmcnt(24) lgkmcnt(7)
  v_mfma_f32_32x32x16_bf16 v[64:79], a[28:31], v[144:147], v[64:79]
  ds_read_b128 v[144:147], v2 offset:36864
  s_waitcnt lgkmcnt(7)
  v_mfma_f32_32x32x16_bf16 v[80:95], a[28:31], v[148:151], v[80:95]
  ds_read_b128 v[148:151], v2 offset:37888
  s_waitcnt lgkmcnt(7)
  v_mfma_f32_32x32x16_bf16 v[96:111], a[28:31], v[152:155], v[96:111]
  ds_read_b128 v[152:155], v2 offset:38912
  s_waitcnt lgkmcnt(7)
  v_mfma_f32_32x32x16_bf16 v[112:127], a[28:31], v[156:159], v[112:127]
  ds_read_b128 v[156:159], v2 offset:39936
  s_waitcnt vmcnt(23) lgkmcnt(7)
  v_mfma_f32_32x32x16_bf16 v[64:79], a[32:35], v[128:131], v[64:79]
  ds_read_b128 v[128:131], v2 offset:40960
  s_waitcnt lgkmcnt(7)
  v_mfma_f32_32x32x16_bf16 v[80:95], a[32:35], v[132:135], v[80:95]
  ds_read_b128 v[132:135], v2 offset:41984
  s_waitcnt lgkmcnt(7)
  v_mfma_f32_32x32x16_bf16 v[96:111], a[32:35], v[136:139], v[96:111]
  ds_read_b128 v[136:139], v2 offset:43008
  s_waitcnt lgkmcnt(7)
  v_mfma_f32_32x32x16_bf16 v[112:127], a[32:35], v[140:143], v[112:127]
  ds_read_b128 v[140:143], v2 offset:44032
  s_waitcnt vmcnt(22) lgkmcnt(7)
  v_mfma_f32_32x32x16_bf16 v[64:79], a[36:39], v[144:147], v[64:79]
  ds_read_b128 v[144:147], v2 offset:45056
  s_waitcnt lgkmcnt(7)
  v_mfma_f32_32x32x16_bf16 v[80:95], a[36:39], v[148:151], v[80:95]
  ds_read_b128 v[148:151], v2 offset:46080
  s_waitcnt lgkmcnt(7)
  v_mfma_f32_32x32x16_bf16 v[96:111], a[36:39], v[152:155], v[96:111]
  ds_read_b128 v[152:155], v2 offset:47104
  s_waitcnt lgkmcnt(7)
  v_mfma_f32_32x32x16_bf16 v[112:127], a[36:39], v[156:159], v[112:127]
  ds_read_b128 v[156:159], v2 offset:48128
  s_waitcnt vmcnt(21) lgkmcnt(7)
  v_mfma_f32_32x32x16_bf16 v[64:79], a[40:43], v[128:131], v[64:79]
  ds_read_b128 v[128:131], v2 offset:49152
  s_waitcnt lgkmcnt(7)
  v_mfma_f32_32x32x16_bf16 v[80:95], a[40:43], v[132:135], v[80:95]
  ds_read_b128 v[132:135], v2 offset:50176
  s_waitcnt lgkmcnt(7)
  v_mfma_f32_32x32x16_bf16 v[96:111], a[40:43], v[136:139], v[96:111]
  ds_read_b128 v[136:139], v2 offset:51200
  s_waitcnt lgkmcnt(7)
  v_mfma_f32_32x32x16_bf16 v[112:127], a[40:43], v[140:143], v[112:127]
  ds_read_b128 v[140:143], v2 offset:52224
  s_waitcnt vmcnt(20) lgkmcnt(7)
  v_mfma_f32_32x32x16_bf16 v[64:79], a[44:47], v[144:147], v[64:79]
  ds_read_b128 v[144:147], v2 offset:53248
  s_waitcnt lgkmcnt(7)
  v_mfma_f32_32x32x16_bf16 v[80:95], a[44:47], v[148:151], v[80:95]
  ds_read_b128 v[148:151], v2 offset:54272
  s_waitcnt lgkmcnt(7)
  v_mfma_f32_32x32x16_bf16 v[96:111], a[44:47], v[152:155], v[96:111]
  ds_read_b128 v[152:155], v2 offset:55296
  s_waitcnt lgkmcnt(7)
  v_mfma_f32_32x32x16_bf16 v[112:127], a[44:47], v[156:159], v[112:127]
  ds_read_b128 v[156:159], v2 offset:56320
  s_waitcnt vmcnt(19) lgkmcnt(7)
  v_mfma_f32_32x32x16_bf16 v[64:79], a[48:51], v[128:131], v[64:79]
  ds_read_b128 v[128:131], v2 offset:57344
  s_waitcnt lgkmcnt(7)
  v_mfma_f32_32x32x16_bf16 v[80:95], a[48:51], v[132:135], v[80:95]
  ds_read_b128 v[132:135], v2 offset:58368
  s_waitcnt lgkmcnt(7)
  v_mfma_f32_32x32x16_bf16 v[96:111], a[48:51], v[136:139], v[96:111]
  ds_read_b128 v[136:139], v2 offset:59392
  s_waitcnt lgkmcnt(7)
  v_mfma_f32_32x32x16_bf16 v[112:127], a[48:51], v[140:143], v[112:127]
  ds_read_b128 v[140:143], v2 offset:60416
  s_waitcnt vmcnt(18) lgkmcnt(7)
  v_mfma_f32_32x32x16_bf16 v[64:79], a[52:55], v[144:147], v[64:79]
  ds_read_b128 v[144:147], v2 offset:61440
  s_waitcnt lgkmcnt(7)
  v_mfma_f32_32x32x16_bf16 v[80:95], a[52:55], v[148:151], v[80:95]
  ds_read_b128 v[148:151], v2 offset:62464
  s_waitcnt lgkmcnt(7)
  v_mfma_f32_32x32x16_bf16 v[96:111], a[52:55], v[152:155], v[96:111]
  ds_read_b128 v[152:155], v2 offset:63488
  s_waitcnt lgkmcnt(7)
  v_mfma_f32_32x32x16_bf16 v[112:127], a[52:55], v[156:159], v[112:127]
  ds_read_b128 v[156:159], v2 offset:64512
  s_waitcnt vmcnt(17) lgkmcnt(7)
  v_mfma_f32_32x32x16_bf16 v[64:79], a[56:59], v[128:131], v[64:79]
  ds_read_b128 v[128:131], v3 offset:0
  s_waitcnt lgkmcnt(7)
  v_mfma_f32_32x32x16_bf16 v[80:95], a[56:59], v[132:135], v[80:95]
  ds_read_b128 v[132:135], v3 offset:1024
  s_waitcnt lgkmcnt(7)
  v_mfma_f32_32x32x16_bf16 v[96:111], a[56:59], v[136:139], v[96:111]
  ds_read_b128 v[136:139], v3 offset:2048
  s_waitcnt lgkmcnt(7)
  v_mfma_f32_32x32x16_bf16 v[112:127], a[56:59], v[140:143], v[112:127]
  ds_read_b128 v[140:143], v3 offset:3072
  s_waitcnt vmcnt(16) lgkmcnt(7)
  v_mfma_f32_32x32x16_bf16 v[64:79], a[60:63], v[144:147], v[64:79]
  ds_read_b128 v[144:147], v3 offset:4096
  s_waitcnt lgkmcnt(7)
  v_mfma_f32_32x32x16_bf16 v[80:95], a[60:63], v[148:151], v[80:95]
  ds_read_b128 v[148:151], v3 offset:5120
  s_waitcnt lgkmcnt(7)
  v_mfma_f32_32x32x16_bf16 v[96:111], a[60:63], v[152:155], v[96:111]
  ds_read_b128 v[152:155], v3 offset:6144
  s_waitcnt lgkmcnt(7)
  v_mfma_f32_32x32x16_bf16 v[112:127], a[60:63], v[156:159], v[112:127]
  ds_read_b128 v[156:159], v3 offset:7168
  s_waitcnt vmcnt(15) lgkmcnt(7)
  v_mfma_f32_32x32x16_bf16 v[64:79], a[64:67], v[128:131], v[64:79]
  ds_read_b128 v[128:131], v3 offset:8192
  s_waitcnt lgkmcnt(7)
  v_mfma_f32_32x32x16_bf16 v[80:95], a[64:67], v[132:135], v[80:95]
  ds_read_b128 v[132:135], v3 offset:9216
  s_waitcnt lgkmcnt(7)
  v_mfma_f32_32x32x16_bf16 v[96:111], a[64:67], v[136:139], v[96:111]
  ds_read_b128 v[136:139], v3 offset:10240
  s_waitcnt lgkmcnt(7)
  v_mfma_f32_32x32x16_bf16 v[112:127], a[64:67], v[140:143], v[112:127]
  ds_read_b128 v[140:143], v3 offset:11264
  s_waitcnt vmcnt(14) lgkmcnt(7)
  v_mfma_f32_32x32x16_bf16 v[64:79], a[68:71], v[144:147], v[64:79]
  ds_read_b128 v[144:147], v3 offset:12288
  s_waitcnt lgkmcnt(7)
  v_mfma_f32_32x32x16_bf16 v[80:95], a[68:71], v[148:151], v[80:95]
  ds_read_b128 v[148:151], v3 offset:13312
  s_waitcnt lgkmcnt(7)
  v_mfma_f32_32x32x16_bf16 v[96:111], a[68:71], v[152:155], v[96:111]
  ds_read_b128 v[152:155], v3 offset:14336
  s_waitcnt lgkmcnt(7)
  v_mfma_f32_32x32x16_bf16 v[112:127], a[68:71], v[156:159], v[112:127]
  ds_read_b128 v[156:159], v3 offset:15360
  s_waitcnt vmcnt(13) lgkmcnt(7)
  v_mfma_f32_32x32x16_bf16 v[64:79], a[72:75], v[128:131], v[64:79]
  ds_read_b128 v[128:131], v3 offset:16384
  s_waitcnt lgkmcnt(7)
  v_mfma_f32_32x32x16_bf16 v[80:95], a[72:75], v[132:135], v[80:95]
  ds_read_b128 v[132:135], v3 offset:17408
  s_waitcnt lgkmcnt(7)
  v_mfma_f32_32x32x16_bf16 v[96:111], a[72:75], v[136:139], v[96:111]
  ds_read_b128 v[136:139], v3 offset:18432
  s_waitcnt lgkmcnt(7)
  v_mfma_f32_32x32x16_bf16 v[112:127], a[72:75], v[140:143], v[112:127]
  ds_read_b128 v[140:143], v3 offset:19456
  s_waitcnt vmcnt(12) lgkmcnt(7)
  v_mfma_f32_32x32x16_bf16 v[64:79], a[76:79], v[144:147], v[64:79]
  ds_read_b128 v[144:147], v3 offset:20480
  s_waitcnt lgkmcnt(7)
  v_mfma_f32_32x32x16_bf16 v[80:95], a[76:79], v[148:151], v[80:95]
  ds_read_b128 v[148:151], v3 offset:21504
  s_waitcnt lgkmcnt(7)
  v_mfma_f32_32x32x16_bf16 v[96:111], a[76:79], v[152:155], v[96:111]
  ds_read_b128 v[152:155], v3 offset:22528
  s_waitcnt lgkmcnt(7)
  v_mfma_f32_32x32x16_bf16 v[112:127], a[76:79], v[156:159], v[112:127]
  ds_read_b128 v[156:159], v3 offset:23552
  s_waitcnt vmcnt(11) lgkmcnt(7)
  v_mfma_f32_32x32x16_bf16 v[64:79], a[80:83], v[128:131], v[64:79]
  ds_read_b128 v[128:131], v3 offset:24576
  s_waitcnt lgkmcnt(7)
  v_mfma_f32_32x32x16_bf16 v[80:95], a[80:83], v[132:135], v[80:95]
  ds_read_b128 v[132:135], v3 offset:25600
  s_waitcnt lgkmcnt(7)
  v_mfma_f32_32x32x16_bf16 v[96:111], a[80:83], v[136:139], v[96:111]
  ds_read_b128 v[136:139], v3 offset:26624
  s_waitcnt lgkmcnt(7)
  v_mfma_f32_32x32x16_bf16 v[112:127], a[80:83], v[140:143], v[112:127]
  ds_read_b128 v[140:143], v3 offset:27648
  s_waitcnt vmcnt(10) lgkmcnt(7)
  v_mfma_f32_32x32x16_bf16 v[64:79], a[84:87], v[144:147], v[64:79]
  ds_read_b128 v[144:147], v3 offset:28672
  s_waitcnt lgkmcnt(7)
  v_mfma_f32_32x32x16_bf16 v[80:95], a[84:87], v[148:151], v[80:95]
  ds_read_b128 v[148:151], v3 offset:29696
  s_waitcnt lgkmcnt(7)
  v_mfma_f32_32x32x16_bf16 v[96:111], a[84:87], v[152:155], v[96:111]
  ds_read_b128 v[152:155], v3 offset:30720
  s_waitcnt lgkmcnt(7)
  v_mfma_f32_32x32x16_bf16 v[112:127], a[84:87], v[156:159], v[112:127]
  ds_read_b128 v[156:159], v3 offset:31744
  s_waitcnt vmcnt(9) lgkmcnt(7)
  v_mfma_f32_32x32x16_bf16 v[64:79], a[88:91], v[128:131], v[64:79]
  ds_read_b128 v[128:131], v3 offset:32768
  s_waitcnt lgkmcnt(7)
  v_mfma_f32_32x32x16_bf16 v[80:95], a[88:91], v[132:135], v[80:95]
  ds_read_b128 v[132:135], v3 offset:33792
  s_waitcnt lgkmcnt(7)
  v_mfma_f32_32x32x16_bf16 v[96:111], a[88:91], v[136:139], v[96:111]
  ds_read_b128 v[136:139], v3 offset:34816
  s_waitcnt lgkmcnt(7)
  v_mfma_f32_32x32x16_bf16 v[112:127], a[88:91], v[140:143], v[112:127]
  ds_read_b128 v[140:143], v3 offset:35840
  s_waitcnt vmcnt(8) lgkmcnt(7)
  v_mfma_f32_32x32x16_bf16 v[64:79], a[92:95], v[144:147], v[64:79]
  ds_read_b128 v[144:147], v3 offset:36864
  s_waitcnt lgkmcnt(7)
  v_mfma_f32_32x32x16_bf16 v[80:95], a[92:95], v[148:151], v[80:95]
  ds_read_b128 v[148:151], v3 offset:37888
  s_waitcnt lgkmcnt(7)
  v_mfma_f32_32x32x16_bf16 v[96:111], a[92:95], v[152:155], v[96:111]
  ds_read_b128 v[152:155], v3 offset:38912
  s_waitcnt lgkmcnt(7)
  v_mfma_f32_32x32x16_bf16 v[112:127], a[92:95], v[156:159], v[112:127]
  ds_read_b128 v[156:159], v3 offset:39936
  s_waitcnt vmcnt(7) lgkmcnt(7)
  v_mfma_f32_32x32x16_bf16 v[64:79], a[96:99], v[128:131], v[64:79]
  ds_read_b128 v[128:131], v3 offset:40960
  s_waitcnt lgkmcnt(7)
  v_mfma_f32_32x32x16_bf16 v[80:95], a[96:99], v[132:135], v[80:95]
  ds_read_b128 v[132:135], v3 offset:41984
  s_waitcnt lgkmcnt(7)
  v_mfma_f32_32x32x16_bf16 v[96:111], a[96:99], v[136:139], v[96:111]
  ds_read_b128 v[136:139], v3 offset:43008
  s_waitcnt lgkmcnt(7)
  v_mfma_f32_32x32x16_bf16 v[112:127], a[96:99], v[140:143], v[112:127]
  ds_read_b128 v[140:143], v3 offset:44032
  s_waitcnt vmcnt(6) lgkmcnt(7)
  v_mfma_f32_32x32x16_bf16 v[64:79], a[100:103], v[144:147], v[64:79]
  ds_read_b128 v[144:147], v3 offset:45056
  s_waitcnt lgkmcnt(7)
  v_mfma_f32_32x32x16_bf16 v[80:95], a[100:103], v[148:151], v[80:95]
  ds_read_b128 v[148:151], v3 offset:46080
  s_waitcnt lgkmcnt(7)
  v_mfma_f32_32x32x16_bf16 v[96:111], a[100:103], v[152:155], v[96:111]
  ds_read_b128 v[152:155], v3 offset:47104
  s_waitcnt lgkmcnt(7)
  v_mfma_f32_32x32x16_bf16 v[112:127], a[100:103], v[156:159], v[112:127]
  ds_read_b128 v[156:159], v3 offset:48128
  s_waitcnt vmcnt(5) lgkmcnt(7)
  v_mfma_f32_32x32x16_bf16 v[64:79], a[104:107], v[128:131], v[64:79]
  ds_read_b128 v[128:131], v3 offset:49152
  s_waitcnt lgkmcnt(7)
  v_mfma_f32_32x32x16_bf16 v[80:95], a[104:107], v[132:135], v[80:95]
  ds_read_b128 v[132:135], v3 offset:50176
  s_waitcnt lgkmcnt(7)
  v_mfma_f32_32x32x16_bf16 v[96:111], a[104:107], v[136:139], v[96:111]
  ds_read_b128 v[136:139], v3 offset:51200
  s_waitcnt lgkmcnt(7)
  v_mfma_f32_32x32x16_bf16 v[112:127], a[104:107], v[140:143], v[112:127]
  ds_read_b128 v[140:143], v3 offset:52224
  s_waitcnt vmcnt(4) lgkmcnt(7)
  v_mfma_f32_32x32x16_bf16 v[64:79], a[108:111], v[144:147], v[64:79]
  ds_read_b128 v[144:147], v3 offset:53248
  s_waitcnt lgkmcnt(7)
  v_mfma_f32_32x32x16_bf16 v[80:95], a[108:111], v[148:151], v[80:95]
  ds_read_b128 v[148:151], v3 offset:54272
  s_waitcnt lgkmcnt(7)
  v_mfma_f32_32x32x16_bf16 v[96:111], a[108:111], v[152:155], v[96:111]
  ds_read_b128 v[152:155], v3 offset:55296
  s_waitcnt lgkmcnt(7)
  v_mfma_f32_32x32x16_bf16 v[112:127], a[108:111], v[156:159], v[112:127]
  ds_read_b128 v[156:159], v3 offset:56320
  s_waitcnt vmcnt(3) lgkmcnt(7)
  v_mfma_f32_32x32x16_bf16 v[64:79], a[112:115], v[128:131], v[64:79]
  ds_read_b128 v[128:131], v3 offset:57344
  s_waitcnt lgkmcnt(7)
  v_mfma_f32_32x32x16_bf16 v[80:95], a[112:115], v[132:135], v[80:95]
  ds_read_b128 v[132:135], v3 offset:58368
  s_waitcnt lgkmcnt(7)
  v_mfma_f32_32x32x16_bf16 v[96:111], a[112:115], v[136:139], v[96:111]
  ds_read_b128 v[136:139], v3 offset:59392
  s_waitcnt lgkmcnt(7)
  v_mfma_f32_32x32x16_bf16 v[112:127], a[112:115], v[140:143], v[112:127]
  ds_read_b128 v[140:143], v3 offset:60416
  s_waitcnt vmcnt(2) lgkmcnt(7)
  v_mfma_f32_32x32x16_bf16 v[64:79], a[116:119], v[144:147], v[64:79]
  ds_read_b128 v[144:147], v3 offset:61440
  s_waitcnt lgkmcnt(7)
  v_mfma_f32_32x32x16_bf16 v[80:95], a[116:119], v[148:151], v[80:95]
  ds_read_b128 v[148:151], v3 offset:62464
  s_waitcnt lgkmcnt(7)
  v_mfma_f32_32x32x16_bf16 v[96:111], a[116:119], v[152:155], v[96:111]
  ds_read_b128 v[152:155], v3 offset:63488
  s_waitcnt lgkmcnt(7)
  v_mfma_f32_32x32x16_bf16 v[112:127], a[116:119], v[156:159], v[112:127]
  ds_read_b128 v[156:159], v3 offset:64512
  s_waitcnt vmcnt(1) lgkmcnt(7)
  v_mfma_f32_32x32x16_bf16 v[64:79], a[120:123], v[128:131], v[64:79]
  s_waitcnt lgkmcnt(6)
  v_mfma_f32_32x32x16_bf16 v[80:95], a[120:123], v[132:135], v[80:95]
  s_waitcnt lgkmcnt(5)
  v_mfma_f32_32x32x16_bf16 v[96:111], a[120:123], v[136:139], v[96:111]
  s_waitcnt lgkmcnt(4)
  v_mfma_f32_32x32x16_bf16 v[112:127], a[120:123], v[140:143], v[112:127]
  s_waitcnt vmcnt(0) lgkmcnt(3)
  v_mfma_f32_32x32x16_bf16 v[64:79], a[124:127], v[144:147], v[64:79]
  s_waitcnt lgkmcnt(2)
  v_mfma_f32_32x32x16_bf16 v[80:95], a[124:127], v[148:151], v[80:95]
  s_waitcnt lgkmcnt(1)
  v_mfma_f32_32x32x16_bf16 v[96:111], a[124:127], v[152:155], v[96:111]
  s_waitcnt lgkmcnt(0)
  v_mfma_f32_32x32x16_bf16 v[112:127], a[124:127], v[156:159], v[112:127]
  s_nop 15
  v_cvt_pk_bf16_f32 v160, v64, v65
  v_cvt_pk_bf16_f32 v161, v66, v67
  v_cvt_pk_bf16_f32 v162, v68, v69
  v_cvt_pk_bf16_f32 v163, v70, v71
  v_cvt_pk_bf16_f32 v164, v72, v73
  v_cvt_pk_bf16_f32 v165, v74, v75
  v_cvt_pk_bf16_f32 v166, v76, v77
  v_cvt_pk_bf16_f32 v167, v78, v79
  v_cvt_pk_bf16_f32 v168, v80, v81
  v_cvt_pk_bf16_f32 v169, v82, v83
  v_cvt_pk_bf16_f32 v170, v84, v85
  v_cvt_pk_bf16_f32 v171, v86, v87
  v_cvt_pk_bf16_f32 v172, v88, v89
  v_cvt_pk_bf16_f32 v173, v90, v91
  v_cvt_pk_bf16_f32 v174, v92, v93
  v_cvt_pk_bf16_f32 v175, v94, v95
  v_cvt_pk_bf16_f32 v176, v96, v97
  v_cvt_pk_bf16_f32 v177, v98, v99
  v_cvt_pk_bf16_f32 v178, v100, v101
  v_cvt_pk_bf16_f32 v179, v102, v103
  v_cvt_pk_bf16_f32 v180, v104, v105
  v_cvt_pk_bf16_f32 v181, v106, v107
  v_cvt_pk_bf16_f32 v182, v108, v109
  v_cvt_pk_bf16_f32 v183, v110, v111
  v_cvt_pk_bf16_f32 v184, v112, v113
  v_cvt_pk_bf16_f32 v185, v114, v115
  v_cvt_pk_bf16_f32 v186, v116, v117
  v_cvt_pk_bf16_f32 v187, v118, v119
  v_cvt_pk_bf16_f32 v188, v120, v121
  v_cvt_pk_bf16_f32 v189, v122, v123
  v_cvt_pk_bf16_f32 v190, v124, v125
  v_cvt_pk_bf16_f32 v191, v126, v127
  s_lshl_b32 s61, s49, 6
  s_add_u32 s61, s61, s51
  s_lshl_b32 s61, s61, 13
  s_add_u32 s61, s61, 33554432
  buffer_store_dwordx4 v[160:163], v2, s[32:35], s61 offen offset:0 sc1
  buffer_store_dwordx4 v[164:167], v2, s[32:35], s61 offen offset:1024 sc1
  buffer_store_dwordx4 v[168:171], v2, s[32:35], s61 offen offset:2048 sc1
  buffer_store_dwordx4 v[172:175], v2, s[32:35], s61 offen offset:3072 sc1
  s_add_u32 s61, s61, 4096
  buffer_store_dwordx4 v[176:179], v2, s[32:35], s61 offen offset:0 sc1
  buffer_store_dwordx4 v[180:183], v2, s[32:35], s61 offen offset:1024 sc1
  buffer_store_dwordx4 v[184:187], v2, s[32:35], s61 offen offset:2048 sc1
  buffer_store_dwordx4 v[188:191], v2, s[32:35], s61 offen offset:3072 sc1
  s_lshl_b32 s56, s48, 2
  s_lshl_b32 s57, s49, 7
  s_add_u32 s56, s56, s57
  s_add_u32 s56, s56, 4096
  s_lshr_b32 s57, s51, 2
  s_add_u32 s57, s57, 1
  s_waitcnt vmcnt(0)
  s_cmp_eq_u32 s50, 0
  s_cbranch_scc1 Lsig_28
  v_mov_b32 v4, s57
  v_mov_b32 v5, 0
  s_mov_b64 exec, 1
  buffer_store_dword v4, v5, s[32:35], s56 offen sc1
  s_mov_b64 exec, -1
Lsig_28:
  s_add_u32 s51, s51, 4
  s_cmp_lt_u32 s51, 64
  s_cbranch_scc1 LOOP_V
  s_waitcnt vmcnt(0)
  s_endpgm
ROLE_GU:
  s_mov_b32 s36, s20
  s_mov_b32 s37, s21
  s_mov_b32 s38, 1835008
  s_mov_b32 s39, 0x00020000
  s_mov_b32 s40, s22
  s_mov_b32 s41, s23
  s_mov_b32 s42, 1835008
  s_mov_b32 s43, 0x00020000
  s_lshl_b32 s62, s49, 7
  s_cmp_lg_u32 s48, 0
  s_cbranch_scc1 Lwi_29
  v_mov_b32 v4, 0
  s_mov_b32 s56, 128
  s_mov_b32 s57, 47
  s_cmp_eq_u32 s50, 0
  s_cbranch_scc1 Lwaitd_31
  s_mov_b32 s52, 0
  s_mov_b32 s54, 1
  s_mov_b32 s55, 0
Lwait_30:
  buffer_load_dword v5, v4, s[44:47], s56 offen sc1
  s_add_u32 s52, s52, 1
  s_cmp_gt_u32 s52, 65536
  s_cbranch_scc1 Lwaitd_31
  s_waitcnt vmcnt(0)
  v_cmp_gt_u32 vcc, v5, s57
  s_and_b64 vcc, vcc, s[54:55]
  s_cmp_eq_u64 vcc, s[54:55]
  s_cbranch_scc1 Lwaitd_31
  s_sleep 2
  s_branch Lwait_30
Lwaitd_31:
  s_waitcnt vmcnt(0)
Lwi_29:
  s_barrier
  v_mov_b32 v4, 0
  s_mov_b32 s56, 0
  s_mov_b32 s57, 0
  s_cmp_eq_u32 s50, 0
  s_cbranch_scc1 Lwaitd_33
  s_mov_b32 s52, 0
  s_mov_b32 s54, 1
  s_mov_b32 s55, 0
Lwait_32:
  buffer_load_dword v5, v4, s[32:35], s56 offen sc1
  s_add_u32 s52, s52, 1
  s_cmp_gt_u32 s52, 65536
  s_cbranch_scc1 Lwaitd_33
  s_waitcnt vmcnt(0)
  v_cmp_gt_u32 vcc, v5, s57
  s_and_b64 vcc, vcc, s[54:55]
  s_cmp_eq_u64 vcc, s[54:55]
  s_cbranch_scc1 Lwaitd_33
  s_sleep 16
  s_branch Lwait_32
Lwaitd_33:
  s_waitcnt vmcnt(0)
  v_and_b32 v7, 7, v1
  v_lshlrev_b32 v4, 4, v7
  v_lshrrev_b32 v7, 5, v1
  v_mul_u32_u24 v8, 57344, v7
  v_add_u32 v4, v4, v8
  v_bfe_u32 v9, v1, 4, 1
  v_mul_u32_u24 v8, 14336, v9
  v_add_u32 v4, v4, v8
  v_lshlrev_b32 v5, 12, v7
  v_lshl_add_u32 v5, v9, 9, v5
  v_bfe_u32 v8, v1, 2, 2
  v_lshl_add_u32 v5, v8, 10, v5
  v_and_b32 v8, 3, v1
  v_lshl_add_u32 v5, v8, 7, v5
  s_lshl_b32 s52, s48, 13
  v_add_u32 v5, s52, v5
  v_add_u32 v6, 0x10000, v5
  s_mul_i32 s52, s48, 114688
  s_add_u32 s52, s52, s62
  s_add_u32 s53, s52, 0
  s_mov_b32 exec_lo, 0x00ff00ff
  s_mov_b32 exec_hi, 0x00ff00ff
  buffer_load_dwordx4 v[16:19], v4, s[36:39], s53 offen
  s_mov_b32 exec_lo, 0xff00ff00
  s_mov_b32 exec_hi, 0xff00ff00
  buffer_load_dwordx4 v[16:19], v4, s[40:43], s53 offen
  s_mov_b64 exec, -1
  s_add_u32 s53, s52, 3584
  s_mov_b32 exec_lo, 0x00ff00ff
  s_mov_b32 exec_hi, 0x00ff00ff
  buffer_load_dwordx4 v[20:23], v4, s[36:39], s53 offen
  s_mov_b32 exec_lo, 0xff00ff00
  s_mov_b32 exec_hi, 0xff00ff00
  buffer_load_dwordx4 v[20:23], v4, s[40:43], s53 offen
  s_mov_b64 exec, -1
  s_add_u32 s53, s52, 7168
  s_mov_b32 exec_lo, 0x00ff00ff
  s_mov_b32 exec_hi, 0x00ff00ff
  buffer_load_dwordx4 v[24:27], v4, s[36:39], s53 offen
  s_mov_b32 exec_lo, 0xff00ff00
  s_mov_b32 exec_hi, 0xff00ff00
  buffer_load_dwordx4 v[24:27], v4, s[40:43], s53 offen
  s_mov_b64 exec, -1
  s_add_u32 s53, s52, 10752
  s_mov_b32 exec_lo, 0x00ff00ff
  s_mov_b32 exec_hi, 0x00ff00ff
  buffer_load_dwordx4 v[28:31], v4, s[36:39], s53 offen
  s_mov_b32 exec_lo, 0xff00ff00
  s_mov_b32 exec_hi, 0xff00ff00
  buffer_load_dwordx4 v[28:31], v4, s[40:43], s53 offen
  s_mov_b64 exec, -1
  s_add_u32 s53, s52, 28672
  s_mov_b32 exec_lo, 0x00ff00ff
  s_mov_b32 exec_hi, 0x00ff00ff
  buffer_load_dwordx4 v[32:35], v4, s[36:39], s53 offen
  s_mov_b32 exec_lo, 0xff00ff00
  s_mov_b32 exec_hi, 0xff00ff00
  buffer_load_dwordx4 v[32:35], v4, s[40:43], s53 offen
  s_mov_b64 exec, -1
  s_add_u32 s53, s52, 32256
  s_mov_b32 exec_lo, 0x00ff00ff
  s_mov_b32 exec_hi, 0x00ff00ff
  buffer_load_dwordx4 v[36:39], v4, s[36:39], s53 offen
  s_mov_b32 exec_lo, 0xff00ff00
  s_mov_b32 exec_hi, 0xff00ff00
  buffer_load_dwordx4 v[36:39], v4, s[40:43], s53 offen
  s_mov_b64 exec, -1
  s_add_u32 s53, s52, 35840
  s_mov_b32 exec_lo, 0x00ff00ff
  s_mov_b32 exec_hi, 0x00ff00ff
  buffer_load_dwordx4 v[40:43], v4, s[36:39], s53 offen
  s_mov_b32 exec_lo, 0xff00ff00
  s_mov_b32 exec_hi, 0xff00ff00
  buffer_load_dwordx4 v[40:43], v4, s[40:43], s53 offen
  s_mov_b64 exec, -1
  s_add_u32 s53, s52, 39424
  s_mov_b32 exec_lo, 0x00ff00ff
  s_mov_b32 exec_hi, 0x00ff00ff
  buffer_load_dwordx4 v[44:47], v4, s[36:39], s53 offen
  s_mov_b32 exec_lo, 0xff00ff00
  s_mov_b32 exec_hi, 0xff00ff00
  buffer_load_dwordx4 v[44:47], v4, s[40:43], s53 offen
  s_mov_b64 exec, -1
  s_add_u32 s53, s52, 458752
  s_mov_b32 exec_lo, 0x00ff00ff
  s_mov_b32 exec_hi, 0x00ff00ff
  buffer_load_dwordx4 v[48:51], v4, s[36:39], s53 offen
  s_mov_b32 exec_lo, 0xff00ff00
  s_mov_b32 exec_hi, 0xff00ff00
  buffer_load_dwordx4 v[48:51], v4, s[40:43], s53 offen
  s_mov_b64 exec, -1
  s_add_u32 s53, s52, 462336
  s_mov_b32 exec_lo, 0x00ff00ff
  s_mov_b32 exec_hi, 0x00ff00ff
  buffer_load_dwordx4 v[52:55], v4, s[36:39], s53 offen
  s_mov_b32 exec_lo, 0xff00ff00
  s_mov_b32 exec_hi, 0xff00ff00
  buffer_load_dwordx4 v[52:55], v4, s[40:43], s53 offen
  s_mov_b64 exec, -1
  s_add_u32 s53, s52, 465920
  s_mov_b32 exec_lo, 0x00ff00ff
  s_mov_b32 exec_hi, 0x00ff00ff
  buffer_load_dwordx4 v[56:59], v4, s[36:39], s53 offen
  s_mov_b32 exec_lo, 0xff00ff00
  s_mov_b32 exec_hi, 0xff00ff00
  buffer_load_dwordx4 v[56:59], v4, s[40:43], s53 offen
  s_mov_b64 exec, -1
  s_add_u32 s53, s52, 469504
  s_mov_b32 exec_lo, 0x00ff00ff
  s_mov_b32 exec_hi, 0x00ff00ff
  buffer_load_dwordx4 v[60:63], v4, s[36:39], s53 offen
  s_mov_b32 exec_lo, 0xff00ff00
  s_mov_b32 exec_hi, 0xff00ff00
  buffer_load_dwordx4 v[60:63], v4, s[40:43], s53 offen
  s_mov_b64 exec, -1
  s_add_u32 s53, s52, 487424
  s_mov_b32 exec_lo, 0x00ff00ff
  s_mov_b32 exec_hi, 0x00ff00ff
  buffer_load_dwordx4 v[64:67], v4, s[36:39], s53 offen
  s_mov_b32 exec_lo, 0xff00ff00
  s_mov_b32 exec_hi, 0xff00ff00
  buffer_load_dwordx4 v[64:67], v4, s[40:43], s53 offen
  s_mov_b64 exec, -1
  s_add_u32 s53, s52, 491008
  s_mov_b32 exec_lo, 0x00ff00ff
  s_mov_b32 exec_hi, 0x00ff00ff
  buffer_load_dwordx4 v[68:71], v4, s[36:39], s53 offen
  s_mov_b32 exec_lo, 0xff00ff00
  s_mov_b32 exec_hi, 0xff00ff00
  buffer_load_dwordx4 v[68:71], v4, s[40:43], s53 offen
  s_mov_b64 exec, -1
  s_add_u32 s53, s52, 494592
  s_mov_b32 exec_lo, 0x00ff00ff
  s_mov_b32 exec_hi, 0x00ff00ff
  buffer_load_dwordx4 v[72:75], v4, s[36:39], s53 offen
  s_mov_b32 exec_lo, 0xff00ff00
  s_mov_b32 exec_hi, 0xff00ff00
  buffer_load_dwordx4 v[72:75], v4, s[40:43], s53 offen
  s_mov_b64 exec, -1
  s_add_u32 s53, s52, 498176
  s_mov_b32 exec_lo, 0x00ff00ff
  s_mov_b32 exec_hi, 0x00ff00ff
  buffer_load_dwordx4 v[76:79], v4, s[36:39], s53 offen
  s_mov_b32 exec_lo, 0xff00ff00
  s_mov_b32 exec_hi, 0xff00ff00
  buffer_load_dwordx4 v[76:79], v4, s[40:43], s53 offen
  s_mov_b64 exec, -1
  s_add_u32 s53, s52, 917504
  s_mov_b32 exec_lo, 0x00ff00ff
  s_mov_b32 exec_hi, 0x00ff00ff
  buffer_load_dwordx4 v[80:83], v4, s[36:39], s53 offen
  s_mov_b32 exec_lo, 0xff00ff00
  s_mov_b32 exec_hi, 0xff00ff00
  buffer_load_dwordx4 v[80:83], v4, s[40:43], s53 offen
  s_mov_b64 exec, -1
  s_add_u32 s53, s52, 921088
  s_mov_b32 exec_lo, 0x00ff00ff
  s_mov_b32 exec_hi, 0x00ff00ff
  buffer_load_dwordx4 v[84:87], v4, s[36:39], s53 offen
  s_mov_b32 exec_lo, 0xff00ff00
  s_mov_b32 exec_hi, 0xff00ff00
  buffer_load_dwordx4 v[84:87], v4, s[40:43], s53 offen
  s_mov_b64 exec, -1
  s_add_u32 s53, s52, 924672
  s_mov_b32 exec_lo, 0x00ff00ff
  s_mov_b32 exec_hi, 0x00ff00ff
  buffer_load_dwordx4 v[88:91], v4, s[36:39], s53 offen
  s_mov_b32 exec_lo, 0xff00ff00
  s_mov_b32 exec_hi, 0xff00ff00
  buffer_load_dwordx4 v[88:91], v4, s[40:43], s53 offen
  s_mov_b64 exec, -1
  s_add_u32 s53, s52, 928256
  s_mov_b32 exec_lo, 0x00ff00ff
  s_mov_b32 exec_hi, 0x00ff00ff
  buffer_load_dwordx4 v[92:95], v4, s[36:39], s53 offen
  s_mov_b32 exec_lo, 0xff00ff00
  s_mov_b32 exec_hi, 0xff00ff00
  buffer_load_dwordx4 v[92:95], v4, s[40:43], s53 offen
  s_mov_b64 exec, -1
  s_add_u32 s53, s52, 946176
  s_mov_b32 exec_lo, 0x00ff00ff
  s_mov_b32 exec_hi, 0x00ff00ff
  buffer_load_dwordx4 v[96:99], v4, s[36:39], s53 offen
  s_mov_b32 exec_lo, 0xff00ff00
  s_mov_b32 exec_hi, 0xff00ff00
  buffer_load_dwordx4 v[96:99], v4, s[40:43], s53 offen
  s_mov_b64 exec, -1
  s_add_u32 s53, s52, 949760
  s_mov_b32 exec_lo, 0x00ff00ff
  s_mov_b32 exec_hi, 0x00ff00ff
  buffer_load_dwordx4 v[100:103], v4, s[36:39], s53 offen
  s_mov_b32 exec_lo, 0xff00ff00
  s_mov_b32 exec_hi, 0xff00ff00
  buffer_load_dwordx4 v[100:103], v4, s[40:43], s53 offen
  s_mov_b64 exec, -1
  s_add_u32 s53, s52, 953344
  s_mov_b32 exec_lo, 0x00ff00ff
  s_mov_b32 exec_hi, 0x00ff00ff
  buffer_load_dwordx4 v[104:107], v4, s[36:39], s53 offen
  s_mov_b32 exec_lo, 0xff00ff00
  s_mov_b32 exec_hi, 0xff00ff00
  buffer_load_dwordx4 v[104:107], v4, s[40:43], s53 offen
  s_mov_b64 exec, -1
  s_add_u32 s53, s52, 956928
  s_mov_b32 exec_lo, 0x00ff00ff
  s_mov_b32 exec_hi, 0x00ff00ff
  buffer_load_dwordx4 v[108:111], v4, s[36:39], s53 offen
  s_mov_b32 exec_lo, 0xff00ff00
  s_mov_b32 exec_hi, 0xff00ff00
  buffer_load_dwordx4 v[108:111], v4, s[40:43], s53 offen
  s_mov_b64 exec, -1
  s_add_u32 s53, s52, 1376256
  s_mov_b32 exec_lo, 0x00ff00ff
  s_mov_b32 exec_hi, 0x00ff00ff
  buffer_load_dwordx4 v[112:115], v4, s[36:39], s53 offen
  s_mov_b32 exec_lo, 0xff00ff00
  s_mov_b32 exec_hi, 0xff00ff00
  buffer_load_dwordx4 v[112:115], v4, s[40:43], s53 offen
  s_mov_b64 exec, -1
  s_add_u32 s53, s52, 1379840
  s_mov_b32 exec_lo, 0x00ff00ff
  s_mov_b32 exec_hi, 0x00ff00ff
  buffer_load_dwordx4 v[116:119], v4, s[36:39], s53 offen
  s_mov_b32 exec_lo, 0xff00ff00
  s_mov_b32 exec_hi, 0xff00ff00
  buffer_load_dwordx4 v[116:119], v4, s[40:43], s53 offen
  s_mov_b64 exec, -1
  s_add_u32 s53, s52, 1383424
  s_mov_b32 exec_lo, 0x00ff00ff
  s_mov_b32 exec_hi, 0x00ff00ff
  buffer_load_dwordx4 v[120:123], v4, s[36:39], s53 offen
  s_mov_b32 exec_lo, 0xff00ff00
  s_mov_b32 exec_hi, 0xff00ff00
  buffer_load_dwordx4 v[120:123], v4, s[40:43], s53 offen
  s_mov_b64 exec, -1
  s_add_u32 s53, s52, 1387008
  s_mov_b32 exec_lo, 0x00ff00ff
  s_mov_b32 exec_hi, 0x00ff00ff
  buffer_load_dwordx4 v[124:127], v4, s[36:39], s53 offen
  s_mov_b32 exec_lo, 0xff00ff00
  s_mov_b32 exec_hi, 0xff00ff00
  buffer_load_dwordx4 v[124:127], v4, s[40:43], s53 offen
  s_mov_b64 exec, -1
  s_add_u32 s53, s52, 1404928
  s_mov_b32 exec_lo, 0x00ff00ff
  s_mov_b32 exec_hi, 0x00ff00ff
  buffer_load_dwordx4 v[128:131], v4, s[36:39], s53 offen
  s_mov_b32 exec_lo, 0xff00ff00
  s_mov_b32 exec_hi, 0xff00ff00
  buffer_load_dwordx4 v[128:131], v4, s[40:43], s53 offen
  s_mov_b64 exec, -1
  s_add_u32 s53, s52, 1408512
  s_mov_b32 exec_lo, 0x00ff00ff
  s_mov_b32 exec_hi, 0x00ff00ff
  buffer_load_dwordx4 v[132:135], v4, s[36:39], s53 offen
  s_mov_b32 exec_lo, 0xff00ff00
  s_mov_b32 exec_hi, 0xff00ff00
  buffer_load_dwordx4 v[132:135], v4, s[40:43], s53 offen
  s_mov_b64 exec, -1
  s_add_u32 s53, s52, 1412096
  s_mov_b32 exec_lo, 0x00ff00ff
  s_mov_b32 exec_hi, 0x00ff00ff
  buffer_load_dwordx4 v[136:139], v4, s[36:39], s53 offen
  s_mov_b32 exec_lo, 0xff00ff00
  s_mov_b32 exec_hi, 0xff00ff00
  buffer_load_dwordx4 v[136:139], v4, s[40:43], s53 offen
  s_mov_b64 exec, -1
  s_add_u32 s53, s52, 1415680
  s_mov_b32 exec_lo, 0x00ff00ff
  s_mov_b32 exec_hi, 0x00ff00ff
  buffer_load_dwordx4 v[140:143], v4, s[36:39], s53 offen
  s_mov_b32 exec_lo, 0xff00ff00
  s_mov_b32 exec_hi, 0xff00ff00
  buffer_load_dwordx4 v[140:143], v4, s[40:43], s53 offen
  s_mov_b64 exec, -1
Lwl_skip_34:
  s_waitcnt vmcnt(0)
  v_perm_b32 v144, v20, v16, s64
  v_perm_b32 v145, v28, v24, s64
  v_perm_b32 v146, v36, v32, s64
  v_perm_b32 v147, v44, v40, s64
  ds_write_b128 v5, v[144:147] offset:0
  v_perm_b32 v148, v20, v16, s65
  v_perm_b32 v149, v28, v24, s65
  v_perm_b32 v150, v36, v32, s65
  v_perm_b32 v151, v44, v40, s65
  ds_write_b128 v5, v[148:151] offset:16
  v_perm_b32 v152, v21, v17, s64
  v_perm_b32 v153, v29, v25, s64
  v_perm_b32 v154, v37, v33, s64
  v_perm_b32 v155, v45, v41, s64
  ds_write_b128 v5, v[152:155] offset:32
  v_perm_b32 v156, v21, v17, s65
  v_perm_b32 v157, v29, v25, s65
  v_perm_b32 v158, v37, v33, s65
  v_perm_b32 v159, v45, v41, s65
  ds_write_b128 v5, v[156:159] offset:48
  s_waitcnt lgkmcnt(0)
  v_perm_b32 v144, v22, v18, s64
  v_perm_b32 v145, v30, v26, s64
  v_perm_b32 v146, v38, v34, s64
  v_perm_b32 v147, v46, v42, s64
  ds_write_b128 v5, v[144:147] offset:64
  v_perm_b32 v148, v22, v18, s65
  v_perm_b32 v149, v30, v26, s65
  v_perm_b32 v150, v38, v34, s65
  v_perm_b32 v151, v46, v42, s65
  ds_write_b128 v5, v[148:151] offset:80
  v_perm_b32 v152, v23, v19, s64
  v_perm_b32 v153, v31, v27, s64
  v_perm_b32 v154, v39, v35, s64
  v_perm_b32 v155, v47, v43, s64
  ds_write_b128 v5, v[152:155] offset:96
  v_perm_b32 v156, v23, v19, s65
  v_perm_b32 v157, v31, v27, s65
  v_perm_b32 v158, v39, v35, s65
  v_perm_b32 v159, v47, v43, s65
  ds_write_b128 v5, v[156:159] offset:112
  s_waitcnt lgkmcnt(0)
  v_perm_b32 v144, v52, v48, s64
  v_perm_b32 v145, v60, v56, s64
  v_perm_b32 v146, v68, v64, s64
  v_perm_b32 v147, v76, v72, s64
  ds_write_b128 v5, v[144:147] offset:32768
  v_perm_b32 v148, v52, v48, s65
  v_perm_b32 v149, v60, v56, s65
  v_perm_b32 v150, v68, v64, s65
  v_perm_b32 v151, v76, v72, s65
  ds_write_b128 v5, v[148:151] offset:32784
  v_perm_b32 v152, v53, v49, s64
  v_perm_b32 v153, v61, v57, s64
  v_perm_b32 v154, v69, v65, s64
  v_perm_b32 v155, v77, v73, s64
  ds_write_b128 v5, v[152:155] offset:32800
  v_perm_b32 v156, v53, v49, s65
  v_perm_b32 v157, v61, v57, s65
  v_perm_b32 v158, v69, v65, s65
  v_perm_b32 v159, v77, v73, s65
  ds_write_b128 v5, v[156:159] offset:32816
  s_waitcnt lgkmcnt(0)
  v_perm_b32 v144, v54, v50, s64
  v_perm_b32 v145, v62, v58, s64
  v_perm_b32 v146, v70, v66, s64
  v_perm_b32 v147, v78, v74, s64
  ds_write_b128 v5, v[144:147] offset:32832
  v_perm_b32 v148, v54, v50, s65
  v_perm_b32 v149, v62, v58, s65
  v_perm_b32 v150, v70, v66, s65
  v_perm_b32 v151, v78, v74, s65
  ds_write_b128 v5, v[148:151] offset:32848
  v_perm_b32 v152, v55, v51, s64
  v_perm_b32 v153, v63, v59, s64
  v_perm_b32 v154, v71, v67, s64
  v_perm_b32 v155, v79, v75, s64
  ds_write_b128 v5, v[152:155] offset:32864
  v_perm_b32 v156, v55, v51, s65
  v_perm_b32 v157, v63, v59, s65
  v_perm_b32 v158, v71, v67, s65
  v_perm_b32 v159, v79, v75, s65
  ds_write_b128 v5, v[156:159] offset:32880
  s_waitcnt lgkmcnt(0)
  v_perm_b32 v144, v84, v80, s64
  v_perm_b32 v145, v92, v88, s64
  v_perm_b32 v146, v100, v96, s64
  v_perm_b32 v147, v108, v104, s64
  ds_write_b128 v6, v[144:147] offset:0
  v_perm_b32 v148, v84, v80, s65
  v_perm_b32 v149, v92, v88, s65
  v_perm_b32 v150, v100, v96, s65
  v_perm_b32 v151, v108, v104, s65
  ds_write_b128 v6, v[148:151] offset:16
  v_perm_b32 v152, v85, v81, s64
  v_perm_b32 v153, v93, v89, s64
  v_perm_b32 v154, v101, v97, s64
  v_perm_b32 v155, v109, v105, s64
  ds_write_b128 v6, v[152:155] offset:32
  v_perm_b32 v156, v85, v81, s65
  v_perm_b32 v157, v93, v89, s65
  v_perm_b32 v158, v101, v97, s65
  v_perm_b32 v159, v109, v105, s65
  ds_write_b128 v6, v[156:159] offset:48
  s_waitcnt lgkmcnt(0)
  v_perm_b32 v144, v86, v82, s64
  v_perm_b32 v145, v94, v90, s64
  v_perm_b32 v146, v102, v98, s64
  v_perm_b32 v147, v110, v106, s64
  ds_write_b128 v6, v[144:147] offset:64
  v_perm_b32 v148, v86, v82, s65
  v_perm_b32 v149, v94, v90, s65
  v_perm_b32 v150, v102, v98, s65
  v_perm_b32 v151, v110, v106, s65
  ds_write_b128 v6, v[148:151] offset:80
  v_perm_b32 v152, v87, v83, s64
  v_perm_b32 v153, v95, v91, s64
  v_perm_b32 v154, v103, v99, s64
  v_perm_b32 v155, v111, v107, s64
  ds_write_b128 v6, v[152:155] offset:96
  v_perm_b32 v156, v87, v83, s65
  v_perm_b32 v157, v95, v91, s65
  v_perm_b32 v158, v103, v99, s65
  v_perm_b32 v159, v111, v107, s65
  ds_write_b128 v6, v[156:159] offset:112
  s_waitcnt lgkmcnt(0)
  v_perm_b32 v144, v116, v112, s64
  v_perm_b32 v145, v124, v120, s64
  v_perm_b32 v146, v132, v128, s64
  v_perm_b32 v147, v140, v136, s64
  ds_write_b128 v6, v[144:147] offset:32768
  v_perm_b32 v148, v116, v112, s65
  v_perm_b32 v149, v124, v120, s65
  v_perm_b32 v150, v132, v128, s65
  v_perm_b32 v151, v140, v136, s65
  ds_write_b128 v6, v[148:151] offset:32784
  v_perm_b32 v152, v117, v113, s64
  v_perm_b32 v153, v125, v121, s64
  v_perm_b32 v154, v133, v129, s64
  v_perm_b32 v155, v141, v137, s64
  ds_write_b128 v6, v[152:155] offset:32800
  v_perm_b32 v156, v117, v113, s65
  v_perm_b32 v157, v125, v121, s65
  v_perm_b32 v158, v133, v129, s65
  v_perm_b32 v159, v141, v137, s65
  ds_write_b128 v6, v[156:159] offset:32816
  s_waitcnt lgkmcnt(0)
  v_perm_b32 v144, v118, v114, s64
  v_perm_b32 v145, v126, v122, s64
  v_perm_b32 v146, v134, v130, s64
  v_perm_b32 v147, v142, v138, s64
  ds_write_b128 v6, v[144:147] offset:32832
  v_perm_b32 v148, v118, v114, s65
  v_perm_b32 v149, v126, v122, s65
  v_perm_b32 v150, v134, v130, s65
  v_perm_b32 v151, v142, v138, s65
  ds_write_b128 v6, v[148:151] offset:32848
  v_perm_b32 v152, v119, v115, s64
  v_perm_b32 v153, v127, v123, s64
  v_perm_b32 v154, v135, v131, s64
  v_perm_b32 v155, v143, v139, s64
  ds_write_b128 v6, v[152:155] offset:32864
  v_perm_b32 v156, v119, v115, s65
  v_perm_b32 v157, v127, v123, s65
  v_perm_b32 v158, v135, v131, s65
  v_perm_b32 v159, v143, v139, s65
  ds_write_b128 v6, v[156:159] offset:32880
  s_waitcnt lgkmcnt(0)
Lwl_skip2_35:
  s_cmp_lg_u32 s48, 0
  s_cbranch_scc1 Lwi_36
  v_mov_b32 v4, 0
  s_mov_b32 s56, 128
  s_mov_b32 s57, 47
  s_cmp_eq_u32 s50, 0
  s_cbranch_scc1 Lwaitd_38
  s_mov_b32 s52, 0
  s_mov_b32 s54, 1
  s_mov_b32 s55, 0
Lwait_37:
  buffer_load_dword v5, v4, s[44:47], s56 offen sc1
  s_add_u32 s52, s52, 1
  s_cmp_gt_u32 s52, 65536
  s_cbranch_scc1 Lwaitd_38
  s_waitcnt vmcnt(0)
  v_cmp_gt_u32 vcc, v5, s57
  s_and_b64 vcc, vcc, s[54:55]
  s_cmp_eq_u64 vcc, s[54:55]
  s_cbranch_scc1 Lwaitd_38
  s_sleep 2
  s_branch Lwait_37
Lwaitd_38:
  s_waitcnt vmcnt(0)
Lwi_36:
  s_waitcnt lgkmcnt(0)
  s_barrier
  s_mov_b32 s66, 0xc0135761
  s_mov_b32 s67, 0xbdd2d3e8
  v_add_u32 v3, 0x10000, v2
  s_mov_b32 s51, s48
LOOP_GU:
  s_lshl_b32 s56, s51, 8
  s_add_u32 s56, s56, 32768
  s_mov_b32 s57, 0
  v_min_u32 v4, 3, v1
  v_lshlrev_b32 v4, 6, v4
  s_cmp_eq_u32 s50, 0
  s_cbranch_scc1 Lwaitd_40
  s_mov_b32 s52, 0
  s_mov_b32 s54, 15
  s_mov_b32 s55, 0
Lwait_39:
  buffer_load_dword v5, v4, s[32:35], s56 offen sc1
  s_add_u32 s52, s52, 1
  s_cmp_gt_u32 s52, 65536
  s_cbranch_scc1 Lwaitd_40
  s_waitcnt vmcnt(0)
  v_cmp_gt_u32 vcc, v5, s57
  s_and_b64 vcc, vcc, s[54:55]
  s_cmp_eq_u64 vcc, s[54:55]
  s_cbranch_scc1 Lwaitd_40
  s_sleep 2
  s_branch Lwait_39
Lwaitd_40:
  s_waitcnt vmcnt(0)
  s_lshl_b32 s60, s51, 15
  s_add_u32 s60, s60, 1048576
  buffer_load_dwordx4 a[0:3], v2, s[32:35], s60 offen offset:0 sc1
  buffer_load_dwordx4 a[4:7], v2, s[32:35], s60 offen offset:1024 sc1
  buffer_load_dwordx4 a[8:11], v2, s[32:35], s60 offen offset:2048 sc1
  buffer_load_dwordx4 a[12:15], v2, s[32:35], s60 offen offset:3072 sc1
  s_add_u32 s60, s60, 4096
  buffer_load_dwordx4 a[16:19], v2, s[32:35], s60 offen offset:0 sc1
  buffer_load_dwordx4 a[20:23], v2, s[32:35], s60 offen offset:1024 sc1
  buffer_load_dwordx4 a[24:27], v2, s[32:35], s60 offen offset:2048 sc1
  buffer_load_dwordx4 a[28:31], v2, s[32:35], s60 offen offset:3072 sc1
  s_add_u32 s60, s60, 4096
  buffer_load_dwordx4 a[32:35], v2, s[32:35], s60 offen offset:0 sc1
  buffer_load_dwordx4 a[36:39], v2, s[32:35], s60 offen offset:1024 sc1
  buffer_load_dwordx4 a[40:43], v2, s[32:35], s60 offen offset:2048 sc1
  buffer_load_dwordx4 a[44:47], v2, s[32:35], s60 offen offset:3072 sc1
  s_add_u32 s60, s60, 4096
  buffer_load_dwordx4 a[48:51], v2, s[32:35], s60 offen offset:0 sc1
  buffer_load_dwordx4 a[52:55], v2, s[32:35], s60 offen offset:1024 sc1
  buffer_load_dwordx4 a[56:59], v2, s[32:35], s60 offen offset:2048 sc1
  buffer_load_dwordx4 a[60:63], v2, s[32:35], s60 offen offset:3072 sc1
  s_add_u32 s60, s60, 4096
  buffer_load_dwordx4 a[64:67], v2, s[32:35], s60 offen offset:0 sc1
  buffer_load_dwordx4 a[68:71], v2, s[32:35], s60 offen offset:1024 sc1
  buffer_load_dwordx4 a[72:75], v2, s[32:35], s60 offen offset:2048 sc1
  buffer_load_dwordx4 a[76:79], v2, s[32:35], s60 offen offset:3072 sc1
  s_add_u32 s60, s60, 4096
  buffer_load_dwordx4 a[80:83], v2, s[32:35], s60 offen offset:0 sc1
  buffer_load_dwordx4 a[84:87], v2, s[32:35], s60 offen offset:1024 sc1
  buffer_load_dwordx4 a[88:91], v2, s[32:35], s60 offen offset:2048 sc1
  buffer_load_dwordx4 a[92:95], v2, s[32:35], s60 offen offset:3072 sc1
  s_add_u32 s60, s60, 4096
  buffer_load_dwordx4 a[96:99], v2, s[32:35], s60 offen offset:0 sc1
  buffer_load_dwordx4 a[100:103], v2, s[32:35], s60 offen offset:1024 sc1
  buffer_load_dwordx4 a[104:107], v2, s[32:35], s60 offen offset:2048 sc1
  buffer_load_dwordx4 a[108:111], v2, s[32:35], s60 offen offset:3072 sc1
  s_add_u32 s60, s60, 4096
  buffer_load_dwordx4 a[112:115], v2, s[32:35], s60 offen offset:0 sc1
  buffer_load_dwordx4 a[116:119], v2, s[32:35], s60 offen offset:1024 sc1
  buffer_load_dwordx4 a[120:123], v2, s[32:35], s60 offen offset:2048 sc1
  buffer_load_dwordx4 a[124:127], v2, s[32:35], s60 offen offset:3072 sc1
  ds_read_b128 v[128:131], v2 offset:0
  ds_read_b128 v[132:135], v2 offset:1024
  ds_read_b128 v[136:139], v2 offset:2048
  ds_read_b128 v[140:143], v2 offset:3072
  ds_read_b128 v[144:147], v2 offset:4096
  ds_read_b128 v[148:151], v2 offset:5120
  ds_read_b128 v[152:155], v2 offset:6144
  ds_read_b128 v[156:159], v2 offset:7168
  s_waitcnt vmcnt(31) lgkmcnt(7)
  v_mfma_f32_32x32x16_bf16 v[64:79], v[128:131], a[0:3], 0
  ds_read_b128 v[128:131], v2 offset:8192
  s_waitcnt lgkmcnt(7)
  v_mfma_f32_32x32x16_bf16 v[80:95], v[132:135], a[0:3], 0
  ds_read_b128 v[132:135], v2 offset:9216
  s_waitcnt lgkmcnt(7)
  v_mfma_f32_32x32x16_bf16 v[96:111], v[136:139], a[0:3], 0
  ds_read_b128 v[136:139], v2 offset:10240
  s_waitcnt lgkmcnt(7)
  v_mfma_f32_32x32x16_bf16 v[112:127], v[140:143], a[0:3], 0
  ds_read_b128 v[140:143], v2 offset:11264
  s_waitcnt vmcnt(30) lgkmcnt(7)
  v_mfma_f32_32x32x16_bf16 v[64:79], v[144:147], a[4:7], v[64:79]
  ds_read_b128 v[144:147], v2 offset:12288
  s_waitcnt lgkmcnt(7)
  v_mfma_f32_32x32x16_bf16 v[80:95], v[148:151], a[4:7], v[80:95]
  ds_read_b128 v[148:151], v2 offset:13312
  s_waitcnt lgkmcnt(7)
  v_mfma_f32_32x32x16_bf16 v[96:111], v[152:155], a[4:7], v[96:111]
  ds_read_b128 v[152:155], v2 offset:14336
  s_waitcnt lgkmcnt(7)
  v_mfma_f32_32x32x16_bf16 v[112:127], v[156:159], a[4:7], v[112:127]
  ds_read_b128 v[156:159], v2 offset:15360
  s_waitcnt vmcnt(29) lgkmcnt(7)
  v_mfma_f32_32x32x16_bf16 v[64:79], v[128:131], a[8:11], v[64:79]
  ds_read_b128 v[128:131], v2 offset:16384
  s_waitcnt lgkmcnt(7)
  v_mfma_f32_32x32x16_bf16 v[80:95], v[132:135], a[8:11], v[80:95]
  ds_read_b128 v[132:135], v2 offset:17408
  s_waitcnt lgkmcnt(7)
  v_mfma_f32_32x32x16_bf16 v[96:111], v[136:139], a[8:11], v[96:111]
  ds_read_b128 v[136:139], v2 offset:18432
  s_waitcnt lgkmcnt(7)
  v_mfma_f32_32x32x16_bf16 v[112:127], v[140:143], a[8:11], v[112:127]
  ds_read_b128 v[140:143], v2 offset:19456
  s_waitcnt vmcnt(28) lgkmcnt(7)
  v_mfma_f32_32x32x16_bf16 v[64:79], v[144:147], a[12:15], v[64:79]
  ds_read_b128 v[144:147], v2 offset:20480
  s_waitcnt lgkmcnt(7)
  v_mfma_f32_32x32x16_bf16 v[80:95], v[148:151], a[12:15], v[80:95]
  ds_read_b128 v[148:151], v2 offset:21504
  s_waitcnt lgkmcnt(7)
  v_mfma_f32_32x32x16_bf16 v[96:111], v[152:155], a[12:15], v[96:111]
  ds_read_b128 v[152:155], v2 offset:22528
  s_waitcnt lgkmcnt(7)
  v_mfma_f32_32x32x16_bf16 v[112:127], v[156:159], a[12:15], v[112:127]
  ds_read_b128 v[156:159], v2 offset:23552
  s_waitcnt vmcnt(27) lgkmcnt(7)
  v_mfma_f32_32x32x16_bf16 v[64:79], v[128:131], a[16:19], v[64:79]
  ds_read_b128 v[128:131], v2 offset:24576
  s_waitcnt lgkmcnt(7)
  v_mfma_f32_32x32x16_bf16 v[80:95], v[132:135], a[16:19], v[80:95]
  ds_read_b128 v[132:135], v2 offset:25600
  s_waitcnt lgkmcnt(7)
  v_mfma_f32_32x32x16_bf16 v[96:111], v[136:139], a[16:19], v[96:111]
  ds_read_b128 v[136:139], v2 offset:26624
  s_waitcnt lgkmcnt(7)
  v_mfma_f32_32x32x16_bf16 v[112:127], v[140:143], a[16:19], v[112:127]
  ds_read_b128 v[140:143], v2 offset:27648
  s_waitcnt vmcnt(26) lgkmcnt(7)
  v_mfma_f32_32x32x16_bf16 v[64:79], v[144:147], a[20:23], v[64:79]
  ds_read_b128 v[144:147], v2 offset:28672
  s_waitcnt lgkmcnt(7)
  v_mfma_f32_32x32x16_bf16 v[80:95], v[148:151], a[20:23], v[80:95]
  ds_read_b128 v[148:151], v2 offset:29696
  s_waitcnt lgkmcnt(7)
  v_mfma_f32_32x32x16_bf16 v[96:111], v[152:155], a[20:23], v[96:111]
  ds_read_b128 v[152:155], v2 offset:30720
  s_waitcnt lgkmcnt(7)
  v_mfma_f32_32x32x16_bf16 v[112:127], v[156:159], a[20:23], v[112:127]
  ds_read_b128 v[156:159], v2 offset:31744
  s_waitcnt vmcnt(25) lgkmcnt(7)
  v_mfma_f32_32x32x16_bf16 v[64:79], v[128:131], a[24:27], v[64:79]
  ds_read_b128 v[128:131], v2 offset:32768
  s_waitcnt lgkmcnt(7)
  v_mfma_f32_32x32x16_bf16 v[80:95], v[132:135], a[24:27], v[80:95]
  ds_read_b128 v[132:135], v2 offset:33792
  s_waitcnt lgkmcnt(7)
  v_mfma_f32_32x32x16_bf16 v[96:111], v[136:139], a[24:27], v[96:111]
  ds_read_b128 v[136:139], v2 offset:34816
  s_waitcnt lgkmcnt(7)
  v_mfma_f32_32x32x16_bf16 v[112:127], v[140:143], a[24:27], v[112:127]
  ds_read_b128 v[140:143], v2 offset:35840
  s_waitcnt vmcnt(24) lgkmcnt(7)
  v_mfma_f32_32x32x16_bf16 v[64:79], v[144:147], a[28:31], v[64:79]
  ds_read_b128 v[144:147], v2 offset:36864
  s_waitcnt lgkmcnt(7)
  v_mfma_f32_32x32x16_bf16 v[80:95], v[148:151], a[28:31], v[80:95]
  ds_read_b128 v[148:151], v2 offset:37888
  s_waitcnt lgkmcnt(7)
  v_mfma_f32_32x32x16_bf16 v[96:111], v[152:155], a[28:31], v[96:111]
  ds_read_b128 v[152:155], v2 offset:38912
  s_waitcnt lgkmcnt(7)
  v_mfma_f32_32x32x16_bf16 v[112:127], v[156:159], a[28:31], v[112:127]
  ds_read_b128 v[156:159], v2 offset:39936
  s_waitcnt vmcnt(23) lgkmcnt(7)
  v_mfma_f32_32x32x16_bf16 v[64:79], v[128:131], a[32:35], v[64:79]
  ds_read_b128 v[128:131], v2 offset:40960
  s_waitcnt lgkmcnt(7)
  v_mfma_f32_32x32x16_bf16 v[80:95], v[132:135], a[32:35], v[80:95]
  ds_read_b128 v[132:135], v2 offset:41984
  s_waitcnt lgkmcnt(7)
  v_mfma_f32_32x32x16_bf16 v[96:111], v[136:139], a[32:35], v[96:111]
  ds_read_b128 v[136:139], v2 offset:43008
  s_waitcnt lgkmcnt(7)
  v_mfma_f32_32x32x16_bf16 v[112:127], v[140:143], a[32:35], v[112:127]
  ds_read_b128 v[140:143], v2 offset:44032
  s_waitcnt vmcnt(22) lgkmcnt(7)
  v_mfma_f32_32x32x16_bf16 v[64:79], v[144:147], a[36:39], v[64:79]
  ds_read_b128 v[144:147], v2 offset:45056
  s_waitcnt lgkmcnt(7)
  v_mfma_f32_32x32x16_bf16 v[80:95], v[148:151], a[36:39], v[80:95]
  ds_read_b128 v[148:151], v2 offset:46080
  s_waitcnt lgkmcnt(7)
  v_mfma_f32_32x32x16_bf16 v[96:111], v[152:155], a[36:39], v[96:111]
  ds_read_b128 v[152:155], v2 offset:47104
  s_waitcnt lgkmcnt(7)
  v_mfma_f32_32x32x16_bf16 v[112:127], v[156:159], a[36:39], v[112:127]
  ds_read_b128 v[156:159], v2 offset:48128
  s_waitcnt vmcnt(21) lgkmcnt(7)
  v_mfma_f32_32x32x16_bf16 v[64:79], v[128:131], a[40:43], v[64:79]
  ds_read_b128 v[128:131], v2 offset:49152
  s_waitcnt lgkmcnt(7)
  v_mfma_f32_32x32x16_bf16 v[80:95], v[132:135], a[40:43], v[80:95]
  ds_read_b128 v[132:135], v2 offset:50176
  s_waitcnt lgkmcnt(7)
  v_mfma_f32_32x32x16_bf16 v[96:111], v[136:139], a[40:43], v[96:111]
  ds_read_b128 v[136:139], v2 offset:51200
  s_waitcnt lgkmcnt(7)
  v_mfma_f32_32x32x16_bf16 v[112:127], v[140:143], a[40:43], v[112:127]
  ds_read_b128 v[140:143], v2 offset:52224
  s_waitcnt vmcnt(20) lgkmcnt(7)
  v_mfma_f32_32x32x16_bf16 v[64:79], v[144:147], a[44:47], v[64:79]
  ds_read_b128 v[144:147], v2 offset:53248
  s_waitcnt lgkmcnt(7)
  v_mfma_f32_32x32x16_bf16 v[80:95], v[148:151], a[44:47], v[80:95]
  ds_read_b128 v[148:151], v2 offset:54272
  s_waitcnt lgkmcnt(7)
  v_mfma_f32_32x32x16_bf16 v[96:111], v[152:155], a[44:47], v[96:111]
  ds_read_b128 v[152:155], v2 offset:55296
  s_waitcnt lgkmcnt(7)
  v_mfma_f32_32x32x16_bf16 v[112:127], v[156:159], a[44:47], v[112:127]
  ds_read_b128 v[156:159], v2 offset:56320
  s_waitcnt vmcnt(19) lgkmcnt(7)
  v_mfma_f32_32x32x16_bf16 v[64:79], v[128:131], a[48:51], v[64:79]
  ds_read_b128 v[128:131], v2 offset:57344
  s_waitcnt lgkmcnt(7)
  v_mfma_f32_32x32x16_bf16 v[80:95], v[132:135], a[48:51], v[80:95]
  ds_read_b128 v[132:135], v2 offset:58368
  s_waitcnt lgkmcnt(7)
  v_mfma_f32_32x32x16_bf16 v[96:111], v[136:139], a[48:51], v[96:111]
  ds_read_b128 v[136:139], v2 offset:59392
  s_waitcnt lgkmcnt(7)
  v_mfma_f32_32x32x16_bf16 v[112:127], v[140:143], a[48:51], v[112:127]
  ds_read_b128 v[140:143], v2 offset:60416
  s_waitcnt vmcnt(18) lgkmcnt(7)
  v_mfma_f32_32x32x16_bf16 v[64:79], v[144:147], a[52:55], v[64:79]
  ds_read_b128 v[144:147], v2 offset:61440
  s_waitcnt lgkmcnt(7)
  v_mfma_f32_32x32x16_bf16 v[80:95], v[148:151], a[52:55], v[80:95]
  ds_read_b128 v[148:151], v2 offset:62464
  s_waitcnt lgkmcnt(7)
  v_mfma_f32_32x32x16_bf16 v[96:111], v[152:155], a[52:55], v[96:111]
  ds_read_b128 v[152:155], v2 offset:63488
  s_waitcnt lgkmcnt(7)
  v_mfma_f32_32x32x16_bf16 v[112:127], v[156:159], a[52:55], v[112:127]
  ds_read_b128 v[156:159], v2 offset:64512
  s_waitcnt vmcnt(17) lgkmcnt(7)
  v_mfma_f32_32x32x16_bf16 v[64:79], v[128:131], a[56:59], v[64:79]
  ds_read_b128 v[128:131], v3 offset:0
  s_waitcnt lgkmcnt(7)
  v_mfma_f32_32x32x16_bf16 v[80:95], v[132:135], a[56:59], v[80:95]
  ds_read_b128 v[132:135], v3 offset:1024
  s_waitcnt lgkmcnt(7)
  v_mfma_f32_32x32x16_bf16 v[96:111], v[136:139], a[56:59], v[96:111]
  ds_read_b128 v[136:139], v3 offset:2048
  s_waitcnt lgkmcnt(7)
  v_mfma_f32_32x32x16_bf16 v[112:127], v[140:143], a[56:59], v[112:127]
  ds_read_b128 v[140:143], v3 offset:3072
  s_waitcnt vmcnt(16) lgkmcnt(7)
  v_mfma_f32_32x32x16_bf16 v[64:79], v[144:147], a[60:63], v[64:79]
  ds_read_b128 v[144:147], v3 offset:4096
  s_waitcnt lgkmcnt(7)
  v_mfma_f32_32x32x16_bf16 v[80:95], v[148:151], a[60:63], v[80:95]
  ds_read_b128 v[148:151], v3 offset:5120
  s_waitcnt lgkmcnt(7)
  v_mfma_f32_32x32x16_bf16 v[96:111], v[152:155], a[60:63], v[96:111]
  ds_read_b128 v[152:155], v3 offset:6144
  s_waitcnt lgkmcnt(7)
  v_mfma_f32_32x32x16_bf16 v[112:127], v[156:159], a[60:63], v[112:127]
  ds_read_b128 v[156:159], v3 offset:7168
  s_waitcnt vmcnt(15) lgkmcnt(7)
  v_mfma_f32_32x32x16_bf16 v[64:79], v[128:131], a[64:67], v[64:79]
  ds_read_b128 v[128:131], v3 offset:8192
  s_waitcnt lgkmcnt(7)
  v_mfma_f32_32x32x16_bf16 v[80:95], v[132:135], a[64:67], v[80:95]
  ds_read_b128 v[132:135], v3 offset:9216
  s_waitcnt lgkmcnt(7)
  v_mfma_f32_32x32x16_bf16 v[96:111], v[136:139], a[64:67], v[96:111]
  ds_read_b128 v[136:139], v3 offset:10240
  s_waitcnt lgkmcnt(7)
  v_mfma_f32_32x32x16_bf16 v[112:127], v[140:143], a[64:67], v[112:127]
  ds_read_b128 v[140:143], v3 offset:11264
  s_waitcnt vmcnt(14) lgkmcnt(7)
  v_mfma_f32_32x32x16_bf16 v[64:79], v[144:147], a[68:71], v[64:79]
  ds_read_b128 v[144:147], v3 offset:12288
  s_waitcnt lgkmcnt(7)
  v_mfma_f32_32x32x16_bf16 v[80:95], v[148:151], a[68:71], v[80:95]
  ds_read_b128 v[148:151], v3 offset:13312
  s_waitcnt lgkmcnt(7)
  v_mfma_f32_32x32x16_bf16 v[96:111], v[152:155], a[68:71], v[96:111]
  ds_read_b128 v[152:155], v3 offset:14336
  s_waitcnt lgkmcnt(7)
  v_mfma_f32_32x32x16_bf16 v[112:127], v[156:159], a[68:71], v[112:127]
  ds_read_b128 v[156:159], v3 offset:15360
  s_waitcnt vmcnt(13) lgkmcnt(7)
  v_mfma_f32_32x32x16_bf16 v[64:79], v[128:131], a[72:75], v[64:79]
  ds_read_b128 v[128:131], v3 offset:16384
  s_waitcnt lgkmcnt(7)
  v_mfma_f32_32x32x16_bf16 v[80:95], v[132:135], a[72:75], v[80:95]
  ds_read_b128 v[132:135], v3 offset:17408
  s_waitcnt lgkmcnt(7)
  v_mfma_f32_32x32x16_bf16 v[96:111], v[136:139], a[72:75], v[96:111]
  ds_read_b128 v[136:139], v3 offset:18432
  s_waitcnt lgkmcnt(7)
  v_mfma_f32_32x32x16_bf16 v[112:127], v[140:143], a[72:75], v[112:127]
  ds_read_b128 v[140:143], v3 offset:19456
  s_waitcnt vmcnt(12) lgkmcnt(7)
  v_mfma_f32_32x32x16_bf16 v[64:79], v[144:147], a[76:79], v[64:79]
  ds_read_b128 v[144:147], v3 offset:20480
  s_waitcnt lgkmcnt(7)
  v_mfma_f32_32x32x16_bf16 v[80:95], v[148:151], a[76:79], v[80:95]
  ds_read_b128 v[148:151], v3 offset:21504
  s_waitcnt lgkmcnt(7)
  v_mfma_f32_32x32x16_bf16 v[96:111], v[152:155], a[76:79], v[96:111]
  ds_read_b128 v[152:155], v3 offset:22528
  s_waitcnt lgkmcnt(7)
  v_mfma_f32_32x32x16_bf16 v[112:127], v[156:159], a[76:79], v[112:127]
  ds_read_b128 v[156:159], v3 offset:23552
  s_waitcnt vmcnt(11) lgkmcnt(7)
  v_mfma_f32_32x32x16_bf16 v[64:79], v[128:131], a[80:83], v[64:79]
  ds_read_b128 v[128:131], v3 offset:24576
  s_waitcnt lgkmcnt(7)
  v_mfma_f32_32x32x16_bf16 v[80:95], v[132:135], a[80:83], v[80:95]
  ds_read_b128 v[132:135], v3 offset:25600
  s_waitcnt lgkmcnt(7)
  v_mfma_f32_32x32x16_bf16 v[96:111], v[136:139], a[80:83], v[96:111]
  ds_read_b128 v[136:139], v3 offset:26624
  s_waitcnt lgkmcnt(7)
  v_mfma_f32_32x32x16_bf16 v[112:127], v[140:143], a[80:83], v[112:127]
  ds_read_b128 v[140:143], v3 offset:27648
  s_waitcnt vmcnt(10) lgkmcnt(7)
  v_mfma_f32_32x32x16_bf16 v[64:79], v[144:147], a[84:87], v[64:79]
  ds_read_b128 v[144:147], v3 offset:28672
  s_waitcnt lgkmcnt(7)
  v_mfma_f32_32x32x16_bf16 v[80:95], v[148:151], a[84:87], v[80:95]
  ds_read_b128 v[148:151], v3 offset:29696
  s_waitcnt lgkmcnt(7)
  v_mfma_f32_32x32x16_bf16 v[96:111], v[152:155], a[84:87], v[96:111]
  ds_read_b128 v[152:155], v3 offset:30720
  s_waitcnt lgkmcnt(7)
  v_mfma_f32_32x32x16_bf16 v[112:127], v[156:159], a[84:87], v[112:127]
  ds_read_b128 v[156:159], v3 offset:31744
  s_waitcnt vmcnt(9) lgkmcnt(7)
  v_mfma_f32_32x32x16_bf16 v[64:79], v[128:131], a[88:91], v[64:79]
  ds_read_b128 v[128:131], v3 offset:32768
  s_waitcnt lgkmcnt(7)
  v_mfma_f32_32x32x16_bf16 v[80:95], v[132:135], a[88:91], v[80:95]
  ds_read_b128 v[132:135], v3 offset:33792
  s_waitcnt lgkmcnt(7)
  v_mfma_f32_32x32x16_bf16 v[96:111], v[136:139], a[88:91], v[96:111]
  ds_read_b128 v[136:139], v3 offset:34816
  s_waitcnt lgkmcnt(7)
  v_mfma_f32_32x32x16_bf16 v[112:127], v[140:143], a[88:91], v[112:127]
  ds_read_b128 v[140:143], v3 offset:35840
  s_waitcnt vmcnt(8) lgkmcnt(7)
  v_mfma_f32_32x32x16_bf16 v[64:79], v[144:147], a[92:95], v[64:79]
  ds_read_b128 v[144:147], v3 offset:36864
  s_waitcnt lgkmcnt(7)
  v_mfma_f32_32x32x16_bf16 v[80:95], v[148:151], a[92:95], v[80:95]
  ds_read_b128 v[148:151], v3 offset:37888
  s_waitcnt lgkmcnt(7)
  v_mfma_f32_32x32x16_bf16 v[96:111], v[152:155], a[92:95], v[96:111]
  ds_read_b128 v[152:155], v3 offset:38912
  s_waitcnt lgkmcnt(7)
  v_mfma_f32_32x32x16_bf16 v[112:127], v[156:159], a[92:95], v[112:127]
  ds_read_b128 v[156:159], v3 offset:39936
  s_waitcnt vmcnt(7) lgkmcnt(7)
  v_mfma_f32_32x32x16_bf16 v[64:79], v[128:131], a[96:99], v[64:79]
  ds_read_b128 v[128:131], v3 offset:40960
  s_waitcnt lgkmcnt(7)
  v_mfma_f32_32x32x16_bf16 v[80:95], v[132:135], a[96:99], v[80:95]
  ds_read_b128 v[132:135], v3 offset:41984
  s_waitcnt lgkmcnt(7)
  v_mfma_f32_32x32x16_bf16 v[96:111], v[136:139], a[96:99], v[96:111]
  ds_read_b128 v[136:139], v3 offset:43008
  s_waitcnt lgkmcnt(7)
  v_mfma_f32_32x32x16_bf16 v[112:127], v[140:143], a[96:99], v[112:127]
  ds_read_b128 v[140:143], v3 offset:44032
  s_waitcnt vmcnt(6) lgkmcnt(7)
  v_mfma_f32_32x32x16_bf16 v[64:79], v[144:147], a[100:103], v[64:79]
  ds_read_b128 v[144:147], v3 offset:45056
  s_waitcnt lgkmcnt(7)
  v_mfma_f32_32x32x16_bf16 v[80:95], v[148:151], a[100:103], v[80:95]
  ds_read_b128 v[148:151], v3 offset:46080
  s_waitcnt lgkmcnt(7)
  v_mfma_f32_32x32x16_bf16 v[96:111], v[152:155], a[100:103], v[96:111]
  ds_read_b128 v[152:155], v3 offset:47104
  s_waitcnt lgkmcnt(7)
  v_mfma_f32_32x32x16_bf16 v[112:127], v[156:159], a[100:103], v[112:127]
  ds_read_b128 v[156:159], v3 offset:48128
  s_waitcnt vmcnt(5) lgkmcnt(7)
  v_mfma_f32_32x32x16_bf16 v[64:79], v[128:131], a[104:107], v[64:79]
  ds_read_b128 v[128:131], v3 offset:49152
  s_waitcnt lgkmcnt(7)
  v_mfma_f32_32x32x16_bf16 v[80:95], v[132:135], a[104:107], v[80:95]
  ds_read_b128 v[132:135], v3 offset:50176
  s_waitcnt lgkmcnt(7)
  v_mfma_f32_32x32x16_bf16 v[96:111], v[136:139], a[104:107], v[96:111]
  ds_read_b128 v[136:139], v3 offset:51200
  s_waitcnt lgkmcnt(7)
  v_mfma_f32_32x32x16_bf16 v[112:127], v[140:143], a[104:107], v[112:127]
  ds_read_b128 v[140:143], v3 offset:52224
  s_waitcnt vmcnt(4) lgkmcnt(7)
  v_mfma_f32_32x32x16_bf16 v[64:79], v[144:147], a[108:111], v[64:79]
  ds_read_b128 v[144:147], v3 offset:53248
  s_waitcnt lgkmcnt(7)
  v_mfma_f32_32x32x16_bf16 v[80:95], v[148:151], a[108:111], v[80:95]
  ds_read_b128 v[148:151], v3 offset:54272
  s_waitcnt lgkmcnt(7)
  v_mfma_f32_32x32x16_bf16 v[96:111], v[152:155], a[108:111], v[96:111]
  ds_read_b128 v[152:155], v3 offset:55296
  s_waitcnt lgkmcnt(7)
  v_mfma_f32_32x32x16_bf16 v[112:127], v[156:159], a[108:111], v[112:127]
  ds_read_b128 v[156:159], v3 offset:56320
  s_waitcnt vmcnt(3) lgkmcnt(7)
  v_mfma_f32_32x32x16_bf16 v[64:79], v[128:131], a[112:115], v[64:79]
  ds_read_b128 v[128:131], v3 offset:57344
  s_waitcnt lgkmcnt(7)
  v_mfma_f32_32x32x16_bf16 v[80:95], v[132:135], a[112:115], v[80:95]
  ds_read_b128 v[132:135], v3 offset:58368
  s_waitcnt lgkmcnt(7)
  v_mfma_f32_32x32x16_bf16 v[96:111], v[136:139], a[112:115], v[96:111]
  ds_read_b128 v[136:139], v3 offset:59392
  s_waitcnt lgkmcnt(7)
  v_mfma_f32_32x32x16_bf16 v[112:127], v[140:143], a[112:115], v[112:127]
  ds_read_b128 v[140:143], v3 offset:60416
  s_waitcnt vmcnt(2) lgkmcnt(7)
  v_mfma_f32_32x32x16_bf16 v[64:79], v[144:147], a[116:119], v[64:79]
  ds_read_b128 v[144:147], v3 offset:61440
  s_waitcnt lgkmcnt(7)
  v_mfma_f32_32x32x16_bf16 v[80:95], v[148:151], a[116:119], v[80:95]
  ds_read_b128 v[148:151], v3 offset:62464
  s_waitcnt lgkmcnt(7)
  v_mfma_f32_32x32x16_bf16 v[96:111], v[152:155], a[116:119], v[96:111]
  ds_read_b128 v[152:155], v3 offset:63488
  s_waitcnt lgkmcnt(7)
  v_mfma_f32_32x32x16_bf16 v[112:127], v[156:159], a[116:119], v[112:127]
  ds_read_b128 v[156:159], v3 offset:64512
  s_waitcnt vmcnt(1) lgkmcnt(7)
  v_mfma_f32_32x32x16_bf16 v[64:79], v[128:131], a[120:123], v[64:79]
  s_waitcnt lgkmcnt(6)
  v_mfma_f32_32x32x16_bf16 v[80:95], v[132:135], a[120:123], v[80:95]
  s_waitcnt lgkmcnt(5)
  v_mfma_f32_32x32x16_bf16 v[96:111], v[136:139], a[120:123], v[96:111]
  s_waitcnt lgkmcnt(4)
  v_mfma_f32_32x32x16_bf16 v[112:127], v[140:143], a[120:123], v[112:127]
  s_waitcnt vmcnt(0) lgkmcnt(3)
  v_mfma_f32_32x32x16_bf16 v[64:79], v[144:147], a[124:127], v[64:79]
  s_waitcnt lgkmcnt(2)
  v_mfma_f32_32x32x16_bf16 v[80:95], v[148:151], a[124:127], v[80:95]
  s_waitcnt lgkmcnt(1)
  v_mfma_f32_32x32x16_bf16 v[96:111], v[152:155], a[124:127], v[96:111]
  s_waitcnt lgkmcnt(0)
  v_mfma_f32_32x32x16_bf16 v[112:127], v[156:159], a[124:127], v[112:127]
  s_nop 15
  v_mov_b32 v6, s66
  v_mul_f32 v160, v64, v64
  v_mul_f32 v161, v65, v65
  v_mul_f32 v162, v66, v66
  v_mul_f32 v163, v67, v67
  v_mul_f32 v164, v68, v68
  v_mul_f32 v165, v69, v69
  v_mul_f32 v166, v70, v70
  v_mul_f32 v167, v71, v71
  v_fma_f32 v160, v160, s67, v6
  v_fma_f32 v161, v161, s67, v6
  v_fma_f32 v162, v162, s67, v6
  v_fma_f32 v163, v163, s67, v6
  v_fma_f32 v164, v164, s67, v6
  v_fma_f32 v165, v165, s67, v6
  v_fma_f32 v166, v166, s67, v6
  v_fma_f32 v167, v167, s67, v6
  v_mul_f32 v160, v160, v64
  v_mul_f32 v161, v161, v65
  v_mul_f32 v162, v162, v66
  v_mul_f32 v163, v163, v67
  v_mul_f32 v164, v164, v68
  v_mul_f32 v165, v165, v69
  v_mul_f32 v166, v166, v70
  v_mul_f32 v167, v167, v71
  v_exp_f32 v160, v160
  v_exp_f32 v161, v161
  v_exp_f32 v162, v162
  v_exp_f32 v163, v163
  v_exp_f32 v164, v164
  v_exp_f32 v165, v165
  v_exp_f32 v166, v166
  v_exp_f32 v167, v167
  v_mul_f32 v64, v64, v96
  v_mul_f32 v65, v65, v97
  v_mul_f32 v66, v66, v98
  v_mul_f32 v67, v67, v99
  v_mul_f32 v68, v68, v100
  v_mul_f32 v69, v69, v101
  v_mul_f32 v70, v70, v102
  v_mul_f32 v71, v71, v103
  v_add_f32 v160, 1.0, v160
  v_add_f32 v161, 1.0, v161
  v_add_f32 v162, 1.0, v162
  v_add_f32 v163, 1.0, v163
  v_add_f32 v164, 1.0, v164
  v_add_f32 v165, 1.0, v165
  v_add_f32 v166, 1.0, v166
  v_add_f32 v167, 1.0, v167
  v_rcp_f32 v160, v160
  v_rcp_f32 v161, v161
  v_rcp_f32 v162, v162
  v_rcp_f32 v163, v163
  v_rcp_f32 v164, v164
  v_rcp_f32 v165, v165
  v_rcp_f32 v166, v166
  v_rcp_f32 v167, v167
  s_nop 0
  v_mul_f32 v64, v64, v160
  v_mul_f32 v65, v65, v161
  v_mul_f32 v66, v66, v162
  v_mul_f32 v67, v67, v163
  v_mul_f32 v68, v68, v164
  v_mul_f32 v69, v69, v165
  v_mul_f32 v70, v70, v166
  v_mul_f32 v71, v71, v167
  v_mul_f32 v160, v72, v72
  v_mul_f32 v161, v73, v73
  v_mul_f32 v162, v74, v74
  v_mul_f32 v163, v75, v75
  v_mul_f32 v164, v76, v76
  v_mul_f32 v165, v77, v77
  v_mul_f32 v166, v78, v78
  v_mul_f32 v167, v79, v79
  v_fma_f32 v160, v160, s67, v6
  v_fma_f32 v161, v161, s67, v6
  v_fma_f32 v162, v162, s67, v6
  v_fma_f32 v163, v163, s67, v6
  v_fma_f32 v164, v164, s67, v6
  v_fma_f32 v165, v165, s67, v6
  v_fma_f32 v166, v166, s67, v6
  v_fma_f32 v167, v167, s67, v6
  v_mul_f32 v160, v160, v72
  v_mul_f32 v161, v161, v73
  v_mul_f32 v162, v162, v74
  v_mul_f32 v163, v163, v75
  v_mul_f32 v164, v164, v76
  v_mul_f32 v165, v165, v77
  v_mul_f32 v166, v166, v78
  v_mul_f32 v167, v167, v79
  v_exp_f32 v160, v160
  v_exp_f32 v161, v161
  v_exp_f32 v162, v162
  v_exp_f32 v163, v163
  v_exp_f32 v164, v164
  v_exp_f32 v165, v165
  v_exp_f32 v166, v166
  v_exp_f32 v167, v167
  v_mul_f32 v72, v72, v104
  v_mul_f32 v73, v73, v105
  v_mul_f32 v74, v74, v106
  v_mul_f32 v75, v75, v107
  v_mul_f32 v76, v76, v108
  v_mul_f32 v77, v77, v109
  v_mul_f32 v78, v78, v110
  v_mul_f32 v79, v79, v111
  v_add_f32 v160, 1.0, v160
  v_add_f32 v161, 1.0, v161
  v_add_f32 v162, 1.0, v162
  v_add_f32 v163, 1.0, v163
  v_add_f32 v164, 1.0, v164
  v_add_f32 v165, 1.0, v165
  v_add_f32 v166, 1.0, v166
  v_add_f32 v167, 1.0, v167
  v_rcp_f32 v160, v160
  v_rcp_f32 v161, v161
  v_rcp_f32 v162, v162
  v_rcp_f32 v163, v163
  v_rcp_f32 v164, v164
  v_rcp_f32 v165, v165
  v_rcp_f32 v166, v166
  v_rcp_f32 v167, v167
  s_nop 0
  v_mul_f32 v72, v72, v160
  v_mul_f32 v73, v73, v161
  v_mul_f32 v74, v74, v162
  v_mul_f32 v75, v75, v163
  v_mul_f32 v76, v76, v164
  v_mul_f32 v77, v77, v165
  v_mul_f32 v78, v78, v166
  v_mul_f32 v79, v79, v167
  v_mul_f32 v160, v80, v80
  v_mul_f32 v161, v81, v81
  v_mul_f32 v162, v82, v82
  v_mul_f32 v163, v83, v83
  v_mul_f32 v164, v84, v84
  v_mul_f32 v165, v85, v85
  v_mul_f32 v166, v86, v86
  v_mul_f32 v167, v87, v87
  v_fma_f32 v160, v160, s67, v6
  v_fma_f32 v161, v161, s67, v6
  v_fma_f32 v162, v162, s67, v6
  v_fma_f32 v163, v163, s67, v6
  v_fma_f32 v164, v164, s67, v6
  v_fma_f32 v165, v165, s67, v6
  v_fma_f32 v166, v166, s67, v6
  v_fma_f32 v167, v167, s67, v6
  v_mul_f32 v160, v160, v80
  v_mul_f32 v161, v161, v81
  v_mul_f32 v162, v162, v82
  v_mul_f32 v163, v163, v83
  v_mul_f32 v164, v164, v84
  v_mul_f32 v165, v165, v85
  v_mul_f32 v166, v166, v86
  v_mul_f32 v167, v167, v87
  v_exp_f32 v160, v160
  v_exp_f32 v161, v161
  v_exp_f32 v162, v162
  v_exp_f32 v163, v163
  v_exp_f32 v164, v164
  v_exp_f32 v165, v165
  v_exp_f32 v166, v166
  v_exp_f32 v167, v167
  v_mul_f32 v80, v80, v112
  v_mul_f32 v81, v81, v113
  v_mul_f32 v82, v82, v114
  v_mul_f32 v83, v83, v115
  v_mul_f32 v84, v84, v116
  v_mul_f32 v85, v85, v117
  v_mul_f32 v86, v86, v118
  v_mul_f32 v87, v87, v119
  v_add_f32 v160, 1.0, v160
  v_add_f32 v161, 1.0, v161
  v_add_f32 v162, 1.0, v162
  v_add_f32 v163, 1.0, v163
  v_add_f32 v164, 1.0, v164
  v_add_f32 v165, 1.0, v165
  v_add_f32 v166, 1.0, v166
  v_add_f32 v167, 1.0, v167
  v_rcp_f32 v160, v160
  v_rcp_f32 v161, v161
  v_rcp_f32 v162, v162
  v_rcp_f32 v163, v163
  v_rcp_f32 v164, v164
  v_rcp_f32 v165, v165
  v_rcp_f32 v166, v166
  v_rcp_f32 v167, v167
  s_nop 0
  v_mul_f32 v80, v80, v160
  v_mul_f32 v81, v81, v161
  v_mul_f32 v82, v82, v162
  v_mul_f32 v83, v83, v163
  v_mul_f32 v84, v84, v164
  v_mul_f32 v85, v85, v165
  v_mul_f32 v86, v86, v166
  v_mul_f32 v87, v87, v167
  v_mul_f32 v160, v88, v88
  v_mul_f32 v161, v89, v89
  v_mul_f32 v162, v90, v90
  v_mul_f32 v163, v91, v91
  v_mul_f32 v164, v92, v92
  v_mul_f32 v165, v93, v93
  v_mul_f32 v166, v94, v94
  v_mul_f32 v167, v95, v95
  v_fma_f32 v160, v160, s67, v6
  v_fma_f32 v161, v161, s67, v6
  v_fma_f32 v162, v162, s67, v6
  v_fma_f32 v163, v163, s67, v6
  v_fma_f32 v164, v164, s67, v6
  v_fma_f32 v165, v165, s67, v6
  v_fma_f32 v166, v166, s67, v6
  v_fma_f32 v167, v167, s67, v6
  v_mul_f32 v160, v160, v88
  v_mul_f32 v161, v161, v89
  v_mul_f32 v162, v162, v90
  v_mul_f32 v163, v163, v91
  v_mul_f32 v164, v164, v92
  v_mul_f32 v165, v165, v93
  v_mul_f32 v166, v166, v94
  v_mul_f32 v167, v167, v95
  v_exp_f32 v160, v160
  v_exp_f32 v161, v161
  v_exp_f32 v162, v162
  v_exp_f32 v163, v163
  v_exp_f32 v164, v164
  v_exp_f32 v165, v165
  v_exp_f32 v166, v166
  v_exp_f32 v167, v167
  v_mul_f32 v88, v88, v120
  v_mul_f32 v89, v89, v121
  v_mul_f32 v90, v90, v122
  v_mul_f32 v91, v91, v123
  v_mul_f32 v92, v92, v124
  v_mul_f32 v93, v93, v125
  v_mul_f32 v94, v94, v126
  v_mul_f32 v95, v95, v127
  v_add_f32 v160, 1.0, v160
  v_add_f32 v161, 1.0, v161
  v_add_f32 v162, 1.0, v162
  v_add_f32 v163, 1.0, v163
  v_add_f32 v164, 1.0, v164
  v_add_f32 v165, 1.0, v165
  v_add_f32 v166, 1.0, v166
  v_add_f32 v167, 1.0, v167
  v_rcp_f32 v160, v160
  v_rcp_f32 v161, v161
  v_rcp_f32 v162, v162
  v_rcp_f32 v163, v163
  v_rcp_f32 v164, v164
  v_rcp_f32 v165, v165
  v_rcp_f32 v166, v166
  v_rcp_f32 v167, v167
  s_nop 0
  v_mul_f32 v88, v88, v160
  v_mul_f32 v89, v89, v161
  v_mul_f32 v90, v90, v162
  v_mul_f32 v91, v91, v163
  v_mul_f32 v92, v92, v164
  v_mul_f32 v93, v93, v165
  v_mul_f32 v94, v94, v166
  v_mul_f32 v95, v95, v167
  v_cvt_pk_bf16_f32 v160, v64, v65
  v_cvt_pk_bf16_f32 v161, v66, v67
  v_cvt_pk_bf16_f32 v162, v68, v69
  v_cvt_pk_bf16_f32 v163, v70, v71
  v_cvt_pk_bf16_f32 v164, v72, v73
  v_cvt_pk_bf16_f32 v165, v74, v75
  v_cvt_pk_bf16_f32 v166, v76, v77
  v_cvt_pk_bf16_f32 v167, v78, v79
  v_cvt_pk_bf16_f32 v168, v80, v81
  v_cvt_pk_bf16_f32 v169, v82, v83
  v_cvt_pk_bf16_f32 v170, v84, v85
  v_cvt_pk_bf16_f32 v171, v86, v87
  v_cvt_pk_bf16_f32 v172, v88, v89
  v_cvt_pk_bf16_f32 v173, v90, v91
  v_cvt_pk_bf16_f32 v174, v92, v93
  v_cvt_pk_bf16_f32 v175, v94, v95
  s_mul_i32 s61, s51, 114688
  s_lshl_b32 s52, s49, 12
  s_add_u32 s61, s61, s52
  s_add_u32 s61, s61, 67108864
  buffer_store_dwordx4 v[160:163], v2, s[32:35], s61 offen offset:0 sc1
  buffer_store_dwordx4 v[164:167], v2, s[32:35], s61 offen offset:1024 sc1
  buffer_store_dwordx4 v[168:171], v2, s[32:35], s61 offen offset:2048 sc1
  buffer_store_dwordx4 v[172:175], v2, s[32:35], s61 offen offset:3072 sc1
  s_lshl_b32 s56, s48, 2
  s_lshl_b32 s57, s49, 7
  s_add_u32 s56, s56, s57
  s_add_u32 s56, s56, 12288
  s_lshr_b32 s57, s51, 2
  s_add_u32 s57, s57, 1
  s_waitcnt vmcnt(0)
  s_cmp_eq_u32 s50, 0
  s_cbranch_scc1 Lsig_41
  v_mov_b32 v4, s57
  v_mov_b32 v5, 0
  s_mov_b64 exec, 1
  buffer_store_dword v4, v5, s[32:35], s56 offen sc1
  s_mov_b64 exec, -1
Lsig_41:
  s_add_u32 s51, s51, 4
  s_cmp_lt_u32 s51, 64
  s_cbranch_scc1 LOOP_GU
  s_waitcnt vmcnt(0)
  s_endpgm
ROLE_QA:
  s_mov_b32 s36, s8
  s_mov_b32 s37, s9
  s_mov_b32 s38, 4194304
  s_mov_b32 s39, 0x00020000
  s_lshl_b32 s62, s49, 8
  v_and_b32 v7, 15, v1
  v_lshlrev_b32 v4, 4, v7
  v_lshrrev_b32 v7, 5, v1
  v_mul_u32_u24 v8, 131072, v7
  v_add_u32 v4, v4, v8
  v_bfe_u32 v9, v1, 4, 1
  v_mul_u32_u24 v8, 32768, v9
  v_add_u32 v4, v4, v8
  v_lshlrev_b32 v5, 12, v7
  v_lshl_add_u32 v5, v9, 9, v5
  v_bfe_u32 v8, v1, 2, 2
  v_lshl_add_u32 v5, v8, 10, v5
  v_and_b32 v8, 3, v1
  v_lshl_add_u32 v5, v8, 7, v5
  s_lshl_b32 s52, s48, 13
  v_add_u32 v5, s52, v5
  v_add_u32 v6, 0x10000, v5
  s_mul_i32 s52, s48, 262144
  s_add_u32 s52, s52, s62
  s_add_u32 s53, s52, 0
  buffer_load_dwordx4 v[16:19], v4, s[36:39], s53 offen
  s_add_u32 s53, s52, 8192
  buffer_load_dwordx4 v[20:23], v4, s[36:39], s53 offen
  s_add_u32 s53, s52, 16384
  buffer_load_dwordx4 v[24:27], v4, s[36:39], s53 offen
  s_add_u32 s53, s52, 24576
  buffer_load_dwordx4 v[28:31], v4, s[36:39], s53 offen
  s_add_u32 s53, s52, 65536
  buffer_load_dwordx4 v[32:35], v4, s[36:39], s53 offen
  s_add_u32 s53, s52, 73728
  buffer_load_dwordx4 v[36:39], v4, s[36:39], s53 offen
  s_add_u32 s53, s52, 81920
  buffer_load_dwordx4 v[40:43], v4, s[36:39], s53 offen
  s_add_u32 s53, s52, 90112
  buffer_load_dwordx4 v[44:47], v4, s[36:39], s53 offen
  s_add_u32 s53, s52, 1048576
  buffer_load_dwordx4 v[48:51], v4, s[36:39], s53 offen
  s_add_u32 s53, s52, 1056768
  buffer_load_dwordx4 v[52:55], v4, s[36:39], s53 offen
  s_add_u32 s53, s52, 1064960
  buffer_load_dwordx4 v[56:59], v4, s[36:39], s53 offen
  s_add_u32 s53, s52, 1073152
  buffer_load_dwordx4 v[60:63], v4, s[36:39], s53 offen
  s_add_u32 s53, s52, 1114112
  buffer_load_dwordx4 v[64:67], v4, s[36:39], s53 offen
  s_add_u32 s53, s52, 1122304
  buffer_load_dwordx4 v[68:71], v4, s[36:39], s53 offen
  s_add_u32 s53, s52, 1130496
  buffer_load_dwordx4 v[72:75], v4, s[36:39], s53 offen
  s_add_u32 s53, s52, 1138688
  buffer_load_dwordx4 v[76:79], v4, s[36:39], s53 offen
  s_add_u32 s53, s52, 2097152
  buffer_load_dwordx4 v[80:83], v4, s[36:39], s53 offen
  s_add_u32 s53, s52, 2105344
  buffer_load_dwordx4 v[84:87], v4, s[36:39], s53 offen
  s_add_u32 s53, s52, 2113536
  buffer_load_dwordx4 v[88:91], v4, s[36:39], s53 offen
  s_add_u32 s53, s52, 2121728
  buffer_load_dwordx4 v[92:95], v4, s[36:39], s53 offen
  s_add_u32 s53, s52, 2162688
  buffer_load_dwordx4 v[96:99], v4, s[36:39], s53 offen
  s_add_u32 s53, s52, 2170880
  buffer_load_dwordx4 v[100:103], v4, s[36:39], s53 offen
  s_add_u32 s53, s52, 2179072
  buffer_load_dwordx4 v[104:107], v4, s[36:39], s53 offen
  s_add_u32 s53, s52, 2187264
  buffer_load_dwordx4 v[108:111], v4, s[36:39], s53 offen
  s_add_u32 s53, s52, 3145728
  buffer_load_dwordx4 v[112:115], v4, s[36:39], s53 offen
  s_add_u32 s53, s52, 3153920
  buffer_load_dwordx4 v[116:119], v4, s[36:39], s53 offen
  s_add_u32 s53, s52, 3162112
  buffer_load_dwordx4 v[120:123], v4, s[36:39], s53 offen
  s_add_u32 s53, s52, 3170304
  buffer_load_dwordx4 v[124:127], v4, s[36:39], s53 offen
  s_add_u32 s53, s52, 3211264
  buffer_load_dwordx4 v[128:131], v4, s[36:39], s53 offen
  s_add_u32 s53, s52, 3219456
  buffer_load_dwordx4 v[132:135], v4, s[36:39], s53 offen
  s_add_u32 s53, s52, 3227648
  buffer_load_dwordx4 v[136:139], v4, s[36:39], s53 offen
  s_add_u32 s53, s52, 3235840
  buffer_load_dwordx4 v[140:143], v4, s[36:39], s53 offen
Lwl_skip_42:
  s_waitcnt vmcnt(0)
  v_perm_b32 v144, v20, v16, s64
  v_perm_b32 v145, v28, v24, s64
  v_perm_b32 v146, v36, v32, s64
  v_perm_b32 v147, v44, v40, s64
  ds_write_b128 v5, v[144:147] offset:0
  v_perm_b32 v148, v20, v16, s65
  v_perm_b32 v149, v28, v24, s65
  v_perm_b32 v150, v36, v32, s65
  v_perm_b32 v151, v44, v40, s65
  ds_write_b128 v5, v[148:151] offset:16
  v_perm_b32 v152, v21, v17, s64
  v_perm_b32 v153, v29, v25, s64
  v_perm_b32 v154, v37, v33, s64
  v_perm_b32 v155, v45, v41, s64
  ds_write_b128 v5, v[152:155] offset:32
  v_perm_b32 v156, v21, v17, s65
  v_perm_b32 v157, v29, v25, s65
  v_perm_b32 v158, v37, v33, s65
  v_perm_b32 v159, v45, v41, s65
  ds_write_b128 v5, v[156:159] offset:48
  s_waitcnt lgkmcnt(0)
  v_perm_b32 v144, v22, v18, s64
  v_perm_b32 v145, v30, v26, s64
  v_perm_b32 v146, v38, v34, s64
  v_perm_b32 v147, v46, v42, s64
  ds_write_b128 v5, v[144:147] offset:64
  v_perm_b32 v148, v22, v18, s65
  v_perm_b32 v149, v30, v26, s65
  v_perm_b32 v150, v38, v34, s65
  v_perm_b32 v151, v46, v42, s65
  ds_write_b128 v5, v[148:151] offset:80
  v_perm_b32 v152, v23, v19, s64
  v_perm_b32 v153, v31, v27, s64
  v_perm_b32 v154, v39, v35, s64
  v_perm_b32 v155, v47, v43, s64
  ds_write_b128 v5, v[152:155] offset:96
  v_perm_b32 v156, v23, v19, s65
  v_perm_b32 v157, v31, v27, s65
  v_perm_b32 v158, v39, v35, s65
  v_perm_b32 v159, v47, v43, s65
  ds_write_b128 v5, v[156:159] offset:112
  s_waitcnt lgkmcnt(0)
  v_perm_b32 v144, v52, v48, s64
  v_perm_b32 v145, v60, v56, s64
  v_perm_b32 v146, v68, v64, s64
  v_perm_b32 v147, v76, v72, s64
  ds_write_b128 v5, v[144:147] offset:32768
  v_perm_b32 v148, v52, v48, s65
  v_perm_b32 v149, v60, v56, s65
  v_perm_b32 v150, v68, v64, s65
  v_perm_b32 v151, v76, v72, s65
  ds_write_b128 v5, v[148:151] offset:32784
  v_perm_b32 v152, v53, v49, s64
  v_perm_b32 v153, v61, v57, s64
  v_perm_b32 v154, v69, v65, s64
  v_perm_b32 v155, v77, v73, s64
  ds_write_b128 v5, v[152:155] offset:32800
  v_perm_b32 v156, v53, v49, s65
  v_perm_b32 v157, v61, v57, s65
  v_perm_b32 v158, v69, v65, s65
  v_perm_b32 v159, v77, v73, s65
  ds_write_b128 v5, v[156:159] offset:32816
  s_waitcnt lgkmcnt(0)
  v_perm_b32 v144, v54, v50, s64
  v_perm_b32 v145, v62, v58, s64
  v_perm_b32 v146, v70, v66, s64
  v_perm_b32 v147, v78, v74, s64
  ds_write_b128 v5, v[144:147] offset:32832
  v_perm_b32 v148, v54, v50, s65
  v_perm_b32 v149, v62, v58, s65
  v_perm_b32 v150, v70, v66, s65
  v_perm_b32 v151, v78, v74, s65
  ds_write_b128 v5, v[148:151] offset:32848
  v_perm_b32 v152, v55, v51, s64
  v_perm_b32 v153, v63, v59, s64
  v_perm_b32 v154, v71, v67, s64
  v_perm_b32 v155, v79, v75, s64
  ds_write_b128 v5, v[152:155] offset:32864
  v_perm_b32 v156, v55, v51, s65
  v_perm_b32 v157, v63, v59, s65
  v_perm_b32 v158, v71, v67, s65
  v_perm_b32 v159, v79, v75, s65
  ds_write_b128 v5, v[156:159] offset:32880
  s_waitcnt lgkmcnt(0)
  v_perm_b32 v144, v84, v80, s64
  v_perm_b32 v145, v92, v88, s64
  v_perm_b32 v146, v100, v96, s64
  v_perm_b32 v147, v108, v104, s64
  ds_write_b128 v6, v[144:147] offset:0
  v_perm_b32 v148, v84, v80, s65
  v_perm_b32 v149, v92, v88, s65
  v_perm_b32 v150, v100, v96, s65
  v_perm_b32 v151, v108, v104, s65
  ds_write_b128 v6, v[148:151] offset:16
  v_perm_b32 v152, v85, v81, s64
  v_perm_b32 v153, v93, v89, s64
  v_perm_b32 v154, v101, v97, s64
  v_perm_b32 v155, v109, v105, s64
  ds_write_b128 v6, v[152:155] offset:32
  v_perm_b32 v156, v85, v81, s65
  v_perm_b32 v157, v93, v89, s65
  v_perm_b32 v158, v101, v97, s65
  v_perm_b32 v159, v109, v105, s65
  ds_write_b128 v6, v[156:159] offset:48
  s_waitcnt lgkmcnt(0)
  v_perm_b32 v144, v86, v82, s64
  v_perm_b32 v145, v94, v90, s64
  v_perm_b32 v146, v102, v98, s64
  v_perm_b32 v147, v110, v106, s64
  ds_write_b128 v6, v[144:147] offset:64
  v_perm_b32 v148, v86, v82, s65
  v_perm_b32 v149, v94, v90, s65
  v_perm_b32 v150, v102, v98, s65
  v_perm_b32 v151, v110, v106, s65
  ds_write_b128 v6, v[148:151] offset:80
  v_perm_b32 v152, v87, v83, s64
  v_perm_b32 v153, v95, v91, s64
  v_perm_b32 v154, v103, v99, s64
  v_perm_b32 v155, v111, v107, s64
  ds_write_b128 v6, v[152:155] offset:96
  v_perm_b32 v156, v87, v83, s65
  v_perm_b32 v157, v95, v91, s65
  v_perm_b32 v158, v103, v99, s65
  v_perm_b32 v159, v111, v107, s65
  ds_write_b128 v6, v[156:159] offset:112
  s_waitcnt lgkmcnt(0)
  v_perm_b32 v144, v116, v112, s64
  v_perm_b32 v145, v124, v120, s64
  v_perm_b32 v146, v132, v128, s64
  v_perm_b32 v147, v140, v136, s64
  ds_write_b128 v6, v[144:147] offset:32768
  v_perm_b32 v148, v116, v112, s65
  v_perm_b32 v149, v124, v120, s65
  v_perm_b32 v150, v132, v128, s65
  v_perm_b32 v151, v140, v136, s65
  ds_write_b128 v6, v[148:151] offset:32784
  v_perm_b32 v152, v117, v113, s64
  v_perm_b32 v153, v125, v121, s64
  v_perm_b32 v154, v133, v129, s64
  v_perm_b32 v155, v141, v137, s64
  ds_write_b128 v6, v[152:155] offset:32800
  v_perm_b32 v156, v117, v113, s65
  v_perm_b32 v157, v125, v121, s65
  v_perm_b32 v158, v133, v129, s65
  v_perm_b32 v159, v141, v137, s65
  ds_write_b128 v6, v[156:159] offset:32816
  s_waitcnt lgkmcnt(0)
  v_perm_b32 v144, v118, v114, s64
  v_perm_b32 v145, v126, v122, s64
  v_perm_b32 v146, v134, v130, s64
  v_perm_b32 v147, v142, v138, s64
  ds_write_b128 v6, v[144:147] offset:32832
  v_perm_b32 v148, v118, v114, s65
  v_perm_b32 v149, v126, v122, s65
  v_perm_b32 v150, v134, v130, s65
  v_perm_b32 v151, v142, v138, s65
  ds_write_b128 v6, v[148:151] offset:32848
  v_perm_b32 v152, v119, v115, s64
  v_perm_b32 v153, v127, v123, s64
  v_perm_b32 v154, v135, v131, s64
  v_perm_b32 v155, v143, v139, s64
  ds_write_b128 v6, v[152:155] offset:32864
  v_perm_b32 v156, v119, v115, s65
  v_perm_b32 v157, v127, v123, s65
  v_perm_b32 v158, v135, v131, s65
  v_perm_b32 v159, v143, v139, s65
  ds_write_b128 v6, v[156:159] offset:32880
  s_waitcnt lgkmcnt(0)
Lwl_skip2_43:
  s_cmp_lg_u32 s48, 0
  s_cbranch_scc1 Lwi_44
  v_mov_b32 v4, 0
  s_mov_b32 s56, 128
  s_mov_b32 s57, 47
  s_cmp_eq_u32 s50, 0
  s_cbranch_scc1 Lwaitd_46
  s_mov_b32 s52, 0
  s_mov_b32 s54, 1
  s_mov_b32 s55, 0
Lwait_45:
  buffer_load_dword v5, v4, s[44:47], s56 offen sc1
  s_add_u32 s52, s52, 1
  s_cmp_gt_u32 s52, 65536
  s_cbranch_scc1 Lwaitd_46
  s_waitcnt vmcnt(0)
  v_cmp_gt_u32 vcc, v5, s57
  s_and_b64 vcc, vcc, s[54:55]
  s_cmp_eq_u64 vcc, s[54:55]
  s_cbranch_scc1 Lwaitd_46
  s_sleep 2
  s_branch Lwait_45
Lwaitd_46:
  s_waitcnt vmcnt(0)
Lwi_44:
  s_waitcnt lgkmcnt(0)
  s_barrier
  v_and_b32 v4, 31, v1
  v_lshrrev_b32 v5, 5, v1
  v_lshlrev_b32 v5, 2, v5
  v_sub_u32 v4, v4, v5
  v_cmp_le_i32 s[66:67], 0, v4
  v_cmp_le_i32 s[68:69], 1, v4
  v_cmp_le_i32 s[70:71], 2, v4
  v_cmp_le_i32 s[72:73], 3, v4
  v_cmp_le_i32 s[74:75], 8, v4
  v_cmp_le_i32 s[76:77], 9, v4
  v_cmp_le_i32 s[78:79], 10, v4
  v_cmp_le_i32 s[80:81], 11, v4
  v_cmp_le_i32 s[82:83], 16, v4
  v_cmp_le_i32 s[84:85], 17, v4
  v_cmp_le_i32 s[86:87], 18, v4
  v_cmp_le_i32 s[88:89], 19, v4
  v_cmp_le_i32 s[90:91], 24, v4
  v_cmp_le_i32 s[92:93], 25, v4
  v_cmp_le_i32 s[94:95], 26, v4
  v_cmp_le_i32 s[96:97], 27, v4
  v_and_b32 v6, 7, v1
  v_mul_u32_u24 v6, 256, v6
  v_lshrrev_b32 v5, 5, v1
  v_lshl_add_u32 v6, v5, 4, v6
  v_and_b32 v7, 31, v1
  v_lshlrev_b32 v7, 2, v7
  v_lshl_add_u32 v7, v5, 8, v7
  v_add_u32 v3, 0x10000, v2
  s_mov_b32 s51, s48
LOOP_QA:
  s_lshl_b32 s56, s51, 8
  s_add_u32 s56, s56, 32768
  s_mov_b32 s57, 0
  v_min_u32 v4, 3, v1
  v_lshlrev_b32 v4, 6, v4
  s_cmp_eq_u32 s50, 0
  s_cbranch_scc1 Lwaitd_48
  s_mov_b32 s52, 0
  s_mov_b32 s54, 15
  s_mov_b32 s55, 0
Lwait_47:
  buffer_load_dword v5, v4, s[32:35], s56 offen sc1
  s_add_u32 s52, s52, 1
  s_cmp_gt_u32 s52, 65536
  s_cbranch_scc1 Lwaitd_48
  s_waitcnt vmcnt(0)
  v_cmp_gt_u32 vcc, v5, s57
  s_and_b64 vcc, vcc, s[54:55]
  s_cmp_eq_u64 vcc, s[54:55]
  s_cbranch_scc1 Lwaitd_48
  s_sleep 2
  s_branch Lwait_47
Lwaitd_48:
  s_waitcnt vmcnt(0)
  s_lshl_b32 s60, s51, 15
  s_add_u32 s60, s60, 1048576
  buffer_load_dwordx4 a[0:3], v2, s[32:35], s60 offen offset:0 sc1
  buffer_load_dwordx4 a[4:7], v2, s[32:35], s60 offen offset:1024 sc1
  buffer_load_dwordx4 a[8:11], v2, s[32:35], s60 offen offset:2048 sc1
  buffer_load_dwordx4 a[12:15], v2, s[32:35], s60 offen offset:3072 sc1
  s_add_u32 s60, s60, 4096
  buffer_load_dwordx4 a[16:19], v2, s[32:35], s60 offen offset:0 sc1
  buffer_load_dwordx4 a[20:23], v2, s[32:35], s60 offen offset:1024 sc1
  buffer_load_dwordx4 a[24:27], v2, s[32:35], s60 offen offset:2048 sc1
  buffer_load_dwordx4 a[28:31], v2, s[32:35], s60 offen offset:3072 sc1
  s_add_u32 s60, s60, 4096
  buffer_load_dwordx4 a[32:35], v2, s[32:35], s60 offen offset:0 sc1
  buffer_load_dwordx4 a[36:39], v2, s[32:35], s60 offen offset:1024 sc1
  buffer_load_dwordx4 a[40:43], v2, s[32:35], s60 offen offset:2048 sc1
  buffer_load_dwordx4 a[44:47], v2, s[32:35], s60 offen offset:3072 sc1
  s_add_u32 s60, s60, 4096
  buffer_load_dwordx4 a[48:51], v2, s[32:35], s60 offen offset:0 sc1
  buffer_load_dwordx4 a[52:55], v2, s[32:35], s60 offen offset:1024 sc1
  buffer_load_dwordx4 a[56:59], v2, s[32:35], s60 offen offset:2048 sc1
  buffer_load_dwordx4 a[60:63], v2, s[32:35], s60 offen offset:3072 sc1
  s_add_u32 s60, s60, 4096
  buffer_load_dwordx4 a[64:67], v2, s[32:35], s60 offen offset:0 sc1
  buffer_load_dwordx4 a[68:71], v2, s[32:35], s60 offen offset:1024 sc1
  buffer_load_dwordx4 a[72:75], v2, s[32:35], s60 offen offset:2048 sc1
  buffer_load_dwordx4 a[76:79], v2, s[32:35], s60 offen offset:3072 sc1
  s_add_u32 s60, s60, 4096
  buffer_load_dwordx4 a[80:83], v2, s[32:35], s60 offen offset:0 sc1
  buffer_load_dwordx4 a[84:87], v2, s[32:35], s60 offen offset:1024 sc1
  buffer_load_dwordx4 a[88:91], v2, s[32:35], s60 offen offset:2048 sc1
  buffer_load_dwordx4 a[92:95], v2, s[32:35], s60 offen offset:3072 sc1
  s_add_u32 s60, s60, 4096
  buffer_load_dwordx4 a[96:99], v2, s[32:35], s60 offen offset:0 sc1
  buffer_load_dwordx4 a[100:103], v2, s[32:35], s60 offen offset:1024 sc1
  buffer_load_dwordx4 a[104:107], v2, s[32:35], s60 offen offset:2048 sc1
  buffer_load_dwordx4 a[108:111], v2, s[32:35], s60 offen offset:3072 sc1
  s_add_u32 s60, s60, 4096
  buffer_load_dwordx4 a[112:115], v2, s[32:35], s60 offen offset:0 sc1
  buffer_load_dwordx4 a[116:119], v2, s[32:35], s60 offen offset:1024 sc1
  buffer_load_dwordx4 a[120:123], v2, s[32:35], s60 offen offset:2048 sc1
  buffer_load_dwordx4 a[124:127], v2, s[32:35], s60 offen offset:3072 sc1
  ds_read_b128 v[128:131], v2 offset:0
  ds_read_b128 v[132:135], v2 offset:1024
  ds_read_b128 v[136:139], v2 offset:2048
  ds_read_b128 v[140:143], v2 offset:3072
  ds_read_b128 v[144:147], v2 offset:4096
  ds_read_b128 v[148:151], v2 offset:5120
  ds_read_b128 v[152:155], v2 offset:6144
  ds_read_b128 v[156:159], v2 offset:7168
  s_waitcnt vmcnt(31) lgkmcnt(7)
  v_mfma_f32_32x32x16_bf16 v[64:79], v[128:131], a[0:3], 0
  ds_read_b128 v[128:131], v2 offset:8192
  s_waitcnt lgkmcnt(7)
  v_mfma_f32_32x32x16_bf16 v[80:95], v[132:135], a[0:3], 0
  ds_read_b128 v[132:135], v2 offset:9216
  s_waitcnt lgkmcnt(7)
  v_mfma_f32_32x32x16_bf16 v[96:111], v[136:139], a[0:3], 0
  ds_read_b128 v[136:139], v2 offset:10240
  s_waitcnt lgkmcnt(7)
  v_mfma_f32_32x32x16_bf16 v[112:127], v[140:143], a[0:3], 0
  ds_read_b128 v[140:143], v2 offset:11264
  s_waitcnt vmcnt(30) lgkmcnt(7)
  v_mfma_f32_32x32x16_bf16 v[64:79], v[144:147], a[4:7], v[64:79]
  ds_read_b128 v[144:147], v2 offset:12288
  s_waitcnt lgkmcnt(7)
  v_mfma_f32_32x32x16_bf16 v[80:95], v[148:151], a[4:7], v[80:95]
  ds_read_b128 v[148:151], v2 offset:13312
  s_waitcnt lgkmcnt(7)
  v_mfma_f32_32x32x16_bf16 v[96:111], v[152:155], a[4:7], v[96:111]
  ds_read_b128 v[152:155], v2 offset:14336
  s_waitcnt lgkmcnt(7)
  v_mfma_f32_32x32x16_bf16 v[112:127], v[156:159], a[4:7], v[112:127]
  ds_read_b128 v[156:159], v2 offset:15360
  s_waitcnt vmcnt(29) lgkmcnt(7)
  v_mfma_f32_32x32x16_bf16 v[64:79], v[128:131], a[8:11], v[64:79]
  ds_read_b128 v[128:131], v2 offset:16384
  s_waitcnt lgkmcnt(7)
  v_mfma_f32_32x32x16_bf16 v[80:95], v[132:135], a[8:11], v[80:95]
  ds_read_b128 v[132:135], v2 offset:17408
  s_waitcnt lgkmcnt(7)
  v_mfma_f32_32x32x16_bf16 v[96:111], v[136:139], a[8:11], v[96:111]
  ds_read_b128 v[136:139], v2 offset:18432
  s_waitcnt lgkmcnt(7)
  v_mfma_f32_32x32x16_bf16 v[112:127], v[140:143], a[8:11], v[112:127]
  ds_read_b128 v[140:143], v2 offset:19456
  s_waitcnt vmcnt(28) lgkmcnt(7)
  v_mfma_f32_32x32x16_bf16 v[64:79], v[144:147], a[12:15], v[64:79]
  ds_read_b128 v[144:147], v2 offset:20480
  s_waitcnt lgkmcnt(7)
  v_mfma_f32_32x32x16_bf16 v[80:95], v[148:151], a[12:15], v[80:95]
  ds_read_b128 v[148:151], v2 offset:21504
  s_waitcnt lgkmcnt(7)
  v_mfma_f32_32x32x16_bf16 v[96:111], v[152:155], a[12:15], v[96:111]
  ds_read_b128 v[152:155], v2 offset:22528
  s_waitcnt lgkmcnt(7)
  v_mfma_f32_32x32x16_bf16 v[112:127], v[156:159], a[12:15], v[112:127]
  ds_read_b128 v[156:159], v2 offset:23552
  s_waitcnt vmcnt(27) lgkmcnt(7)
  v_mfma_f32_32x32x16_bf16 v[64:79], v[128:131], a[16:19], v[64:79]
  ds_read_b128 v[128:131], v2 offset:24576
  s_waitcnt lgkmcnt(7)
  v_mfma_f32_32x32x16_bf16 v[80:95], v[132:135], a[16:19], v[80:95]
  ds_read_b128 v[132:135], v2 offset:25600
  s_waitcnt lgkmcnt(7)
  v_mfma_f32_32x32x16_bf16 v[96:111], v[136:139], a[16:19], v[96:111]
  ds_read_b128 v[136:139], v2 offset:26624
  s_waitcnt lgkmcnt(7)
  v_mfma_f32_32x32x16_bf16 v[112:127], v[140:143], a[16:19], v[112:127]
  ds_read_b128 v[140:143], v2 offset:27648
  s_waitcnt vmcnt(26) lgkmcnt(7)
  v_mfma_f32_32x32x16_bf16 v[64:79], v[144:147], a[20:23], v[64:79]
  ds_read_b128 v[144:147], v2 offset:28672
  s_waitcnt lgkmcnt(7)
  v_mfma_f32_32x32x16_bf16 v[80:95], v[148:151], a[20:23], v[80:95]
  ds_read_b128 v[148:151], v2 offset:29696
  s_waitcnt lgkmcnt(7)
  v_mfma_f32_32x32x16_bf16 v[96:111], v[152:155], a[20:23], v[96:111]
  ds_read_b128 v[152:155], v2 offset:30720
  s_waitcnt lgkmcnt(7)
  v_mfma_f32_32x32x16_bf16 v[112:127], v[156:159], a[20:23], v[112:127]
  ds_read_b128 v[156:159], v2 offset:31744
  s_waitcnt vmcnt(25) lgkmcnt(7)
  v_mfma_f32_32x32x16_bf16 v[64:79], v[128:131], a[24:27], v[64:79]
  ds_read_b128 v[128:131], v2 offset:32768
  s_waitcnt lgkmcnt(7)
  v_mfma_f32_32x32x16_bf16 v[80:95], v[132:135], a[24:27], v[80:95]
  ds_read_b128 v[132:135], v2 offset:33792
  s_waitcnt lgkmcnt(7)
  v_mfma_f32_32x32x16_bf16 v[96:111], v[136:139], a[24:27], v[96:111]
  ds_read_b128 v[136:139], v2 offset:34816
  s_waitcnt lgkmcnt(7)
  v_mfma_f32_32x32x16_bf16 v[112:127], v[140:143], a[24:27], v[112:127]
  ds_read_b128 v[140:143], v2 offset:35840
  s_waitcnt vmcnt(24) lgkmcnt(7)
  v_mfma_f32_32x32x16_bf16 v[64:79], v[144:147], a[28:31], v[64:79]
  ds_read_b128 v[144:147], v2 offset:36864
  s_waitcnt lgkmcnt(7)
  v_mfma_f32_32x32x16_bf16 v[80:95], v[148:151], a[28:31], v[80:95]
  ds_read_b128 v[148:151], v2 offset:37888
  s_waitcnt lgkmcnt(7)
  v_mfma_f32_32x32x16_bf16 v[96:111], v[152:155], a[28:31], v[96:111]
  ds_read_b128 v[152:155], v2 offset:38912
  s_waitcnt lgkmcnt(7)
  v_mfma_f32_32x32x16_bf16 v[112:127], v[156:159], a[28:31], v[112:127]
  ds_read_b128 v[156:159], v2 offset:39936
  s_waitcnt vmcnt(23) lgkmcnt(7)
  v_mfma_f32_32x32x16_bf16 v[64:79], v[128:131], a[32:35], v[64:79]
  ds_read_b128 v[128:131], v2 offset:40960
  s_waitcnt lgkmcnt(7)
  v_mfma_f32_32x32x16_bf16 v[80:95], v[132:135], a[32:35], v[80:95]
  ds_read_b128 v[132:135], v2 offset:41984
  s_waitcnt lgkmcnt(7)
  v_mfma_f32_32x32x16_bf16 v[96:111], v[136:139], a[32:35], v[96:111]
  ds_read_b128 v[136:139], v2 offset:43008
  s_waitcnt lgkmcnt(7)
  v_mfma_f32_32x32x16_bf16 v[112:127], v[140:143], a[32:35], v[112:127]
  ds_read_b128 v[140:143], v2 offset:44032
  s_waitcnt vmcnt(22) lgkmcnt(7)
  v_mfma_f32_32x32x16_bf16 v[64:79], v[144:147], a[36:39], v[64:79]
  ds_read_b128 v[144:147], v2 offset:45056
  s_waitcnt lgkmcnt(7)
  v_mfma_f32_32x32x16_bf16 v[80:95], v[148:151], a[36:39], v[80:95]
  ds_read_b128 v[148:151], v2 offset:46080
  s_waitcnt lgkmcnt(7)
  v_mfma_f32_32x32x16_bf16 v[96:111], v[152:155], a[36:39], v[96:111]
  ds_read_b128 v[152:155], v2 offset:47104
  s_waitcnt lgkmcnt(7)
  v_mfma_f32_32x32x16_bf16 v[112:127], v[156:159], a[36:39], v[112:127]
  ds_read_b128 v[156:159], v2 offset:48128
  s_waitcnt vmcnt(21) lgkmcnt(7)
  v_mfma_f32_32x32x16_bf16 v[64:79], v[128:131], a[40:43], v[64:79]
  ds_read_b128 v[128:131], v2 offset:49152
  s_waitcnt lgkmcnt(7)
  v_mfma_f32_32x32x16_bf16 v[80:95], v[132:135], a[40:43], v[80:95]
  ds_read_b128 v[132:135], v2 offset:50176
  s_waitcnt lgkmcnt(7)
  v_mfma_f32_32x32x16_bf16 v[96:111], v[136:139], a[40:43], v[96:111]
  ds_read_b128 v[136:139], v2 offset:51200
  s_waitcnt lgkmcnt(7)
  v_mfma_f32_32x32x16_bf16 v[112:127], v[140:143], a[40:43], v[112:127]
  ds_read_b128 v[140:143], v2 offset:52224
  s_waitcnt vmcnt(20) lgkmcnt(7)
  v_mfma_f32_32x32x16_bf16 v[64:79], v[144:147], a[44:47], v[64:79]
  ds_read_b128 v[144:147], v2 offset:53248
  s_waitcnt lgkmcnt(7)
  v_mfma_f32_32x32x16_bf16 v[80:95], v[148:151], a[44:47], v[80:95]
  ds_read_b128 v[148:151], v2 offset:54272
  s_waitcnt lgkmcnt(7)
  v_mfma_f32_32x32x16_bf16 v[96:111], v[152:155], a[44:47], v[96:111]
  ds_read_b128 v[152:155], v2 offset:55296
  s_waitcnt lgkmcnt(7)
  v_mfma_f32_32x32x16_bf16 v[112:127], v[156:159], a[44:47], v[112:127]
  ds_read_b128 v[156:159], v2 offset:56320
  s_waitcnt vmcnt(19) lgkmcnt(7)
  v_mfma_f32_32x32x16_bf16 v[64:79], v[128:131], a[48:51], v[64:79]
  ds_read_b128 v[128:131], v2 offset:57344
  s_waitcnt lgkmcnt(7)
  v_mfma_f32_32x32x16_bf16 v[80:95], v[132:135], a[48:51], v[80:95]
  ds_read_b128 v[132:135], v2 offset:58368
  s_waitcnt lgkmcnt(7)
  v_mfma_f32_32x32x16_bf16 v[96:111], v[136:139], a[48:51], v[96:111]
  ds_read_b128 v[136:139], v2 offset:59392
  s_waitcnt lgkmcnt(7)
  v_mfma_f32_32x32x16_bf16 v[112:127], v[140:143], a[48:51], v[112:127]
  ds_read_b128 v[140:143], v2 offset:60416
  s_waitcnt vmcnt(18) lgkmcnt(7)
  v_mfma_f32_32x32x16_bf16 v[64:79], v[144:147], a[52:55], v[64:79]
  ds_read_b128 v[144:147], v2 offset:61440
  s_waitcnt lgkmcnt(7)
  v_mfma_f32_32x32x16_bf16 v[80:95], v[148:151], a[52:55], v[80:95]
  ds_read_b128 v[148:151], v2 offset:62464
  s_waitcnt lgkmcnt(7)
  v_mfma_f32_32x32x16_bf16 v[96:111], v[152:155], a[52:55], v[96:111]
  ds_read_b128 v[152:155], v2 offset:63488
  s_waitcnt lgkmcnt(7)
  v_mfma_f32_32x32x16_bf16 v[112:127], v[156:159], a[52:55], v[112:127]
  ds_read_b128 v[156:159], v2 offset:64512
  s_waitcnt vmcnt(17) lgkmcnt(7)
  v_mfma_f32_32x32x16_bf16 v[64:79], v[128:131], a[56:59], v[64:79]
  ds_read_b128 v[128:131], v3 offset:0
  s_waitcnt lgkmcnt(7)
  v_mfma_f32_32x32x16_bf16 v[80:95], v[132:135], a[56:59], v[80:95]
  ds_read_b128 v[132:135], v3 offset:1024
  s_waitcnt lgkmcnt(7)
  v_mfma_f32_32x32x16_bf16 v[96:111], v[136:139], a[56:59], v[96:111]
  ds_read_b128 v[136:139], v3 offset:2048
  s_waitcnt lgkmcnt(7)
  v_mfma_f32_32x32x16_bf16 v[112:127], v[140:143], a[56:59], v[112:127]
  ds_read_b128 v[140:143], v3 offset:3072
  s_waitcnt vmcnt(16) lgkmcnt(7)
  v_mfma_f32_32x32x16_bf16 v[64:79], v[144:147], a[60:63], v[64:79]
  ds_read_b128 v[144:147], v3 offset:4096
  s_waitcnt lgkmcnt(7)
  v_mfma_f32_32x32x16_bf16 v[80:95], v[148:151], a[60:63], v[80:95]
  ds_read_b128 v[148:151], v3 offset:5120
  s_waitcnt lgkmcnt(7)
  v_mfma_f32_32x32x16_bf16 v[96:111], v[152:155], a[60:63], v[96:111]
  ds_read_b128 v[152:155], v3 offset:6144
  s_waitcnt lgkmcnt(7)
  v_mfma_f32_32x32x16_bf16 v[112:127], v[156:159], a[60:63], v[112:127]
  ds_read_b128 v[156:159], v3 offset:7168
  s_waitcnt vmcnt(15) lgkmcnt(7)
  v_mfma_f32_32x32x16_bf16 v[64:79], v[128:131], a[64:67], v[64:79]
  ds_read_b128 v[128:131], v3 offset:8192
  s_waitcnt lgkmcnt(7)
  v_mfma_f32_32x32x16_bf16 v[80:95], v[132:135], a[64:67], v[80:95]
  ds_read_b128 v[132:135], v3 offset:9216
  s_waitcnt lgkmcnt(7)
  v_mfma_f32_32x32x16_bf16 v[96:111], v[136:139], a[64:67], v[96:111]
  ds_read_b128 v[136:139], v3 offset:10240
  s_waitcnt lgkmcnt(7)
  v_mfma_f32_32x32x16_bf16 v[112:127], v[140:143], a[64:67], v[112:127]
  ds_read_b128 v[140:143], v3 offset:11264
  s_waitcnt vmcnt(14) lgkmcnt(7)
  v_mfma_f32_32x32x16_bf16 v[64:79], v[144:147], a[68:71], v[64:79]
  ds_read_b128 v[144:147], v3 offset:12288
  s_waitcnt lgkmcnt(7)
  v_mfma_f32_32x32x16_bf16 v[80:95], v[148:151], a[68:71], v[80:95]
  ds_read_b128 v[148:151], v3 offset:13312
  s_waitcnt lgkmcnt(7)
  v_mfma_f32_32x32x16_bf16 v[96:111], v[152:155], a[68:71], v[96:111]
  ds_read_b128 v[152:155], v3 offset:14336
  s_waitcnt lgkmcnt(7)
  v_mfma_f32_32x32x16_bf16 v[112:127], v[156:159], a[68:71], v[112:127]
  ds_read_b128 v[156:159], v3 offset:15360
  s_waitcnt vmcnt(13) lgkmcnt(7)
  v_mfma_f32_32x32x16_bf16 v[64:79], v[128:131], a[72:75], v[64:79]
  ds_read_b128 v[128:131], v3 offset:16384
  s_waitcnt lgkmcnt(7)
  v_mfma_f32_32x32x16_bf16 v[80:95], v[132:135], a[72:75], v[80:95]
  ds_read_b128 v[132:135], v3 offset:17408
  s_waitcnt lgkmcnt(7)
  v_mfma_f32_32x32x16_bf16 v[96:111], v[136:139], a[72:75], v[96:111]
  ds_read_b128 v[136:139], v3 offset:18432
  s_waitcnt lgkmcnt(7)
  v_mfma_f32_32x32x16_bf16 v[112:127], v[140:143], a[72:75], v[112:127]
  ds_read_b128 v[140:143], v3 offset:19456
  s_waitcnt vmcnt(12) lgkmcnt(7)
  v_mfma_f32_32x32x16_bf16 v[64:79], v[144:147], a[76:79], v[64:79]
  ds_read_b128 v[144:147], v3 offset:20480
  s_waitcnt lgkmcnt(7)
  v_mfma_f32_32x32x16_bf16 v[80:95], v[148:151], a[76:79], v[80:95]
  ds_read_b128 v[148:151], v3 offset:21504
  s_waitcnt lgkmcnt(7)
  v_mfma_f32_32x32x16_bf16 v[96:111], v[152:155], a[76:79], v[96:111]
  ds_read_b128 v[152:155], v3 offset:22528
  s_waitcnt lgkmcnt(7)
  v_mfma_f32_32x32x16_bf16 v[112:127], v[156:159], a[76:79], v[112:127]
  ds_read_b128 v[156:159], v3 offset:23552
  s_waitcnt vmcnt(11) lgkmcnt(7)
  v_mfma_f32_32x32x16_bf16 v[64:79], v[128:131], a[80:83], v[64:79]
  ds_read_b128 v[128:131], v3 offset:24576
  s_waitcnt lgkmcnt(7)
  v_mfma_f32_32x32x16_bf16 v[80:95], v[132:135], a[80:83], v[80:95]
  ds_read_b128 v[132:135], v3 offset:25600
  s_waitcnt lgkmcnt(7)
  v_mfma_f32_32x32x16_bf16 v[96:111], v[136:139], a[80:83], v[96:111]
  ds_read_b128 v[136:139], v3 offset:26624
  s_waitcnt lgkmcnt(7)
  v_mfma_f32_32x32x16_bf16 v[112:127], v[140:143], a[80:83], v[112:127]
  ds_read_b128 v[140:143], v3 offset:27648
  s_waitcnt vmcnt(10) lgkmcnt(7)
  v_mfma_f32_32x32x16_bf16 v[64:79], v[144:147], a[84:87], v[64:79]
  ds_read_b128 v[144:147], v3 offset:28672
  s_waitcnt lgkmcnt(7)
  v_mfma_f32_32x32x16_bf16 v[80:95], v[148:151], a[84:87], v[80:95]
  ds_read_b128 v[148:151], v3 offset:29696
  s_waitcnt lgkmcnt(7)
  v_mfma_f32_32x32x16_bf16 v[96:111], v[152:155], a[84:87], v[96:111]
  ds_read_b128 v[152:155], v3 offset:30720
  s_waitcnt lgkmcnt(7)
  v_mfma_f32_32x32x16_bf16 v[112:127], v[156:159], a[84:87], v[112:127]
  ds_read_b128 v[156:159], v3 offset:31744
  s_waitcnt vmcnt(9) lgkmcnt(7)
  v_mfma_f32_32x32x16_bf16 v[64:79], v[128:131], a[88:91], v[64:79]
  ds_read_b128 v[128:131], v3 offset:32768
  s_waitcnt lgkmcnt(7)
  v_mfma_f32_32x32x16_bf16 v[80:95], v[132:135], a[88:91], v[80:95]
  ds_read_b128 v[132:135], v3 offset:33792
  s_waitcnt lgkmcnt(7)
  v_mfma_f32_32x32x16_bf16 v[96:111], v[136:139], a[88:91], v[96:111]
  ds_read_b128 v[136:139], v3 offset:34816
  s_waitcnt lgkmcnt(7)
  v_mfma_f32_32x32x16_bf16 v[112:127], v[140:143], a[88:91], v[112:127]
  ds_read_b128 v[140:143], v3 offset:35840
  s_waitcnt vmcnt(8) lgkmcnt(7)
  v_mfma_f32_32x32x16_bf16 v[64:79], v[144:147], a[92:95], v[64:79]
  ds_read_b128 v[144:147], v3 offset:36864
  s_waitcnt lgkmcnt(7)
  v_mfma_f32_32x32x16_bf16 v[80:95], v[148:151], a[92:95], v[80:95]
  ds_read_b128 v[148:151], v3 offset:37888
  s_waitcnt lgkmcnt(7)
  v_mfma_f32_32x32x16_bf16 v[96:111], v[152:155], a[92:95], v[96:111]
  ds_read_b128 v[152:155], v3 offset:38912
  s_waitcnt lgkmcnt(7)
  v_mfma_f32_32x32x16_bf16 v[112:127], v[156:159], a[92:95], v[112:127]
  ds_read_b128 v[156:159], v3 offset:39936
  s_waitcnt vmcnt(7) lgkmcnt(7)
  v_mfma_f32_32x32x16_bf16 v[64:79], v[128:131], a[96:99], v[64:79]
  ds_read_b128 v[128:131], v3 offset:40960
  s_waitcnt lgkmcnt(7)
  v_mfma_f32_32x32x16_bf16 v[80:95], v[132:135], a[96:99], v[80:95]
  ds_read_b128 v[132:135], v3 offset:41984
  s_waitcnt lgkmcnt(7)
  v_mfma_f32_32x32x16_bf16 v[96:111], v[136:139], a[96:99], v[96:111]
  ds_read_b128 v[136:139], v3 offset:43008
  s_waitcnt lgkmcnt(7)
  v_mfma_f32_32x32x16_bf16 v[112:127], v[140:143], a[96:99], v[112:127]
  ds_read_b128 v[140:143], v3 offset:44032
  s_waitcnt vmcnt(6) lgkmcnt(7)
  v_mfma_f32_32x32x16_bf16 v[64:79], v[144:147], a[100:103], v[64:79]
  ds_read_b128 v[144:147], v3 offset:45056
  s_waitcnt lgkmcnt(7)
  v_mfma_f32_32x32x16_bf16 v[80:95], v[148:151], a[100:103], v[80:95]
  ds_read_b128 v[148:151], v3 offset:46080
  s_waitcnt lgkmcnt(7)
  v_mfma_f32_32x32x16_bf16 v[96:111], v[152:155], a[100:103], v[96:111]
  ds_read_b128 v[152:155], v3 offset:47104
  s_waitcnt lgkmcnt(7)
  v_mfma_f32_32x32x16_bf16 v[112:127], v[156:159], a[100:103], v[112:127]
  ds_read_b128 v[156:159], v3 offset:48128
  s_waitcnt vmcnt(5) lgkmcnt(7)
  v_mfma_f32_32x32x16_bf16 v[64:79], v[128:131], a[104:107], v[64:79]
  ds_read_b128 v[128:131], v3 offset:49152
  s_waitcnt lgkmcnt(7)
  v_mfma_f32_32x32x16_bf16 v[80:95], v[132:135], a[104:107], v[80:95]
  ds_read_b128 v[132:135], v3 offset:50176
  s_waitcnt lgkmcnt(7)
  v_mfma_f32_32x32x16_bf16 v[96:111], v[136:139], a[104:107], v[96:111]
  ds_read_b128 v[136:139], v3 offset:51200
  s_waitcnt lgkmcnt(7)
  v_mfma_f32_32x32x16_bf16 v[112:127], v[140:143], a[104:107], v[112:127]
  ds_read_b128 v[140:143], v3 offset:52224
  s_waitcnt vmcnt(4) lgkmcnt(7)
  v_mfma_f32_32x32x16_bf16 v[64:79], v[144:147], a[108:111], v[64:79]
  ds_read_b128 v[144:147], v3 offset:53248
  s_waitcnt lgkmcnt(7)
  v_mfma_f32_32x32x16_bf16 v[80:95], v[148:151], a[108:111], v[80:95]
  ds_read_b128 v[148:151], v3 offset:54272
  s_waitcnt lgkmcnt(7)
  v_mfma_f32_32x32x16_bf16 v[96:111], v[152:155], a[108:111], v[96:111]
  ds_read_b128 v[152:155], v3 offset:55296
  s_waitcnt lgkmcnt(7)
  v_mfma_f32_32x32x16_bf16 v[112:127], v[156:159], a[108:111], v[112:127]
  ds_read_b128 v[156:159], v3 offset:56320
  s_waitcnt vmcnt(3) lgkmcnt(7)
  v_mfma_f32_32x32x16_bf16 v[64:79], v[128:131], a[112:115], v[64:79]
  ds_read_b128 v[128:131], v3 offset:57344
  s_waitcnt lgkmcnt(7)
  v_mfma_f32_32x32x16_bf16 v[80:95], v[132:135], a[112:115], v[80:95]
  ds_read_b128 v[132:135], v3 offset:58368
  s_waitcnt lgkmcnt(7)
  v_mfma_f32_32x32x16_bf16 v[96:111], v[136:139], a[112:115], v[96:111]
  ds_read_b128 v[136:139], v3 offset:59392
  s_waitcnt lgkmcnt(7)
  v_mfma_f32_32x32x16_bf16 v[112:127], v[140:143], a[112:115], v[112:127]
  ds_read_b128 v[140:143], v3 offset:60416
  s_waitcnt vmcnt(2) lgkmcnt(7)
  v_mfma_f32_32x32x16_bf16 v[64:79], v[144:147], a[116:119], v[64:79]
  ds_read_b128 v[144:147], v3 offset:61440
  s_waitcnt lgkmcnt(7)
  v_mfma_f32_32x32x16_bf16 v[80:95], v[148:151], a[116:119], v[80:95]
  ds_read_b128 v[148:151], v3 offset:62464
  s_waitcnt lgkmcnt(7)
  v_mfma_f32_32x32x16_bf16 v[96:111], v[152:155], a[116:119], v[96:111]
  ds_read_b128 v[152:155], v3 offset:63488
  s_waitcnt lgkmcnt(7)
  v_mfma_f32_32x32x16_bf16 v[112:127], v[156:159], a[116:119], v[112:127]
  ds_read_b128 v[156:159], v3 offset:64512
  s_waitcnt vmcnt(1) lgkmcnt(7)
  v_mfma_f32_32x32x16_bf16 v[64:79], v[128:131], a[120:123], v[64:79]
  s_waitcnt lgkmcnt(6)
  v_mfma_f32_32x32x16_bf16 v[80:95], v[132:135], a[120:123], v[80:95]
  s_waitcnt lgkmcnt(5)
  v_mfma_f32_32x32x16_bf16 v[96:111], v[136:139], a[120:123], v[96:111]
  s_waitcnt lgkmcnt(4)
  v_mfma_f32_32x32x16_bf16 v[112:127], v[140:143], a[120:123], v[112:127]
  s_waitcnt vmcnt(0) lgkmcnt(3)
  v_mfma_f32_32x32x16_bf16 v[64:79], v[144:147], a[124:127], v[64:79]
  s_waitcnt lgkmcnt(2)
  v_mfma_f32_32x32x16_bf16 v[80:95], v[148:151], a[124:127], v[80:95]
  s_waitcnt lgkmcnt(1)
  v_mfma_f32_32x32x16_bf16 v[96:111], v[152:155], a[124:127], v[96:111]
  s_waitcnt lgkmcnt(0)
  v_mfma_f32_32x32x16_bf16 v[112:127], v[156:159], a[124:127], v[112:127]
  s_nop 15
  v_cvt_pk_bf16_f32 v160, v64, v65
  v_cvt_pk_bf16_f32 v161, v66, v67
  v_cvt_pk_bf16_f32 v162, v68, v69
  v_cvt_pk_bf16_f32 v163, v70, v71
  v_cvt_pk_bf16_f32 v164, v72, v73
  v_cvt_pk_bf16_f32 v165, v74, v75
  v_cvt_pk_bf16_f32 v166, v76, v77
  v_cvt_pk_bf16_f32 v167, v78, v79
  v_cvt_pk_bf16_f32 v168, v80, v81
  v_cvt_pk_bf16_f32 v169, v82, v83
  v_cvt_pk_bf16_f32 v170, v84, v85
  v_cvt_pk_bf16_f32 v171, v86, v87
  v_cvt_pk_bf16_f32 v172, v88, v89
  v_cvt_pk_bf16_f32 v173, v90, v91
  v_cvt_pk_bf16_f32 v174, v92, v93
  v_cvt_pk_bf16_f32 v175, v94, v95
  v_cvt_pk_bf16_f32 v176, v96, v97
  v_cvt_pk_bf16_f32 v177, v98, v99
  v_cvt_pk_bf16_f32 v178, v100, v101
  v_cvt_pk_bf16_f32 v179, v102, v103
  v_cvt_pk_bf16_f32 v180, v104, v105
  v_cvt_pk_bf16_f32 v181, v106, v107
  v_cvt_pk_bf16_f32 v182, v108, v109
  v_cvt_pk_bf16_f32 v183, v110, v111
  v_cvt_pk_bf16_f32 v184, v112, v113
  v_cvt_pk_bf16_f32 v185, v114, v115
  v_cvt_pk_bf16_f32 v186, v116, v117
  v_cvt_pk_bf16_f32 v187, v118, v119
  v_cvt_pk_bf16_f32 v188, v120, v121
  v_cvt_pk_bf16_f32 v189, v122, v123
  v_cvt_pk_bf16_f32 v190, v124, v125
  v_cvt_pk_bf16_f32 v191, v126, v127
  s_and_b32 s56, s51, 3
  s_lshl_b32 s56, s56, 2
  s_lshl_b32 s57, s49, 7
  s_add_u32 s56, s56, s57
  s_add_u32 s56, s56, 0
  s_lshr_b32 s57, s51, 2
  v_min_u32 v4, 1, v1
  v_mul_u32_u24 v4, 4096, v4
  s_cmp_eq_u32 s50, 0
  s_cbranch_scc1 Lwaitd_50
  s_mov_b32 s52, 0
  s_mov_b32 s54, 3
  s_mov_b32 s55, 0
Lwait_49:
  buffer_load_dword v5, v4, s[32:35], s56 offen sc1
  s_add_u32 s52, s52, 1
  s_cmp_gt_u32 s52, 65536
  s_cbranch_scc1 Lwaitd_50
  s_waitcnt vmcnt(0)
  v_cmp_gt_u32 vcc, v5, s57
  s_and_b64 vcc, vcc, s[54:55]
  s_cmp_eq_u64 vcc, s[54:55]
  s_cbranch_scc1 Lwaitd_50
  s_sleep 2
  s_branch Lwait_49
Lwaitd_50:
  s_waitcnt vmcnt(0)
  s_lshl_b32 s60, s49, 6
  s_add_u32 s60, s60, s51
  s_lshl_b32 s61, s60, 13
  s_add_u32 s52, s61, 16777216
  s_add_u32 s53, s61, 16781312
  s_add_u32 s54, s61, 33554432
  s_add_u32 s55, s61, 33558528
  buffer_load_dwordx4 a[128:131], v2, s[32:35], s52 offen offset:0 sc1
  buffer_load_dwordx4 a[132:135], v2, s[32:35], s52 offen offset:1024 sc1
  buffer_load_dwordx4 a[136:139], v2, s[32:35], s52 offen offset:2048 sc1
  buffer_load_dwordx4 a[140:143], v2, s[32:35], s52 offen offset:3072 sc1
  buffer_load_dwordx4 a[144:147], v2, s[32:35], s53 offen offset:0 sc1
  buffer_load_dwordx4 a[148:151], v2, s[32:35], s53 offen offset:1024 sc1
  buffer_load_dwordx4 a[152:155], v2, s[32:35], s53 offen offset:2048 sc1
  buffer_load_dwordx4 a[156:159], v2, s[32:35], s53 offen offset:3072 sc1
  buffer_load_dwordx4 a[160:163], v2, s[32:35], s54 offen offset:0 sc1
  buffer_load_dwordx4 a[164:167], v2, s[32:35], s54 offen offset:1024 sc1
  buffer_load_dwordx4 a[168:171], v2, s[32:35], s54 offen offset:2048 sc1
  buffer_load_dwordx4 a[172:175], v2, s[32:35], s54 offen offset:3072 sc1
  buffer_load_dwordx4 a[176:179], v2, s[32:35], s55 offen offset:0 sc1
  buffer_load_dwordx4 a[180:183], v2, s[32:35], s55 offen offset:1024 sc1
  buffer_load_dwordx4 a[184:187], v2, s[32:35], s55 offen offset:2048 sc1
  buffer_load_dwordx4 a[188:191], v2, s[32:35], s55 offen offset:3072 sc1
  s_waitcnt vmcnt(15)
  v_mfma_f32_32x32x16_bf16 v[64:79], a[128:131], v[160:163], 0
  s_waitcnt vmcnt(14)
  v_mfma_f32_32x32x16_bf16 v[64:79], a[132:135], v[164:167], v[64:79]
  s_waitcnt vmcnt(13)
  v_mfma_f32_32x32x16_bf16 v[64:79], a[136:139], v[168:171], v[64:79]
  s_waitcnt vmcnt(12)
  v_mfma_f32_32x32x16_bf16 v[64:79], a[140:143], v[172:175], v[64:79]
  s_waitcnt vmcnt(11)
  v_mfma_f32_32x32x16_bf16 v[64:79], a[144:147], v[176:179], v[64:79]
  s_waitcnt vmcnt(10)
  v_mfma_f32_32x32x16_bf16 v[64:79], a[148:151], v[180:183], v[64:79]
  s_waitcnt vmcnt(9)
  v_mfma_f32_32x32x16_bf16 v[64:79], a[152:155], v[184:187], v[64:79]
  s_waitcnt vmcnt(8)
  v_mfma_f32_32x32x16_bf16 v[64:79], a[156:159], v[188:191], v[64:79]
  s_lshl_b32 s56, s49, 7
  s_add_u32 s56, s56, 24576
  v_mov_b32 v4, 0
  s_cmp_eq_u32 s50, 0
  s_cbranch_scc1 Lwaitd_52
  s_mov_b32 s52, 0
  s_mov_b32 s54, 1
  s_mov_b32 s55, 0
Lwait_51:
  buffer_load_dword v5, v4, s[32:35], s56 offen sc1
  s_add_u32 s52, s52, 1
  s_cmp_gt_u32 s52, 65536
  s_cbranch_scc1 Lwaitd_52
  s_waitcnt vmcnt(0)
  v_cmp_gt_u32 vcc, v5, s51
  s_and_b64 vcc, vcc, s[54:55]
  s_cmp_eq_u64 vcc, s[54:55]
  s_cbranch_scc1 Lwaitd_52
  s_sleep 2
  s_branch Lwait_51
Lwaitd_52:
  s_waitcnt vmcnt(0)
  s_lshl_b32 s61, s60, 11
  s_lshl_b32 s52, s60, 12
  s_add_u32 s52, s52, 8388608
  s_add_u32 s53, s61, 134217728
  buffer_load_dwordx4 v[192:195], v6, s[32:35], s52 offen offset:0 sc1
  buffer_load_dwordx4 v[196:199], v6, s[32:35], s52 offen offset:32 sc1
  buffer_load_dwordx4 v[200:203], v6, s[32:35], s52 offen offset:64 sc1
  buffer_load_dwordx4 v[204:207], v6, s[32:35], s52 offen offset:96 sc1
  buffer_load_dwordx4 v[208:211], v6, s[32:35], s52 offen offset:128 sc1
  buffer_load_dwordx4 v[212:215], v6, s[32:35], s52 offen offset:160 sc1
  buffer_load_dwordx4 v[216:219], v6, s[32:35], s52 offen offset:192 sc1
  buffer_load_dwordx4 v[220:223], v6, s[32:35], s52 offen offset:224 sc1
  buffer_load_dword v224, v7, s[32:35], s53 offen offset:0 sc1
  buffer_load_dword v225, v7, s[32:35], s53 offen offset:128 sc1
  v_mov_b32 v226, 0
  v_mov_b32 v227, 0
  buffer_load_dword v228, v7, s[32:35], s53 offen offset:512 sc1
  buffer_load_dword v229, v7, s[32:35], s53 offen offset:640 sc1
  v_mov_b32 v230, 0
  v_mov_b32 v231, 0
  buffer_load_dword v232, v7, s[32:35], s53 offen offset:1024 sc1
  buffer_load_dword v233, v7, s[32:35], s53 offen offset:1152 sc1
  v_mov_b32 v234, 0
  v_mov_b32 v235, 0
  buffer_load_dword v236, v7, s[32:35], s53 offen offset:1536 sc1
  buffer_load_dword v237, v7, s[32:35], s53 offen offset:1664 sc1
  v_mov_b32 v238, 0
  v_mov_b32 v239, 0
  v_mov_b32 v8, 0xf149f2ca
  v_cndmask_b32 v64, v8, v64, s[66:67]
  v_cndmask_b32 v65, v8, v65, s[68:69]
  v_cndmask_b32 v66, v8, v66, s[70:71]
  v_cndmask_b32 v67, v8, v67, s[72:73]
  v_cndmask_b32 v68, v8, v68, s[74:75]
  v_cndmask_b32 v69, v8, v69, s[76:77]
  v_cndmask_b32 v70, v8, v70, s[78:79]
  v_cndmask_b32 v71, v8, v71, s[80:81]
  v_cndmask_b32 v72, v8, v72, s[82:83]
  v_cndmask_b32 v73, v8, v73, s[84:85]
  v_cndmask_b32 v74, v8, v74, s[86:87]
  v_cndmask_b32 v75, v8, v75, s[88:89]
  v_cndmask_b32 v76, v8, v76, s[90:91]
  v_cndmask_b32 v77, v8, v77, s[92:93]
  v_cndmask_b32 v78, v8, v78, s[94:95]
  v_cndmask_b32 v79, v8, v79, s[96:97]
  v_max3_f32 v9, v64, v65, v66
  v_max3_f32 v9, v9, v67, v68
  v_max3_f32 v9, v9, v69, v70
  v_max3_f32 v9, v9, v71, v72
  v_max3_f32 v9, v9, v73, v74
  v_max3_f32 v9, v9, v75, v76
  v_max3_f32 v9, v9, v77, v78
  v_max_f32 v9, v9, v79
  s_waitcnt vmcnt(15)
  v_mfma_f32_32x32x16_bf16 v[80:95], v[192:195], v[160:163], 0
  s_waitcnt vmcnt(14)
  v_mfma_f32_32x32x16_bf16 v[80:95], v[196:199], v[164:167], v[80:95]
  s_waitcnt vmcnt(13)
  v_mfma_f32_32x32x16_bf16 v[80:95], v[200:203], v[168:171], v[80:95]
  s_waitcnt vmcnt(12)
  v_mfma_f32_32x32x16_bf16 v[80:95], v[204:207], v[172:175], v[80:95]
  s_waitcnt vmcnt(11)
  v_mfma_f32_32x32x16_bf16 v[80:95], v[208:211], v[176:179], v[80:95]
  s_waitcnt vmcnt(10)
  v_mfma_f32_32x32x16_bf16 v[80:95], v[212:215], v[180:183], v[80:95]
  s_waitcnt vmcnt(9)
  v_mfma_f32_32x32x16_bf16 v[80:95], v[216:219], v[184:187], v[80:95]
  s_waitcnt vmcnt(8)
  v_mfma_f32_32x32x16_bf16 v[80:95], v[220:223], v[188:191], v[80:95]
  s_nop 15
  v_max3_f32 v9, v9, v80, v81
  v_max3_f32 v9, v9, v82, v83
  v_mov_b32 v10, v9
  s_nop 1
  v_permlane32_swap_b32 v9, v10
  s_nop 1
  v_max_f32 v9, v9, v10
  s_mov_b32 s58, 0x3e0293ee
  v_mul_f32 v9, 0xbe0293ee, v9
  v_fma_f32 v64, v64, s58, v9
  v_fma_f32 v65, v65, s58, v9
  v_fma_f32 v66, v66, s58, v9
  v_fma_f32 v67, v67, s58, v9
  v_fma_f32 v68, v68, s58, v9
  v_fma_f32 v69, v69, s58, v9
  v_fma_f32 v70, v70, s58, v9
  v_fma_f32 v71, v71, s58, v9
  v_fma_f32 v72, v72, s58, v9
  v_fma_f32 v73, v73, s58, v9
  v_fma_f32 v74, v74, s58, v9
  v_fma_f32 v75, v75, s58, v9
  v_fma_f32 v76, v76, s58, v9
  v_fma_f32 v77, v77, s58, v9
  v_fma_f32 v78, v78, s58, v9
  v_fma_f32 v79, v79, s58, v9
  v_fma_f32 v80, v80, s58, v9
  v_fma_f32 v81, v81, s58, v9
  v_fma_f32 v82, v82, s58, v9
  v_fma_f32 v83, v83, s58, v9
  v_exp_f32 v64, v64
  v_exp_f32 v65, v65
  v_exp_f32 v66, v66
  v_exp_f32 v67, v67
  v_exp_f32 v68, v68
  v_exp_f32 v69, v69
  v_exp_f32 v70, v70
  v_exp_f32 v71, v71
  v_exp_f32 v72, v72
  v_exp_f32 v73, v73
  v_exp_f32 v74, v74
  v_exp_f32 v75, v75
  v_exp_f32 v76, v76
  v_exp_f32 v77, v77
  v_exp_f32 v78, v78
  v_exp_f32 v79, v79
  v_exp_f32 v80, v80
  v_exp_f32 v81, v81
  v_exp_f32 v82, v82
  v_exp_f32 v83, v83
  s_nop 0
  v_add_f32 v10, v64, v65
  v_add_f32 v11, v66, v67
  v_add_f32 v10, v10, v68
  v_add_f32 v11, v11, v69
  v_add_f32 v10, v10, v70
  v_add_f32 v11, v11, v71
  v_add_f32 v10, v10, v72
  v_add_f32 v11, v11, v73
  v_add_f32 v10, v10, v74
  v_add_f32 v11, v11, v75
  v_add_f32 v10, v10, v76
  v_add_f32 v11, v11, v77
  v_add_f32 v10, v10, v78
  v_add_f32 v11, v11, v79
  v_add_f32 v10, v10, v80
  v_add_f32 v11, v11, v81
  v_add_f32 v10, v10, v82
  v_add_f32 v11, v11, v83
  v_add_f32 v10, v10, v11
  v_mov_b32 v11, v10
  s_nop 1
  v_permlane32_swap_b32 v10, v11
  s_nop 1
  v_add_f32 v10, v10, v11
  v_rcp_f32 v10, v10
  s_nop 0
  v_mul_f32 v64, v64, v10
  v_mul_f32 v65, v65, v10
  v_mul_f32 v66, v66, v10
  v_mul_f32 v67, v67, v10
  v_mul_f32 v68, v68, v10
  v_mul_f32 v69, v69, v10
  v_mul_f32 v70, v70, v10
  v_mul_f32 v71, v71, v10
  v_mul_f32 v72, v72, v10
  v_mul_f32 v73, v73, v10
  v_mul_f32 v74, v74, v10
  v_mul_f32 v75, v75, v10
  v_mul_f32 v76, v76, v10
  v_mul_f32 v77, v77, v10
  v_mul_f32 v78, v78, v10
  v_mul_f32 v79, v79, v10
  v_mul_f32 v80, v80, v10
  v_mul_f32 v81, v81, v10
  v_mul_f32 v82, v82, v10
  v_mul_f32 v83, v83, v10
  v_cvt_pk_bf16_f32 v12, v64, v65
  v_cvt_pk_bf16_f32 v13, v66, v67
  v_cvt_pk_bf16_f32 v14, v68, v69
  v_cvt_pk_bf16_f32 v15, v70, v71
  v_cvt_pk_bf16_f32 v16, v72, v73
  v_cvt_pk_bf16_f32 v17, v74, v75
  v_cvt_pk_bf16_f32 v18, v76, v77
  v_cvt_pk_bf16_f32 v19, v78, v79
  v_cvt_pk_bf16_f32 v20, v80, v81
  v_cvt_pk_bf16_f32 v21, v82, v83
  v_mov_b32 v22, 0
  v_mov_b32 v23, 0
  s_waitcnt vmcnt(0)
  s_nop 1
  v_mfma_f32_32x32x16_bf16 v[64:79], a[160:163], v[12:15], 0
  v_mfma_f32_32x32x16_bf16 v[80:95], a[168:171], v[12:15], 0
  v_mfma_f32_32x32x16_bf16 v[96:111], a[176:179], v[12:15], 0
  v_mfma_f32_32x32x16_bf16 v[112:127], a[184:187], v[12:15], 0
  v_mfma_f32_32x32x16_bf16 v[64:79], a[164:167], v[16:19], v[64:79]
  v_mfma_f32_32x32x16_bf16 v[80:95], a[172:175], v[16:19], v[80:95]
  v_mfma_f32_32x32x16_bf16 v[96:111], a[180:183], v[16:19], v[96:111]
  v_mfma_f32_32x32x16_bf16 v[112:127], a[188:191], v[16:19], v[112:127]
  v_mfma_f32_32x32x16_bf16 v[64:79], v[224:227], v[20:23], v[64:79]
  v_mfma_f32_32x32x16_bf16 v[80:95], v[228:231], v[20:23], v[80:95]
  v_mfma_f32_32x32x16_bf16 v[96:111], v[232:235], v[20:23], v[96:111]
  v_mfma_f32_32x32x16_bf16 v[112:127], v[236:239], v[20:23], v[112:127]
  s_nop 15
  v_cvt_pk_bf16_f32 v160, v64, v65
  v_cvt_pk_bf16_f32 v161, v66, v67
  v_cvt_pk_bf16_f32 v162, v68, v69
  v_cvt_pk_bf16_f32 v163, v70, v71
  v_cvt_pk_bf16_f32 v164, v72, v73
  v_cvt_pk_bf16_f32 v165, v74, v75
  v_cvt_pk_bf16_f32 v166, v76, v77
  v_cvt_pk_bf16_f32 v167, v78, v79
  v_cvt_pk_bf16_f32 v168, v80, v81
  v_cvt_pk_bf16_f32 v169, v82, v83
  v_cvt_pk_bf16_f32 v170, v84, v85
  v_cvt_pk_bf16_f32 v171, v86, v87
  v_cvt_pk_bf16_f32 v172, v88, v89
  v_cvt_pk_bf16_f32 v173, v90, v91
  v_cvt_pk_bf16_f32 v174, v92, v93
  v_cvt_pk_bf16_f32 v175, v94, v95
  v_cvt_pk_bf16_f32 v176, v96, v97
  v_cvt_pk_bf16_f32 v177, v98, v99
  v_cvt_pk_bf16_f32 v178, v100, v101
  v_cvt_pk_bf16_f32 v179, v102, v103
  v_cvt_pk_bf16_f32 v180, v104, v105
  v_cvt_pk_bf16_f32 v181, v106, v107
  v_cvt_pk_bf16_f32 v182, v108, v109
  v_cvt_pk_bf16_f32 v183, v110, v111
  v_cvt_pk_bf16_f32 v184, v112, v113
  v_cvt_pk_bf16_f32 v185, v114, v115
  v_cvt_pk_bf16_f32 v186, v116, v117
  v_cvt_pk_bf16_f32 v187, v118, v119
  v_cvt_pk_bf16_f32 v188, v120, v121
  v_cvt_pk_bf16_f32 v189, v122, v123
  v_cvt_pk_bf16_f32 v190, v124, v125
  v_cvt_pk_bf16_f32 v191, v126, v127
  s_lshl_b32 s61, s51, 5
  s_add_u32 s61, s61, s49
  s_lshl_b32 s61, s61, 13
  s_add_u32 s61, s61, 50331648
  buffer_store_dwordx4 v[160:163], v2, s[32:35], s61 offen offset:0 sc1
  buffer_store_dwordx4 v[164:167], v2, s[32:35], s61 offen offset:1024 sc1
  buffer_store_dwordx4 v[168:171], v2, s[32:35], s61 offen offset:2048 sc1
  buffer_store_dwordx4 v[172:175], v2, s[32:35], s61 offen offset:3072 sc1
  s_add_u32 s61, s61, 4096
  buffer_store_dwordx4 v[176:179], v2, s[32:35], s61 offen offset:0 sc1
  buffer_store_dwordx4 v[180:183], v2, s[32:35], s61 offen offset:1024 sc1
  buffer_store_dwordx4 v[184:187], v2, s[32:35], s61 offen offset:2048 sc1
  buffer_store_dwordx4 v[188:191], v2, s[32:35], s61 offen offset:3072 sc1
  s_lshl_b32 s56, s48, 2
  s_lshl_b32 s57, s49, 7
  s_add_u32 s56, s56, s57
  s_add_u32 s56, s56, 8192
  s_lshr_b32 s57, s51, 2
  s_add_u32 s57, s57, 1
  s_waitcnt vmcnt(0)
  s_cmp_eq_u32 s50, 0
  s_cbranch_scc1 Lsig_53
  v_mov_b32 v4, s57
  v_mov_b32 v5, 0
  s_mov_b64 exec, 1
  buffer_store_dword v4, v5, s[32:35], s56 offen sc1
  s_mov_b64 exec, -1
Lsig_53:
  s_add_u32 s51, s51, 4
  s_cmp_lt_u32 s51, 64
  s_cbranch_scc1 LOOP_QA
  s_waitcnt vmcnt(0)
  s_endpgm
ROLE_WO:
  s_mov_b32 s36, s14
  s_mov_b32 s37, s15
  s_mov_b32 s38, 4194304
  s_mov_b32 s39, 0x00020000
  s_lshr_b32 s66, s49, 2
  s_and_b32 s67, s49, 3
  s_mul_i32 s62, s66, 524288
  s_lshl_b32 s52, s67, 8
  s_add_u32 s62, s62, s52
  s_add_u32 s68, s66, 0
  s_mul_i32 s49, s67, 12
  s_add_u32 s49, s49, s68
  v_and_b32 v7, 15, v1
  v_lshlrev_b32 v4, 4, v7
  v_lshrrev_b32 v7, 5, v1
  v_mul_u32_u24 v8, 16384, v7
  v_add_u32 v4, v4, v8
  v_bfe_u32 v9, v1, 4, 1
  v_mul_u32_u24 v8, 4096, v9
  v_add_u32 v4, v4, v8
  v_lshlrev_b32 v5, 12, v7
  v_lshl_add_u32 v5, v9, 9, v5
  v_bfe_u32 v8, v1, 2, 2
  v_lshl_add_u32 v5, v8, 10, v5
  v_and_b32 v8, 3, v1
  v_lshl_add_u32 v5, v8, 7, v5
  s_lshl_b32 s52, s48, 13
  v_add_u32 v5, s52, v5
  v_add_u32 v6, 0x10000, v5
  s_mul_i32 s52, s48, 32768
  s_add_u32 s52, s52, s62
  s_add_u32 s53, s52, 0
  buffer_load_dwordx4 v[16:19], v4, s[36:39], s53 offen
  s_add_u32 s53, s52, 1024
  buffer_load_dwordx4 v[20:23], v4, s[36:39], s53 offen
  s_add_u32 s53, s52, 2048
  buffer_load_dwordx4 v[24:27], v4, s[36:39], s53 offen
  s_add_u32 s53, s52, 3072
  buffer_load_dwordx4 v[28:31], v4, s[36:39], s53 offen
  s_add_u32 s53, s52, 8192
  buffer_load_dwordx4 v[32:35], v4, s[36:39], s53 offen
  s_add_u32 s53, s52, 9216
  buffer_load_dwordx4 v[36:39], v4, s[36:39], s53 offen
  s_add_u32 s53, s52, 10240
  buffer_load_dwordx4 v[40:43], v4, s[36:39], s53 offen
  s_add_u32 s53, s52, 11264
  buffer_load_dwordx4 v[44:47], v4, s[36:39], s53 offen
  s_add_u32 s53, s52, 131072
  buffer_load_dwordx4 v[48:51], v4, s[36:39], s53 offen
  s_add_u32 s53, s52, 132096
  buffer_load_dwordx4 v[52:55], v4, s[36:39], s53 offen
  s_add_u32 s53, s52, 133120
  buffer_load_dwordx4 v[56:59], v4, s[36:39], s53 offen
  s_add_u32 s53, s52, 134144
  buffer_load_dwordx4 v[60:63], v4, s[36:39], s53 offen
  s_add_u32 s53, s52, 139264
  buffer_load_dwordx4 v[64:67], v4, s[36:39], s53 offen
  s_add_u32 s53, s52, 140288
  buffer_load_dwordx4 v[68:71], v4, s[36:39], s53 offen
  s_add_u32 s53, s52, 141312
  buffer_load_dwordx4 v[72:75], v4, s[36:39], s53 offen
  s_add_u32 s53, s52, 142336
  buffer_load_dwordx4 v[76:79], v4, s[36:39], s53 offen
  s_add_u32 s53, s52, 262144
  buffer_load_dwordx4 v[80:83], v4, s[36:39], s53 offen
  s_add_u32 s53, s52, 263168
  buffer_load_dwordx4 v[84:87], v4, s[36:39], s53 offen
  s_add_u32 s53, s52, 264192
  buffer_load_dwordx4 v[88:91], v4, s[36:39], s53 offen
  s_add_u32 s53, s52, 265216
  buffer_load_dwordx4 v[92:95], v4, s[36:39], s53 offen
  s_add_u32 s53, s52, 270336
  buffer_load_dwordx4 v[96:99], v4, s[36:39], s53 offen
  s_add_u32 s53, s52, 271360
  buffer_load_dwordx4 v[100:103], v4, s[36:39], s53 offen
  s_add_u32 s53, s52, 272384
  buffer_load_dwordx4 v[104:107], v4, s[36:39], s53 offen
  s_add_u32 s53, s52, 273408
  buffer_load_dwordx4 v[108:111], v4, s[36:39], s53 offen
  s_add_u32 s53, s52, 393216
  buffer_load_dwordx4 v[112:115], v4, s[36:39], s53 offen
  s_add_u32 s53, s52, 394240
  buffer_load_dwordx4 v[116:119], v4, s[36:39], s53 offen
  s_add_u32 s53, s52, 395264
  buffer_load_dwordx4 v[120:123], v4, s[36:39], s53 offen
  s_add_u32 s53, s52, 396288
  buffer_load_dwordx4 v[124:127], v4, s[36:39], s53 offen
  s_add_u32 s53, s52, 401408
  buffer_load_dwordx4 v[128:131], v4, s[36:39], s53 offen
  s_add_u32 s53, s52, 402432
  buffer_load_dwordx4 v[132:135], v4, s[36:39], s53 offen
  s_add_u32 s53, s52, 403456
  buffer_load_dwordx4 v[136:139], v4, s[36:39], s53 offen
  s_add_u32 s53, s52, 404480
  buffer_load_dwordx4 v[140:143], v4, s[36:39], s53 offen
Lwl_skip_54:
  s_waitcnt vmcnt(0)
  v_perm_b32 v144, v20, v16, s64
  v_perm_b32 v145, v28, v24, s64
  v_perm_b32 v146, v36, v32, s64
  v_perm_b32 v147, v44, v40, s64
  ds_write_b128 v5, v[144:147] offset:0
  v_perm_b32 v148, v20, v16, s65
  v_perm_b32 v149, v28, v24, s65
  v_perm_b32 v150, v36, v32, s65
  v_perm_b32 v151, v44, v40, s65
  ds_write_b128 v5, v[148:151] offset:16
  v_perm_b32 v152, v21, v17, s64
  v_perm_b32 v153, v29, v25, s64
  v_perm_b32 v154, v37, v33, s64
  v_perm_b32 v155, v45, v41, s64
  ds_write_b128 v5, v[152:155] offset:32
  v_perm_b32 v156, v21, v17, s65
  v_perm_b32 v157, v29, v25, s65
  v_perm_b32 v158, v37, v33, s65
  v_perm_b32 v159, v45, v41, s65
  ds_write_b128 v5, v[156:159] offset:48
  s_waitcnt lgkmcnt(0)
  v_perm_b32 v144, v22, v18, s64
  v_perm_b32 v145, v30, v26, s64
  v_perm_b32 v146, v38, v34, s64
  v_perm_b32 v147, v46, v42, s64
  ds_write_b128 v5, v[144:147] offset:64
  v_perm_b32 v148, v22, v18, s65
  v_perm_b32 v149, v30, v26, s65
  v_perm_b32 v150, v38, v34, s65
  v_perm_b32 v151, v46, v42, s65
  ds_write_b128 v5, v[148:151] offset:80
  v_perm_b32 v152, v23, v19, s64
  v_perm_b32 v153, v31, v27, s64
  v_perm_b32 v154, v39, v35, s64
  v_perm_b32 v155, v47, v43, s64
  ds_write_b128 v5, v[152:155] offset:96
  v_perm_b32 v156, v23, v19, s65
  v_perm_b32 v157, v31, v27, s65
  v_perm_b32 v158, v39, v35, s65
  v_perm_b32 v159, v47, v43, s65
  ds_write_b128 v5, v[156:159] offset:112
  s_waitcnt lgkmcnt(0)
  v_perm_b32 v144, v52, v48, s64
  v_perm_b32 v145, v60, v56, s64
  v_perm_b32 v146, v68, v64, s64
  v_perm_b32 v147, v76, v72, s64
  ds_write_b128 v5, v[144:147] offset:32768
  v_perm_b32 v148, v52, v48, s65
  v_perm_b32 v149, v60, v56, s65
  v_perm_b32 v150, v68, v64, s65
  v_perm_b32 v151, v76, v72, s65
  ds_write_b128 v5, v[148:151] offset:32784
  v_perm_b32 v152, v53, v49, s64
  v_perm_b32 v153, v61, v57, s64
  v_perm_b32 v154, v69, v65, s64
  v_perm_b32 v155, v77, v73, s64
  ds_write_b128 v5, v[152:155] offset:32800
  v_perm_b32 v156, v53, v49, s65
  v_perm_b32 v157, v61, v57, s65
  v_perm_b32 v158, v69, v65, s65
  v_perm_b32 v159, v77, v73, s65
  ds_write_b128 v5, v[156:159] offset:32816
  s_waitcnt lgkmcnt(0)
  v_perm_b32 v144, v54, v50, s64
  v_perm_b32 v145, v62, v58, s64
  v_perm_b32 v146, v70, v66, s64
  v_perm_b32 v147, v78, v74, s64
  ds_write_b128 v5, v[144:147] offset:32832
  v_perm_b32 v148, v54, v50, s65
  v_perm_b32 v149, v62, v58, s65
  v_perm_b32 v150, v70, v66, s65
  v_perm_b32 v151, v78, v74, s65
  ds_write_b128 v5, v[148:151] offset:32848
  v_perm_b32 v152, v55, v51, s64
  v_perm_b32 v153, v63, v59, s64
  v_perm_b32 v154, v71, v67, s64
  v_perm_b32 v155, v79, v75, s64
  ds_write_b128 v5, v[152:155] offset:32864
  v_perm_b32 v156, v55, v51, s65
  v_perm_b32 v157, v63, v59, s65
  v_perm_b32 v158, v71, v67, s65
  v_perm_b32 v159, v79, v75, s65
  ds_write_b128 v5, v[156:159] offset:32880
  s_waitcnt lgkmcnt(0)
  v_perm_b32 v144, v84, v80, s64
  v_perm_b32 v145, v92, v88, s64
  v_perm_b32 v146, v100, v96, s64
  v_perm_b32 v147, v108, v104, s64
  ds_write_b128 v6, v[144:147] offset:0
  v_perm_b32 v148, v84, v80, s65
  v_perm_b32 v149, v92, v88, s65
  v_perm_b32 v150, v100, v96, s65
  v_perm_b32 v151, v108, v104, s65
  ds_write_b128 v6, v[148:151] offset:16
  v_perm_b32 v152, v85, v81, s64
  v_perm_b32 v153, v93, v89, s64
  v_perm_b32 v154, v101, v97, s64
  v_perm_b32 v155, v109, v105, s64
  ds_write_b128 v6, v[152:155] offset:32
  v_perm_b32 v156, v85, v81, s65
  v_perm_b32 v157, v93, v89, s65
  v_perm_b32 v158, v101, v97, s65
  v_perm_b32 v159, v109, v105, s65
  ds_write_b128 v6, v[156:159] offset:48
  s_waitcnt lgkmcnt(0)
  v_perm_b32 v144, v86, v82, s64
  v_perm_b32 v145, v94, v90, s64
  v_perm_b32 v146, v102, v98, s64
  v_perm_b32 v147, v110, v106, s64
  ds_write_b128 v6, v[144:147] offset:64
  v_perm_b32 v148, v86, v82, s65
  v_perm_b32 v149, v94, v90, s65
  v_perm_b32 v150, v102, v98, s65
  v_perm_b32 v151, v110, v106, s65
  ds_write_b128 v6, v[148:151] offset:80
  v_perm_b32 v152, v87, v83, s64
  v_perm_b32 v153, v95, v91, s64
  v_perm_b32 v154, v103, v99, s64
  v_perm_b32 v155, v111, v107, s64
  ds_write_b128 v6, v[152:155] offset:96
  v_perm_b32 v156, v87, v83, s65
  v_perm_b32 v157, v95, v91, s65
  v_perm_b32 v158, v103, v99, s65
  v_perm_b32 v159, v111, v107, s65
  ds_write_b128 v6, v[156:159] offset:112
  s_waitcnt lgkmcnt(0)
  v_perm_b32 v144, v116, v112, s64
  v_perm_b32 v145, v124, v120, s64
  v_perm_b32 v146, v132, v128, s64
  v_perm_b32 v147, v140, v136, s64
  ds_write_b128 v6, v[144:147] offset:32768
  v_perm_b32 v148, v116, v112, s65
  v_perm_b32 v149, v124, v120, s65
  v_perm_b32 v150, v132, v128, s65
  v_perm_b32 v151, v140, v136, s65
  ds_write_b128 v6, v[148:151] offset:32784
  v_perm_b32 v152, v117, v113, s64
  v_perm_b32 v153, v125, v121, s64
  v_perm_b32 v154, v133, v129, s64
  v_perm_b32 v155, v141, v137, s64
  ds_write_b128 v6, v[152:155] offset:32800
  v_perm_b32 v156, v117, v113, s65
  v_perm_b32 v157, v125, v121, s65
  v_perm_b32 v158, v133, v129, s65
  v_perm_b32 v159, v141, v137, s65
  ds_write_b128 v6, v[156:159] offset:32816
  s_waitcnt lgkmcnt(0)
  v_perm_b32 v144, v118, v114, s64
  v_perm_b32 v145, v126, v122, s64
  v_perm_b32 v146, v134, v130, s64
  v_perm_b32 v147, v142, v138, s64
  ds_write_b128 v6, v[144:147] offset:32832
  v_perm_b32 v148, v118, v114, s65
  v_perm_b32 v149, v126, v122, s65
  v_perm_b32 v150, v134, v130, s65
  v_perm_b32 v151, v142, v138, s65
  ds_write_b128 v6, v[148:151] offset:32848
  v_perm_b32 v152, v119, v115, s64
  v_perm_b32 v153, v127, v123, s64
  v_perm_b32 v154, v135, v131, s64
  v_perm_b32 v155, v143, v139, s64
  ds_write_b128 v6, v[152:155] offset:32864
  v_perm_b32 v156, v119, v115, s65
  v_perm_b32 v157, v127, v123, s65
  v_perm_b32 v158, v135, v131, s65
  v_perm_b32 v159, v143, v139, s65
  ds_write_b128 v6, v[156:159] offset:32880
  s_waitcnt lgkmcnt(0)
Lwl_skip2_55:
  s_cmp_lg_u32 s48, 0
  s_cbranch_scc1 Lwi_56
  v_mov_b32 v4, 0
  s_mov_b32 s56, 128
  s_mov_b32 s57, 47
  s_cmp_eq_u32 s50, 0
  s_cbranch_scc1 Lwaitd_58
  s_mov_b32 s52, 0
  s_mov_b32 s54, 1
  s_mov_b32 s55, 0
Lwait_57:
  buffer_load_dword v5, v4, s[44:47], s56 offen sc1
  s_add_u32 s52, s52, 1
  s_cmp_gt_u32 s52, 65536
  s_cbranch_scc1 Lwaitd_58
  s_waitcnt vmcnt(0)
  v_cmp_gt_u32 vcc, v5, s57
  s_and_b64 vcc, vcc, s[54:55]
  s_cmp_eq_u64 vcc, s[54:55]
  s_cbranch_scc1 Lwaitd_58
  s_sleep 2
  s_branch Lwait_57
Lwaitd_58:
  s_waitcnt vmcnt(0)
Lwi_56:
  s_waitcnt lgkmcnt(0)
  s_barrier
  v_add_u32 v3, 0x10000, v2
  s_mov_b32 s51, s48
LOOP_WO:
  s_lshl_b32 s69, s66, 2
  s_and_b32 s56, s51, 3
  s_lshl_b32 s56, s56, 2
  s_lshl_b32 s57, s69, 7
  s_add_u32 s56, s56, s57
  s_add_u32 s56, s56, 8192
  s_lshr_b32 s57, s51, 2
  v_min_u32 v4, 3, v1
  v_mul_u32_u24 v4, 128, v4
  s_cmp_eq_u32 s50, 0
  s_cbranch_scc1 Lwaitd_60
  s_mov_b32 s52, 0
  s_mov_b32 s54, 15
  s_mov_b32 s55, 0
Lwait_59:
  buffer_load_dword v5, v4, s[32:35], s56 offen sc1
  s_add_u32 s52, s52, 1
  s_cmp_gt_u32 s52, 65536
  s_cbranch_scc1 Lwaitd_60
  s_waitcnt vmcnt(0)
  v_cmp_gt_u32 vcc, v5, s57
  s_and_b64 vcc, vcc, s[54:55]
  s_cmp_eq_u64 vcc, s[54:55]
  s_cbranch_scc1 Lwaitd_60
  s_sleep 2
  s_branch Lwait_59
Lwaitd_60:
  s_waitcnt vmcnt(0)
  s_lshl_b32 s60, s51, 18
  s_lshl_b32 s52, s66, 15
  s_add_u32 s60, s60, s52
  s_add_u32 s60, s60, 50331648
  buffer_load_dwordx4 a[0:3], v2, s[32:35], s60 offen offset:0 sc1
  buffer_load_dwordx4 a[4:7], v2, s[32:35], s60 offen offset:1024 sc1
  buffer_load_dwordx4 a[8:11], v2, s[32:35], s60 offen offset:2048 sc1
  buffer_load_dwordx4 a[12:15], v2, s[32:35], s60 offen offset:3072 sc1
  s_add_u32 s60, s60, 4096
  buffer_load_dwordx4 a[16:19], v2, s[32:35], s60 offen offset:0 sc1
  buffer_load_dwordx4 a[20:23], v2, s[32:35], s60 offen offset:1024 sc1
  buffer_load_dwordx4 a[24:27], v2, s[32:35], s60 offen offset:2048 sc1
  buffer_load_dwordx4 a[28:31], v2, s[32:35], s60 offen offset:3072 sc1
  s_add_u32 s60, s60, 4096
  buffer_load_dwordx4 a[32:35], v2, s[32:35], s60 offen offset:0 sc1
  buffer_load_dwordx4 a[36:39], v2, s[32:35], s60 offen offset:1024 sc1
  buffer_load_dwordx4 a[40:43], v2, s[32:35], s60 offen offset:2048 sc1
  buffer_load_dwordx4 a[44:47], v2, s[32:35], s60 offen offset:3072 sc1
  s_add_u32 s60, s60, 4096
  buffer_load_dwordx4 a[48:51], v2, s[32:35], s60 offen offset:0 sc1
  buffer_load_dwordx4 a[52:55], v2, s[32:35], s60 offen offset:1024 sc1
  buffer_load_dwordx4 a[56:59], v2, s[32:35], s60 offen offset:2048 sc1
  buffer_load_dwordx4 a[60:63], v2, s[32:35], s60 offen offset:3072 sc1
  s_add_u32 s60, s60, 4096
  buffer_load_dwordx4 a[64:67], v2, s[32:35], s60 offen offset:0 sc1
  buffer_load_dwordx4 a[68:71], v2, s[32:35], s60 offen offset:1024 sc1
  buffer_load_dwordx4 a[72:75], v2, s[32:35], s60 offen offset:2048 sc1
  buffer_load_dwordx4 a[76:79], v2, s[32:35], s60 offen offset:3072 sc1
  s_add_u32 s60, s60, 4096
  buffer_load_dwordx4 a[80:83], v2, s[32:35], s60 offen offset:0 sc1
  buffer_load_dwordx4 a[84:87], v2, s[32:35], s60 offen offset:1024 sc1
  buffer_load_dwordx4 a[88:91], v2, s[32:35], s60 offen offset:2048 sc1
  buffer_load_dwordx4 a[92:95], v2, s[32:35], s60 offen offset:3072 sc1
  s_add_u32 s60, s60, 4096
  buffer_load_dwordx4 a[96:99], v2, s[32:35], s60 offen offset:0 sc1
  buffer_load_dwordx4 a[100:103], v2, s[32:35], s60 offen offset:1024 sc1
  buffer_load_dwordx4 a[104:107], v2, s[32:35], s60 offen offset:2048 sc1
  buffer_load_dwordx4 a[108:111], v2, s[32:35], s60 offen offset:3072 sc1
  s_add_u32 s60, s60, 4096
  buffer_load_dwordx4 a[112:115], v2, s[32:35], s60 offen offset:0 sc1
  buffer_load_dwordx4 a[116:119], v2, s[32:35], s60 offen offset:1024 sc1
  buffer_load_dwordx4 a[120:123], v2, s[32:35], s60 offen offset:2048 sc1
  buffer_load_dwordx4 a[124:127], v2, s[32:35], s60 offen offset:3072 sc1
  ds_read_b128 v[128:131], v2 offset:0
  ds_read_b128 v[132:135], v2 offset:1024
  ds_read_b128 v[136:139], v2 offset:2048
  ds_read_b128 v[140:143], v2 offset:3072
  ds_read_b128 v[144:147], v2 offset:4096
  ds_read_b128 v[148:151], v2 offset:5120
  ds_read_b128 v[152:155], v2 offset:6144
  ds_read_b128 v[156:159], v2 offset:7168
  s_waitcnt vmcnt(31) lgkmcnt(7)
  v_mfma_f32_32x32x16_bf16 v[64:79], v[128:131], a[0:3], 0
  ds_read_b128 v[128:131], v2 offset:8192
  s_waitcnt lgkmcnt(7)
  v_mfma_f32_32x32x16_bf16 v[80:95], v[132:135], a[0:3], 0
  ds_read_b128 v[132:135], v2 offset:9216
  s_waitcnt lgkmcnt(7)
  v_mfma_f32_32x32x16_bf16 v[96:111], v[136:139], a[0:3], 0
  ds_read_b128 v[136:139], v2 offset:10240
  s_waitcnt lgkmcnt(7)
  v_mfma_f32_32x32x16_bf16 v[112:127], v[140:143], a[0:3], 0
  ds_read_b128 v[140:143], v2 offset:11264
  s_waitcnt vmcnt(30) lgkmcnt(7)
  v_mfma_f32_32x32x16_bf16 v[64:79], v[144:147], a[4:7], v[64:79]
  ds_read_b128 v[144:147], v2 offset:12288
  s_waitcnt lgkmcnt(7)
  v_mfma_f32_32x32x16_bf16 v[80:95], v[148:151], a[4:7], v[80:95]
  ds_read_b128 v[148:151], v2 offset:13312
  s_waitcnt lgkmcnt(7)
  v_mfma_f32_32x32x16_bf16 v[96:111], v[152:155], a[4:7], v[96:111]
  ds_read_b128 v[152:155], v2 offset:14336
  s_waitcnt lgkmcnt(7)
  v_mfma_f32_32x32x16_bf16 v[112:127], v[156:159], a[4:7], v[112:127]
  ds_read_b128 v[156:159], v2 offset:15360
  s_waitcnt vmcnt(29) lgkmcnt(7)
  v_mfma_f32_32x32x16_bf16 v[64:79], v[128:131], a[8:11], v[64:79]
  ds_read_b128 v[128:131], v2 offset:16384
  s_waitcnt lgkmcnt(7)
  v_mfma_f32_32x32x16_bf16 v[80:95], v[132:135], a[8:11], v[80:95]
  ds_read_b128 v[132:135], v2 offset:17408
  s_waitcnt lgkmcnt(7)
  v_mfma_f32_32x32x16_bf16 v[96:111], v[136:139], a[8:11], v[96:111]
  ds_read_b128 v[136:139], v2 offset:18432
  s_waitcnt lgkmcnt(7)
  v_mfma_f32_32x32x16_bf16 v[112:127], v[140:143], a[8:11], v[112:127]
  ds_read_b128 v[140:143], v2 offset:19456
  s_waitcnt vmcnt(28) lgkmcnt(7)
  v_mfma_f32_32x32x16_bf16 v[64:79], v[144:147], a[12:15], v[64:79]
  ds_read_b128 v[144:147], v2 offset:20480
  s_waitcnt lgkmcnt(7)
  v_mfma_f32_32x32x16_bf16 v[80:95], v[148:151], a[12:15], v[80:95]
  ds_read_b128 v[148:151], v2 offset:21504
  s_waitcnt lgkmcnt(7)
  v_mfma_f32_32x32x16_bf16 v[96:111], v[152:155], a[12:15], v[96:111]
  ds_read_b128 v[152:155], v2 offset:22528
  s_waitcnt lgkmcnt(7)
  v_mfma_f32_32x32x16_bf16 v[112:127], v[156:159], a[12:15], v[112:127]
  ds_read_b128 v[156:159], v2 offset:23552
  s_waitcnt vmcnt(27) lgkmcnt(7)
  v_mfma_f32_32x32x16_bf16 v[64:79], v[128:131], a[16:19], v[64:79]
  ds_read_b128 v[128:131], v2 offset:24576
  s_waitcnt lgkmcnt(7)
  v_mfma_f32_32x32x16_bf16 v[80:95], v[132:135], a[16:19], v[80:95]
  ds_read_b128 v[132:135], v2 offset:25600
  s_waitcnt lgkmcnt(7)
  v_mfma_f32_32x32x16_bf16 v[96:111], v[136:139], a[16:19], v[96:111]
  ds_read_b128 v[136:139], v2 offset:26624
  s_waitcnt lgkmcnt(7)
  v_mfma_f32_32x32x16_bf16 v[112:127], v[140:143], a[16:19], v[112:127]
  ds_read_b128 v[140:143], v2 offset:27648
  s_waitcnt vmcnt(26) lgkmcnt(7)
  v_mfma_f32_32x32x16_bf16 v[64:79], v[144:147], a[20:23], v[64:79]
  ds_read_b128 v[144:147], v2 offset:28672
  s_waitcnt lgkmcnt(7)
  v_mfma_f32_32x32x16_bf16 v[80:95], v[148:151], a[20:23], v[80:95]
  ds_read_b128 v[148:151], v2 offset:29696
  s_waitcnt lgkmcnt(7)
  v_mfma_f32_32x32x16_bf16 v[96:111], v[152:155], a[20:23], v[96:111]
  ds_read_b128 v[152:155], v2 offset:30720
  s_waitcnt lgkmcnt(7)
  v_mfma_f32_32x32x16_bf16 v[112:127], v[156:159], a[20:23], v[112:127]
  ds_read_b128 v[156:159], v2 offset:31744
  s_waitcnt vmcnt(25) lgkmcnt(7)
  v_mfma_f32_32x32x16_bf16 v[64:79], v[128:131], a[24:27], v[64:79]
  ds_read_b128 v[128:131], v2 offset:32768
  s_waitcnt lgkmcnt(7)
  v_mfma_f32_32x32x16_bf16 v[80:95], v[132:135], a[24:27], v[80:95]
  ds_read_b128 v[132:135], v2 offset:33792
  s_waitcnt lgkmcnt(7)
  v_mfma_f32_32x32x16_bf16 v[96:111], v[136:139], a[24:27], v[96:111]
  ds_read_b128 v[136:139], v2 offset:34816
  s_waitcnt lgkmcnt(7)
  v_mfma_f32_32x32x16_bf16 v[112:127], v[140:143], a[24:27], v[112:127]
  ds_read_b128 v[140:143], v2 offset:35840
  s_waitcnt vmcnt(24) lgkmcnt(7)
  v_mfma_f32_32x32x16_bf16 v[64:79], v[144:147], a[28:31], v[64:79]
  ds_read_b128 v[144:147], v2 offset:36864
  s_waitcnt lgkmcnt(7)
  v_mfma_f32_32x32x16_bf16 v[80:95], v[148:151], a[28:31], v[80:95]
  ds_read_b128 v[148:151], v2 offset:37888
  s_waitcnt lgkmcnt(7)
  v_mfma_f32_32x32x16_bf16 v[96:111], v[152:155], a[28:31], v[96:111]
  ds_read_b128 v[152:155], v2 offset:38912
  s_waitcnt lgkmcnt(7)
  v_mfma_f32_32x32x16_bf16 v[112:127], v[156:159], a[28:31], v[112:127]
  ds_read_b128 v[156:159], v2 offset:39936
  s_waitcnt vmcnt(23) lgkmcnt(7)
  v_mfma_f32_32x32x16_bf16 v[64:79], v[128:131], a[32:35], v[64:79]
  ds_read_b128 v[128:131], v2 offset:40960
  s_waitcnt lgkmcnt(7)
  v_mfma_f32_32x32x16_bf16 v[80:95], v[132:135], a[32:35], v[80:95]
  ds_read_b128 v[132:135], v2 offset:41984
  s_waitcnt lgkmcnt(7)
  v_mfma_f32_32x32x16_bf16 v[96:111], v[136:139], a[32:35], v[96:111]
  ds_read_b128 v[136:139], v2 offset:43008
  s_waitcnt lgkmcnt(7)
  v_mfma_f32_32x32x16_bf16 v[112:127], v[140:143], a[32:35], v[112:127]
  ds_read_b128 v[140:143], v2 offset:44032
  s_waitcnt vmcnt(22) lgkmcnt(7)
  v_mfma_f32_32x32x16_bf16 v[64:79], v[144:147], a[36:39], v[64:79]
  ds_read_b128 v[144:147], v2 offset:45056
  s_waitcnt lgkmcnt(7)
  v_mfma_f32_32x32x16_bf16 v[80:95], v[148:151], a[36:39], v[80:95]
  ds_read_b128 v[148:151], v2 offset:46080
  s_waitcnt lgkmcnt(7)
  v_mfma_f32_32x32x16_bf16 v[96:111], v[152:155], a[36:39], v[96:111]
  ds_read_b128 v[152:155], v2 offset:47104
  s_waitcnt lgkmcnt(7)
  v_mfma_f32_32x32x16_bf16 v[112:127], v[156:159], a[36:39], v[112:127]
  ds_read_b128 v[156:159], v2 offset:48128
  s_waitcnt vmcnt(21) lgkmcnt(7)
  v_mfma_f32_32x32x16_bf16 v[64:79], v[128:131], a[40:43], v[64:79]
  ds_read_b128 v[128:131], v2 offset:49152
  s_waitcnt lgkmcnt(7)
  v_mfma_f32_32x32x16_bf16 v[80:95], v[132:135], a[40:43], v[80:95]
  ds_read_b128 v[132:135], v2 offset:50176
  s_waitcnt lgkmcnt(7)
  v_mfma_f32_32x32x16_bf16 v[96:111], v[136:139], a[40:43], v[96:111]
  ds_read_b128 v[136:139], v2 offset:51200
  s_waitcnt lgkmcnt(7)
  v_mfma_f32_32x32x16_bf16 v[112:127], v[140:143], a[40:43], v[112:127]
  ds_read_b128 v[140:143], v2 offset:52224
  s_waitcnt vmcnt(20) lgkmcnt(7)
  v_mfma_f32_32x32x16_bf16 v[64:79], v[144:147], a[44:47], v[64:79]
  ds_read_b128 v[144:147], v2 offset:53248
  s_waitcnt lgkmcnt(7)
  v_mfma_f32_32x32x16_bf16 v[80:95], v[148:151], a[44:47], v[80:95]
  ds_read_b128 v[148:151], v2 offset:54272
  s_waitcnt lgkmcnt(7)
  v_mfma_f32_32x32x16_bf16 v[96:111], v[152:155], a[44:47], v[96:111]
  ds_read_b128 v[152:155], v2 offset:55296
  s_waitcnt lgkmcnt(7)
  v_mfma_f32_32x32x16_bf16 v[112:127], v[156:159], a[44:47], v[112:127]
  ds_read_b128 v[156:159], v2 offset:56320
  s_waitcnt vmcnt(19) lgkmcnt(7)
  v_mfma_f32_32x32x16_bf16 v[64:79], v[128:131], a[48:51], v[64:79]
  ds_read_b128 v[128:131], v2 offset:57344
  s_waitcnt lgkmcnt(7)
  v_mfma_f32_32x32x16_bf16 v[80:95], v[132:135], a[48:51], v[80:95]
  ds_read_b128 v[132:135], v2 offset:58368
  s_waitcnt lgkmcnt(7)
  v_mfma_f32_32x32x16_bf16 v[96:111], v[136:139], a[48:51], v[96:111]
  ds_read_b128 v[136:139], v2 offset:59392
  s_waitcnt lgkmcnt(7)
  v_mfma_f32_32x32x16_bf16 v[112:127], v[140:143], a[48:51], v[112:127]
  ds_read_b128 v[140:143], v2 offset:60416
  s_waitcnt vmcnt(18) lgkmcnt(7)
  v_mfma_f32_32x32x16_bf16 v[64:79], v[144:147], a[52:55], v[64:79]
  ds_read_b128 v[144:147], v2 offset:61440
  s_waitcnt lgkmcnt(7)
  v_mfma_f32_32x32x16_bf16 v[80:95], v[148:151], a[52:55], v[80:95]
  ds_read_b128 v[148:151], v2 offset:62464
  s_waitcnt lgkmcnt(7)
  v_mfma_f32_32x32x16_bf16 v[96:111], v[152:155], a[52:55], v[96:111]
  ds_read_b128 v[152:155], v2 offset:63488
  s_waitcnt lgkmcnt(7)
  v_mfma_f32_32x32x16_bf16 v[112:127], v[156:159], a[52:55], v[112:127]
  ds_read_b128 v[156:159], v2 offset:64512
  s_waitcnt vmcnt(17) lgkmcnt(7)
  v_mfma_f32_32x32x16_bf16 v[64:79], v[128:131], a[56:59], v[64:79]
  ds_read_b128 v[128:131], v3 offset:0
  s_waitcnt lgkmcnt(7)
  v_mfma_f32_32x32x16_bf16 v[80:95], v[132:135], a[56:59], v[80:95]
  ds_read_b128 v[132:135], v3 offset:1024
  s_waitcnt lgkmcnt(7)
  v_mfma_f32_32x32x16_bf16 v[96:111], v[136:139], a[56:59], v[96:111]
  ds_read_b128 v[136:139], v3 offset:2048
  s_waitcnt lgkmcnt(7)
  v_mfma_f32_32x32x16_bf16 v[112:127], v[140:143], a[56:59], v[112:127]
  ds_read_b128 v[140:143], v3 offset:3072
  s_waitcnt vmcnt(16) lgkmcnt(7)
  v_mfma_f32_32x32x16_bf16 v[64:79], v[144:147], a[60:63], v[64:79]
  ds_read_b128 v[144:147], v3 offset:4096
  s_waitcnt lgkmcnt(7)
  v_mfma_f32_32x32x16_bf16 v[80:95], v[148:151], a[60:63], v[80:95]
  ds_read_b128 v[148:151], v3 offset:5120
  s_waitcnt lgkmcnt(7)
  v_mfma_f32_32x32x16_bf16 v[96:111], v[152:155], a[60:63], v[96:111]
  ds_read_b128 v[152:155], v3 offset:6144
  s_waitcnt lgkmcnt(7)
  v_mfma_f32_32x32x16_bf16 v[112:127], v[156:159], a[60:63], v[112:127]
  ds_read_b128 v[156:159], v3 offset:7168
  s_waitcnt vmcnt(15) lgkmcnt(7)
  v_mfma_f32_32x32x16_bf16 v[64:79], v[128:131], a[64:67], v[64:79]
  ds_read_b128 v[128:131], v3 offset:8192
  s_waitcnt lgkmcnt(7)
  v_mfma_f32_32x32x16_bf16 v[80:95], v[132:135], a[64:67], v[80:95]
  ds_read_b128 v[132:135], v3 offset:9216
  s_waitcnt lgkmcnt(7)
  v_mfma_f32_32x32x16_bf16 v[96:111], v[136:139], a[64:67], v[96:111]
  ds_read_b128 v[136:139], v3 offset:10240
  s_waitcnt lgkmcnt(7)
  v_mfma_f32_32x32x16_bf16 v[112:127], v[140:143], a[64:67], v[112:127]
  ds_read_b128 v[140:143], v3 offset:11264
  s_waitcnt vmcnt(14) lgkmcnt(7)
  v_mfma_f32_32x32x16_bf16 v[64:79], v[144:147], a[68:71], v[64:79]
  ds_read_b128 v[144:147], v3 offset:12288
  s_waitcnt lgkmcnt(7)
  v_mfma_f32_32x32x16_bf16 v[80:95], v[148:151], a[68:71], v[80:95]
  ds_read_b128 v[148:151], v3 offset:13312
  s_waitcnt lgkmcnt(7)
  v_mfma_f32_32x32x16_bf16 v[96:111], v[152:155], a[68:71], v[96:111]
  ds_read_b128 v[152:155], v3 offset:14336
  s_waitcnt lgkmcnt(7)
  v_mfma_f32_32x32x16_bf16 v[112:127], v[156:159], a[68:71], v[112:127]
  ds_read_b128 v[156:159], v3 offset:15360
  s_waitcnt vmcnt(13) lgkmcnt(7)
  v_mfma_f32_32x32x16_bf16 v[64:79], v[128:131], a[72:75], v[64:79]
  ds_read_b128 v[128:131], v3 offset:16384
  s_waitcnt lgkmcnt(7)
  v_mfma_f32_32x32x16_bf16 v[80:95], v[132:135], a[72:75], v[80:95]
  ds_read_b128 v[132:135], v3 offset:17408
  s_waitcnt lgkmcnt(7)
  v_mfma_f32_32x32x16_bf16 v[96:111], v[136:139], a[72:75], v[96:111]
  ds_read_b128 v[136:139], v3 offset:18432
  s_waitcnt lgkmcnt(7)
  v_mfma_f32_32x32x16_bf16 v[112:127], v[140:143], a[72:75], v[112:127]
  ds_read_b128 v[140:143], v3 offset:19456
  s_waitcnt vmcnt(12) lgkmcnt(7)
  v_mfma_f32_32x32x16_bf16 v[64:79], v[144:147], a[76:79], v[64:79]
  ds_read_b128 v[144:147], v3 offset:20480
  s_waitcnt lgkmcnt(7)
  v_mfma_f32_32x32x16_bf16 v[80:95], v[148:151], a[76:79], v[80:95]
  ds_read_b128 v[148:151], v3 offset:21504
  s_waitcnt lgkmcnt(7)
  v_mfma_f32_32x32x16_bf16 v[96:111], v[152:155], a[76:79], v[96:111]
  ds_read_b128 v[152:155], v3 offset:22528
  s_waitcnt lgkmcnt(7)
  v_mfma_f32_32x32x16_bf16 v[112:127], v[156:159], a[76:79], v[112:127]
  ds_read_b128 v[156:159], v3 offset:23552
  s_waitcnt vmcnt(11) lgkmcnt(7)
  v_mfma_f32_32x32x16_bf16 v[64:79], v[128:131], a[80:83], v[64:79]
  ds_read_b128 v[128:131], v3 offset:24576
  s_waitcnt lgkmcnt(7)
  v_mfma_f32_32x32x16_bf16 v[80:95], v[132:135], a[80:83], v[80:95]
  ds_read_b128 v[132:135], v3 offset:25600
  s_waitcnt lgkmcnt(7)
  v_mfma_f32_32x32x16_bf16 v[96:111], v[136:139], a[80:83], v[96:111]
  ds_read_b128 v[136:139], v3 offset:26624
  s_waitcnt lgkmcnt(7)
  v_mfma_f32_32x32x16_bf16 v[112:127], v[140:143], a[80:83], v[112:127]
  ds_read_b128 v[140:143], v3 offset:27648
  s_waitcnt vmcnt(10) lgkmcnt(7)
  v_mfma_f32_32x32x16_bf16 v[64:79], v[144:147], a[84:87], v[64:79]
  ds_read_b128 v[144:147], v3 offset:28672
  s_waitcnt lgkmcnt(7)
  v_mfma_f32_32x32x16_bf16 v[80:95], v[148:151], a[84:87], v[80:95]
  ds_read_b128 v[148:151], v3 offset:29696
  s_waitcnt lgkmcnt(7)
  v_mfma_f32_32x32x16_bf16 v[96:111], v[152:155], a[84:87], v[96:111]
  ds_read_b128 v[152:155], v3 offset:30720
  s_waitcnt lgkmcnt(7)
  v_mfma_f32_32x32x16_bf16 v[112:127], v[156:159], a[84:87], v[112:127]
  ds_read_b128 v[156:159], v3 offset:31744
  s_waitcnt vmcnt(9) lgkmcnt(7)
  v_mfma_f32_32x32x16_bf16 v[64:79], v[128:131], a[88:91], v[64:79]
  ds_read_b128 v[128:131], v3 offset:32768
  s_waitcnt lgkmcnt(7)
  v_mfma_f32_32x32x16_bf16 v[80:95], v[132:135], a[88:91], v[80:95]
  ds_read_b128 v[132:135], v3 offset:33792
  s_waitcnt lgkmcnt(7)
  v_mfma_f32_32x32x16_bf16 v[96:111], v[136:139], a[88:91], v[96:111]
  ds_read_b128 v[136:139], v3 offset:34816
  s_waitcnt lgkmcnt(7)
  v_mfma_f32_32x32x16_bf16 v[112:127], v[140:143], a[88:91], v[112:127]
  ds_read_b128 v[140:143], v3 offset:35840
  s_waitcnt vmcnt(8) lgkmcnt(7)
  v_mfma_f32_32x32x16_bf16 v[64:79], v[144:147], a[92:95], v[64:79]
  ds_read_b128 v[144:147], v3 offset:36864
  s_waitcnt lgkmcnt(7)
  v_mfma_f32_32x32x16_bf16 v[80:95], v[148:151], a[92:95], v[80:95]
  ds_read_b128 v[148:151], v3 offset:37888
  s_waitcnt lgkmcnt(7)
  v_mfma_f32_32x32x16_bf16 v[96:111], v[152:155], a[92:95], v[96:111]
  ds_read_b128 v[152:155], v3 offset:38912
  s_waitcnt lgkmcnt(7)
  v_mfma_f32_32x32x16_bf16 v[112:127], v[156:159], a[92:95], v[112:127]
  ds_read_b128 v[156:159], v3 offset:39936
  s_waitcnt vmcnt(7) lgkmcnt(7)
  v_mfma_f32_32x32x16_bf16 v[64:79], v[128:131], a[96:99], v[64:79]
  ds_read_b128 v[128:131], v3 offset:40960
  s_waitcnt lgkmcnt(7)
  v_mfma_f32_32x32x16_bf16 v[80:95], v[132:135], a[96:99], v[80:95]
  ds_read_b128 v[132:135], v3 offset:41984
  s_waitcnt lgkmcnt(7)
  v_mfma_f32_32x32x16_bf16 v[96:111], v[136:139], a[96:99], v[96:111]
  ds_read_b128 v[136:139], v3 offset:43008
  s_waitcnt lgkmcnt(7)
  v_mfma_f32_32x32x16_bf16 v[112:127], v[140:143], a[96:99], v[112:127]
  ds_read_b128 v[140:143], v3 offset:44032
  s_waitcnt vmcnt(6) lgkmcnt(7)
  v_mfma_f32_32x32x16_bf16 v[64:79], v[144:147], a[100:103], v[64:79]
  ds_read_b128 v[144:147], v3 offset:45056
  s_waitcnt lgkmcnt(7)
  v_mfma_f32_32x32x16_bf16 v[80:95], v[148:151], a[100:103], v[80:95]
  ds_read_b128 v[148:151], v3 offset:46080
  s_waitcnt lgkmcnt(7)
  v_mfma_f32_32x32x16_bf16 v[96:111], v[152:155], a[100:103], v[96:111]
  ds_read_b128 v[152:155], v3 offset:47104
  s_waitcnt lgkmcnt(7)
  v_mfma_f32_32x32x16_bf16 v[112:127], v[156:159], a[100:103], v[112:127]
  ds_read_b128 v[156:159], v3 offset:48128
  s_waitcnt vmcnt(5) lgkmcnt(7)
  v_mfma_f32_32x32x16_bf16 v[64:79], v[128:131], a[104:107], v[64:79]
  ds_read_b128 v[128:131], v3 offset:49152
  s_waitcnt lgkmcnt(7)
  v_mfma_f32_32x32x16_bf16 v[80:95], v[132:135], a[104:107], v[80:95]
  ds_read_b128 v[132:135], v3 offset:50176
  s_waitcnt lgkmcnt(7)
  v_mfma_f32_32x32x16_bf16 v[96:111], v[136:139], a[104:107], v[96:111]
  ds_read_b128 v[136:139], v3 offset:51200
  s_waitcnt lgkmcnt(7)
  v_mfma_f32_32x32x16_bf16 v[112:127], v[140:143], a[104:107], v[112:127]
  ds_read_b128 v[140:143], v3 offset:52224
  s_waitcnt vmcnt(4) lgkmcnt(7)
  v_mfma_f32_32x32x16_bf16 v[64:79], v[144:147], a[108:111], v[64:79]
  ds_read_b128 v[144:147], v3 offset:53248
  s_waitcnt lgkmcnt(7)
  v_mfma_f32_32x32x16_bf16 v[80:95], v[148:151], a[108:111], v[80:95]
  ds_read_b128 v[148:151], v3 offset:54272
  s_waitcnt lgkmcnt(7)
  v_mfma_f32_32x32x16_bf16 v[96:111], v[152:155], a[108:111], v[96:111]
  ds_read_b128 v[152:155], v3 offset:55296
  s_waitcnt lgkmcnt(7)
  v_mfma_f32_32x32x16_bf16 v[112:127], v[156:159], a[108:111], v[112:127]
  ds_read_b128 v[156:159], v3 offset:56320
  s_waitcnt vmcnt(3) lgkmcnt(7)
  v_mfma_f32_32x32x16_bf16 v[64:79], v[128:131], a[112:115], v[64:79]
  ds_read_b128 v[128:131], v3 offset:57344
  s_waitcnt lgkmcnt(7)
  v_mfma_f32_32x32x16_bf16 v[80:95], v[132:135], a[112:115], v[80:95]
  ds_read_b128 v[132:135], v3 offset:58368
  s_waitcnt lgkmcnt(7)
  v_mfma_f32_32x32x16_bf16 v[96:111], v[136:139], a[112:115], v[96:111]
  ds_read_b128 v[136:139], v3 offset:59392
  s_waitcnt lgkmcnt(7)
  v_mfma_f32_32x32x16_bf16 v[112:127], v[140:143], a[112:115], v[112:127]
  ds_read_b128 v[140:143], v3 offset:60416
  s_waitcnt vmcnt(2) lgkmcnt(7)
  v_mfma_f32_32x32x16_bf16 v[64:79], v[144:147], a[116:119], v[64:79]
  ds_read_b128 v[144:147], v3 offset:61440
  s_waitcnt lgkmcnt(7)
  v_mfma_f32_32x32x16_bf16 v[80:95], v[148:151], a[116:119], v[80:95]
  ds_read_b128 v[148:151], v3 offset:62464
  s_waitcnt lgkmcnt(7)
  v_mfma_f32_32x32x16_bf16 v[96:111], v[152:155], a[116:119], v[96:111]
  ds_read_b128 v[152:155], v3 offset:63488
  s_waitcnt lgkmcnt(7)
  v_mfma_f32_32x32x16_bf16 v[112:127], v[156:159], a[116:119], v[112:127]
  ds_read_b128 v[156:159], v3 offset:64512
  s_waitcnt vmcnt(1) lgkmcnt(7)
  v_mfma_f32_32x32x16_bf16 v[64:79], v[128:131], a[120:123], v[64:79]
  s_waitcnt lgkmcnt(6)
  v_mfma_f32_32x32x16_bf16 v[80:95], v[132:135], a[120:123], v[80:95]
  s_waitcnt lgkmcnt(5)
  v_mfma_f32_32x32x16_bf16 v[96:111], v[136:139], a[120:123], v[96:111]
  s_waitcnt lgkmcnt(4)
  v_mfma_f32_32x32x16_bf16 v[112:127], v[140:143], a[120:123], v[112:127]
  s_waitcnt vmcnt(0) lgkmcnt(3)
  v_mfma_f32_32x32x16_bf16 v[64:79], v[144:147], a[124:127], v[64:79]
  s_waitcnt lgkmcnt(2)
  v_mfma_f32_32x32x16_bf16 v[80:95], v[148:151], a[124:127], v[80:95]
  s_waitcnt lgkmcnt(1)
  v_mfma_f32_32x32x16_bf16 v[96:111], v[152:155], a[124:127], v[96:111]
  s_waitcnt lgkmcnt(0)
  v_mfma_f32_32x32x16_bf16 v[112:127], v[156:159], a[124:127], v[112:127]
  s_nop 15
  s_lshl_b32 s61, s68, 6
  s_add_u32 s61, s61, s51
  s_lshl_b32 s61, s61, 16
  s_lshl_b32 s52, s67, 14
  s_add_u32 s61, s61, s52
  s_add_u32 s61, s61, 83886080
  buffer_store_dwordx4 v[64:67], v2, s[32:35], s61 offen offset:0 sc1
  buffer_store_dwordx4 v[68:71], v2, s[32:35], s61 offen offset:1024 sc1
  buffer_store_dwordx4 v[72:75], v2, s[32:35], s61 offen offset:2048 sc1
  buffer_store_dwordx4 v[76:79], v2, s[32:35], s61 offen offset:3072 sc1
  s_add_u32 s61, s61, 4096
  buffer_store_dwordx4 v[80:83], v2, s[32:35], s61 offen offset:0 sc1
  buffer_store_dwordx4 v[84:87], v2, s[32:35], s61 offen offset:1024 sc1
  buffer_store_dwordx4 v[88:91], v2, s[32:35], s61 offen offset:2048 sc1
  buffer_store_dwordx4 v[92:95], v2, s[32:35], s61 offen offset:3072 sc1
  s_add_u32 s61, s61, 4096
  buffer_store_dwordx4 v[96:99], v2, s[32:35], s61 offen offset:0 sc1
  buffer_store_dwordx4 v[100:103], v2, s[32:35], s61 offen offset:1024 sc1
  buffer_store_dwordx4 v[104:107], v2, s[32:35], s61 offen offset:2048 sc1
  buffer_store_dwordx4 v[108:111], v2, s[32:35], s61 offen offset:3072 sc1
  s_add_u32 s61, s61, 4096
  buffer_store_dwordx4 v[112:115], v2, s[32:35], s61 offen offset:0 sc1
  buffer_store_dwordx4 v[116:119], v2, s[32:35], s61 offen offset:1024 sc1
  buffer_store_dwordx4 v[120:123], v2, s[32:35], s61 offen offset:2048 sc1
  buffer_store_dwordx4 v[124:127], v2, s[32:35], s61 offen offset:3072 sc1
  s_lshl_b32 s56, s48, 2
  s_lshl_b32 s57, s49, 7
  s_add_u32 s56, s56, s57
  s_add_u32 s56, s56, 16384
  s_lshr_b32 s57, s51, 2
  s_add_u32 s57, s57, 1
  s_waitcnt vmcnt(0)
  s_cmp_eq_u32 s50, 0
  s_cbranch_scc1 Lsig_61
  v_mov_b32 v4, s57
  v_mov_b32 v5, 0
  s_mov_b64 exec, 1
  buffer_store_dword v4, v5, s[32:35], s56 offen sc1
  s_mov_b64 exec, -1
Lsig_61:
  s_add_u32 s51, s51, 4
  s_cmp_lt_u32 s51, 64
  s_cbranch_scc1 LOOP_WO
  s_waitcnt vmcnt(0)
  s_endpgm
ROLE_DOWN:
  s_mov_b32 s36, s24
  s_mov_b32 s37, s25
  s_mov_b32 s38, 1835008
  s_mov_b32 s39, 0x00020000
  s_lshr_b32 s66, s49, 2
  s_and_b32 s67, s49, 3
  s_mul_i32 s62, s66, 458752
  s_lshl_b32 s52, s67, 8
  s_add_u32 s62, s62, s52
  s_add_u32 s68, s66, 8
  s_mul_i32 s49, s67, 12
  s_add_u32 s49, s49, s68
  s_cmp_lg_u32 s48, 0
  s_cbranch_scc1 Lwi_62
  v_mov_b32 v4, 0
  s_mov_b32 s56, 128
  s_mov_b32 s57, 47
  s_cmp_eq_u32 s50, 0
  s_cbranch_scc1 Lwaitd_64
  s_mov_b32 s52, 0
  s_mov_b32 s54, 1
  s_mov_b32 s55, 0
Lwait_63:
  buffer_load_dword v5, v4, s[44:47], s56 offen sc1
  s_add_u32 s52, s52, 1
  s_cmp_gt_u32 s52, 65536
  s_cbranch_scc1 Lwaitd_64
  s_waitcnt vmcnt(0)
  v_cmp_gt_u32 vcc, v5, s57
  s_and_b64 vcc, vcc, s[54:55]
  s_cmp_eq_u64 vcc, s[54:55]
  s_cbranch_scc1 Lwaitd_64
  s_sleep 2
  s_branch Lwait_63
Lwaitd_64:
  s_waitcnt vmcnt(0)
Lwi_62:
  s_barrier
  v_mov_b32 v4, 0
  s_mov_b32 s56, 0
  s_mov_b32 s57, 0
  s_cmp_eq_u32 s50, 0
  s_cbranch_scc1 Lwaitd_66
  s_mov_b32 s52, 0
  s_mov_b32 s54, 1
  s_mov_b32 s55, 0
Lwait_65:
  buffer_load_dword v5, v4, s[32:35], s56 offen sc1
  s_add_u32 s52, s52, 1
  s_cmp_gt_u32 s52, 65536
  s_cbranch_scc1 Lwaitd_66
  s_waitcnt vmcnt(0)
  v_cmp_gt_u32 vcc, v5, s57
  s_and_b64 vcc, vcc, s[54:55]
  s_cmp_eq_u64 vcc, s[54:55]
  s_cbranch_scc1 Lwaitd_66
  s_sleep 16
  s_branch Lwait_65
Lwaitd_66:
  s_waitcnt vmcnt(0)
  v_and_b32 v7, 15, v1
  v_lshlrev_b32 v4, 4, v7
  v_lshrrev_b32 v7, 5, v1
  v_mul_u32_u24 v8, 16384, v7
  v_add_u32 v4, v4, v8
  v_bfe_u32 v9, v1, 4, 1
  v_mul_u32_u24 v8, 4096, v9
  v_add_u32 v4, v4, v8
  v_lshlrev_b32 v5, 12, v7
  v_lshl_add_u32 v5, v9, 9, v5
  v_bfe_u32 v8, v1, 2, 2
  v_lshl_add_u32 v5, v8, 10, v5
  v_and_b32 v8, 3, v1
  v_lshl_add_u32 v5, v8, 7, v5
  s_lshl_b32 s52, s48, 13
  v_add_u32 v5, s52, v5
  v_add_u32 v6, 0x10000, v5
  s_mul_i32 s52, s48, 32768
  s_add_u32 s52, s52, s62
  s_add_u32 s53, s52, 0
  buffer_load_dwordx4 v[16:19], v4, s[36:39], s53 offen
  s_add_u32 s53, s52, 1024
  buffer_load_dwordx4 v[20:23], v4, s[36:39], s53 offen
  s_add_u32 s53, s52, 2048
  buffer_load_dwordx4 v[24:27], v4, s[36:39], s53 offen
  s_add_u32 s53, s52, 3072
  buffer_load_dwordx4 v[28:31], v4, s[36:39], s53 offen
  s_add_u32 s53, s52, 8192
  buffer_load_dwordx4 v[32:35], v4, s[36:39], s53 offen
  s_add_u32 s53, s52, 9216
  buffer_load_dwordx4 v[36:39], v4, s[36:39], s53 offen
  s_add_u32 s53, s52, 10240
  buffer_load_dwordx4 v[40:43], v4, s[36:39], s53 offen
  s_add_u32 s53, s52, 11264
  buffer_load_dwordx4 v[44:47], v4, s[36:39], s53 offen
  s_add_u32 s53, s52, 131072
  buffer_load_dwordx4 v[48:51], v4, s[36:39], s53 offen
  s_add_u32 s53, s52, 132096
  buffer_load_dwordx4 v[52:55], v4, s[36:39], s53 offen
  s_add_u32 s53, s52, 133120
  buffer_load_dwordx4 v[56:59], v4, s[36:39], s53 offen
  s_add_u32 s53, s52, 134144
  buffer_load_dwordx4 v[60:63], v4, s[36:39], s53 offen
  s_add_u32 s53, s52, 139264
  buffer_load_dwordx4 v[64:67], v4, s[36:39], s53 offen
  s_add_u32 s53, s52, 140288
  buffer_load_dwordx4 v[68:71], v4, s[36:39], s53 offen
  s_add_u32 s53, s52, 141312
  buffer_load_dwordx4 v[72:75], v4, s[36:39], s53 offen
  s_add_u32 s53, s52, 142336
  buffer_load_dwordx4 v[76:79], v4, s[36:39], s53 offen
  s_add_u32 s53, s52, 262144
  buffer_load_dwordx4 v[80:83], v4, s[36:39], s53 offen
  s_add_u32 s53, s52, 263168
  buffer_load_dwordx4 v[84:87], v4, s[36:39], s53 offen
  s_add_u32 s53, s52, 264192
  buffer_load_dwordx4 v[88:91], v4, s[36:39], s53 offen
  s_add_u32 s53, s52, 265216
  buffer_load_dwordx4 v[92:95], v4, s[36:39], s53 offen
  s_add_u32 s53, s52, 270336
  buffer_load_dwordx4 v[96:99], v4, s[36:39], s53 offen
  s_add_u32 s53, s52, 271360
  buffer_load_dwordx4 v[100:103], v4, s[36:39], s53 offen
  s_add_u32 s53, s52, 272384
  buffer_load_dwordx4 v[104:107], v4, s[36:39], s53 offen
  s_add_u32 s53, s52, 273408
  buffer_load_dwordx4 v[108:111], v4, s[36:39], s53 offen
  s_cmp_ge_u32 s48, 2
  s_cbranch_scc1 Lwl_skip_67
  s_add_u32 s53, s52, 393216
  buffer_load_dwordx4 v[112:115], v4, s[36:39], s53 offen
  s_add_u32 s53, s52, 394240
  buffer_load_dwordx4 v[116:119], v4, s[36:39], s53 offen
  s_add_u32 s53, s52, 395264
  buffer_load_dwordx4 v[120:123], v4, s[36:39], s53 offen
  s_add_u32 s53, s52, 396288
  buffer_load_dwordx4 v[124:127], v4, s[36:39], s53 offen
  s_add_u32 s53, s52, 401408
  buffer_load_dwordx4 v[128:131], v4, s[36:39], s53 offen
  s_add_u32 s53, s52, 402432
  buffer_load_dwordx4 v[132:135], v4, s[36:39], s53 offen
  s_add_u32 s53, s52, 403456
  buffer_load_dwordx4 v[136:139], v4, s[36:39], s53 offen
  s_add_u32 s53, s52, 404480
  buffer_load_dwordx4 v[140:143], v4, s[36:39], s53 offen
Lwl_skip_67:
  s_waitcnt vmcnt(0)
  v_perm_b32 v144, v20, v16, s64
  v_perm_b32 v145, v28, v24, s64
  v_perm_b32 v146, v36, v32, s64
  v_perm_b32 v147, v44, v40, s64
  ds_write_b128 v5, v[144:147] offset:0
  v_perm_b32 v148, v20, v16, s65
  v_perm_b32 v149, v28, v24, s65
  v_perm_b32 v150, v36, v32, s65
  v_perm_b32 v151, v44, v40, s65
  ds_write_b128 v5, v[148:151] offset:16
  v_perm_b32 v152, v21, v17, s64
  v_perm_b32 v153, v29, v25, s64
  v_perm_b32 v154, v37, v33, s64
  v_perm_b32 v155, v45, v41, s64
  ds_write_b128 v5, v[152:155] offset:32
  v_perm_b32 v156, v21, v17, s65
  v_perm_b32 v157, v29, v25, s65
  v_perm_b32 v158, v37, v33, s65
  v_perm_b32 v159, v45, v41, s65
  ds_write_b128 v5, v[156:159] offset:48
  s_waitcnt lgkmcnt(0)
  v_perm_b32 v144, v22, v18, s64
  v_perm_b32 v145, v30, v26, s64
  v_perm_b32 v146, v38, v34, s64
  v_perm_b32 v147, v46, v42, s64
  ds_write_b128 v5, v[144:147] offset:64
  v_perm_b32 v148, v22, v18, s65
  v_perm_b32 v149, v30, v26, s65
  v_perm_b32 v150, v38, v34, s65
  v_perm_b32 v151, v46, v42, s65
  ds_write_b128 v5, v[148:151] offset:80
  v_perm_b32 v152, v23, v19, s64
  v_perm_b32 v153, v31, v27, s64
  v_perm_b32 v154, v39, v35, s64
  v_perm_b32 v155, v47, v43, s64
  ds_write_b128 v5, v[152:155] offset:96
  v_perm_b32 v156, v23, v19, s65
  v_perm_b32 v157, v31, v27, s65
  v_perm_b32 v158, v39, v35, s65
  v_perm_b32 v159, v47, v43, s65
  ds_write_b128 v5, v[156:159] offset:112
  s_waitcnt lgkmcnt(0)
  v_perm_b32 v144, v52, v48, s64
  v_perm_b32 v145, v60, v56, s64
  v_perm_b32 v146, v68, v64, s64
  v_perm_b32 v147, v76, v72, s64
  ds_write_b128 v5, v[144:147] offset:32768
  v_perm_b32 v148, v52, v48, s65
  v_perm_b32 v149, v60, v56, s65
  v_perm_b32 v150, v68, v64, s65
  v_perm_b32 v151, v76, v72, s65
  ds_write_b128 v5, v[148:151] offset:32784
  v_perm_b32 v152, v53, v49, s64
  v_perm_b32 v153, v61, v57, s64
  v_perm_b32 v154, v69, v65, s64
  v_perm_b32 v155, v77, v73, s64
  ds_write_b128 v5, v[152:155] offset:32800
  v_perm_b32 v156, v53, v49, s65
  v_perm_b32 v157, v61, v57, s65
  v_perm_b32 v158, v69, v65, s65
  v_perm_b32 v159, v77, v73, s65
  ds_write_b128 v5, v[156:159] offset:32816
  s_waitcnt lgkmcnt(0)
  v_perm_b32 v144, v54, v50, s64
  v_perm_b32 v145, v62, v58, s64
  v_perm_b32 v146, v70, v66, s64
  v_perm_b32 v147, v78, v74, s64
  ds_write_b128 v5, v[144:147] offset:32832
  v_perm_b32 v148, v54, v50, s65
  v_perm_b32 v149, v62, v58, s65
  v_perm_b32 v150, v70, v66, s65
  v_perm_b32 v151, v78, v74, s65
  ds_write_b128 v5, v[148:151] offset:32848
  v_perm_b32 v152, v55, v51, s64
  v_perm_b32 v153, v63, v59, s64
  v_perm_b32 v154, v71, v67, s64
  v_perm_b32 v155, v79, v75, s64
  ds_write_b128 v5, v[152:155] offset:32864
  v_perm_b32 v156, v55, v51, s65
  v_perm_b32 v157, v63, v59, s65
  v_perm_b32 v158, v71, v67, s65
  v_perm_b32 v159, v79, v75, s65
  ds_write_b128 v5, v[156:159] offset:32880
  s_waitcnt lgkmcnt(0)
  v_perm_b32 v144, v84, v80, s64
  v_perm_b32 v145, v92, v88, s64
  v_perm_b32 v146, v100, v96, s64
  v_perm_b32 v147, v108, v104, s64
  ds_write_b128 v6, v[144:147] offset:0
  v_perm_b32 v148, v84, v80, s65
  v_perm_b32 v149, v92, v88, s65
  v_perm_b32 v150, v100, v96, s65
  v_perm_b32 v151, v108, v104, s65
  ds_write_b128 v6, v[148:151] offset:16
  v_perm_b32 v152, v85, v81, s64
  v_perm_b32 v153, v93, v89, s64
  v_perm_b32 v154, v101, v97, s64
  v_perm_b32 v155, v109, v105, s64
  ds_write_b128 v6, v[152:155] offset:32
  v_perm_b32 v156, v85, v81, s65
  v_perm_b32 v157, v93, v89, s65
  v_perm_b32 v158, v101, v97, s65
  v_perm_b32 v159, v109, v105, s65
  ds_write_b128 v6, v[156:159] offset:48
  s_waitcnt lgkmcnt(0)
  v_perm_b32 v144, v86, v82, s64
  v_perm_b32 v145, v94, v90, s64
  v_perm_b32 v146, v102, v98, s64
  v_perm_b32 v147, v110, v106, s64
  ds_write_b128 v6, v[144:147] offset:64
  v_perm_b32 v148, v86, v82, s65
  v_perm_b32 v149, v94, v90, s65
  v_perm_b32 v150, v102, v98, s65
  v_perm_b32 v151, v110, v106, s65
  ds_write_b128 v6, v[148:151] offset:80
  v_perm_b32 v152, v87, v83, s64
  v_perm_b32 v153, v95, v91, s64
  v_perm_b32 v154, v103, v99, s64
  v_perm_b32 v155, v111, v107, s64
  ds_write_b128 v6, v[152:155] offset:96
  v_perm_b32 v156, v87, v83, s65
  v_perm_b32 v157, v95, v91, s65
  v_perm_b32 v158, v103, v99, s65
  v_perm_b32 v159, v111, v107, s65
  ds_write_b128 v6, v[156:159] offset:112
  s_waitcnt lgkmcnt(0)
  s_cmp_ge_u32 s48, 2
  s_cbranch_scc1 Lwl_skip2_68
  v_perm_b32 v144, v116, v112, s64
  v_perm_b32 v145, v124, v120, s64
  v_perm_b32 v146, v132, v128, s64
  v_perm_b32 v147, v140, v136, s64
  ds_write_b128 v6, v[144:147] offset:32768
  v_perm_b32 v148, v116, v112, s65
  v_perm_b32 v149, v124, v120, s65
  v_perm_b32 v150, v132, v128, s65
  v_perm_b32 v151, v140, v136, s65
  ds_write_b128 v6, v[148:151] offset:32784
  v_perm_b32 v152, v117, v113, s64
  v_perm_b32 v153, v125, v121, s64
  v_perm_b32 v154, v133, v129, s64
  v_perm_b32 v155, v141, v137, s64
  ds_write_b128 v6, v[152:155] offset:32800
  v_perm_b32 v156, v117, v113, s65
  v_perm_b32 v157, v125, v121, s65
  v_perm_b32 v158, v133, v129, s65
  v_perm_b32 v159, v141, v137, s65
  ds_write_b128 v6, v[156:159] offset:32816
  s_waitcnt lgkmcnt(0)
  v_perm_b32 v144, v118, v114, s64
  v_perm_b32 v145, v126, v122, s64
  v_perm_b32 v146, v134, v130, s64
  v_perm_b32 v147, v142, v138, s64
  ds_write_b128 v6, v[144:147] offset:32832
  v_perm_b32 v148, v118, v114, s65
  v_perm_b32 v149, v126, v122, s65
  v_perm_b32 v150, v134, v130, s65
  v_perm_b32 v151, v142, v138, s65
  ds_write_b128 v6, v[148:151] offset:32848
  v_perm_b32 v152, v119, v115, s64
  v_perm_b32 v153, v127, v123, s64
  v_perm_b32 v154, v135, v131, s64
  v_perm_b32 v155, v143, v139, s64
  ds_write_b128 v6, v[152:155] offset:32864
  v_perm_b32 v156, v119, v115, s65
  v_perm_b32 v157, v127, v123, s65
  v_perm_b32 v158, v135, v131, s65
  v_perm_b32 v159, v143, v139, s65
  ds_write_b128 v6, v[156:159] offset:32880
  s_waitcnt lgkmcnt(0)
Lwl_skip2_68:
  s_cmp_lg_u32 s48, 0
  s_cbranch_scc1 Lwi_69
  v_mov_b32 v4, 0
  s_mov_b32 s56, 128
  s_mov_b32 s57, 47
  s_cmp_eq_u32 s50, 0
  s_cbranch_scc1 Lwaitd_71
  s_mov_b32 s52, 0
  s_mov_b32 s54, 1
  s_mov_b32 s55, 0
Lwait_70:
  buffer_load_dword v5, v4, s[44:47], s56 offen sc1
  s_add_u32 s52, s52, 1
  s_cmp_gt_u32 s52, 65536
  s_cbranch_scc1 Lwaitd_71
  s_waitcnt vmcnt(0)
  v_cmp_gt_u32 vcc, v5, s57
  s_and_b64 vcc, vcc, s[54:55]
  s_cmp_eq_u64 vcc, s[54:55]
  s_cbranch_scc1 Lwaitd_71
  s_sleep 2
  s_branch Lwait_70
Lwaitd_71:
  s_waitcnt vmcnt(0)
Lwi_69:
  s_waitcnt lgkmcnt(0)
  s_barrier
  v_add_u32 v3, 0x10000, v2
  s_mov_b32 s51, s48
LOOP_DOWN:
  s_mul_i32 s69, s66, 7
  s_and_b32 s56, s51, 3
  s_lshl_b32 s56, s56, 2
  s_lshl_b32 s57, s69, 7
  s_add_u32 s56, s56, s57
  s_add_u32 s56, s56, 12288
  s_lshr_b32 s57, s51, 2
  v_min_u32 v4, 6, v1
  v_mul_u32_u24 v4, 128, v4
  s_cmp_eq_u32 s50, 0
  s_cbranch_scc1 Lwaitd_73
  s_mov_b32 s52, 0
  s_mov_b32 s54, 127
  s_mov_b32 s55, 0
Lwait_72:
  buffer_load_dword v5, v4, s[32:35], s56 offen sc1
  s_add_u32 s52, s52, 1
  s_cmp_gt_u32 s52, 65536
  s_cbranch_scc1 Lwaitd_73
  s_waitcnt vmcnt(0)
  v_cmp_gt_u32 vcc, v5, s57
  s_and_b64 vcc, vcc, s[54:55]
  s_cmp_eq_u64 vcc, s[54:55]
  s_cbranch_scc1 Lwaitd_73
  s_sleep 2
  s_branch Lwait_72
Lwaitd_73:
  s_waitcnt vmcnt(0)
  s_mul_i32 s60, s51, 114688
  s_mul_i32 s52, s66, 28672
  s_add_u32 s60, s60, s52
  s_add_u32 s60, s60, 67108864
  buffer_load_dwordx4 a[0:3], v2, s[32:35], s60 offen offset:0 sc1
  buffer_load_dwordx4 a[4:7], v2, s[32:35], s60 offen offset:1024 sc1
  buffer_load_dwordx4 a[8:11], v2, s[32:35], s60 offen offset:2048 sc1
  buffer_load_dwordx4 a[12:15], v2, s[32:35], s60 offen offset:3072 sc1
  s_add_u32 s60, s60, 4096
  buffer_load_dwordx4 a[16:19], v2, s[32:35], s60 offen offset:0 sc1
  buffer_load_dwordx4 a[20:23], v2, s[32:35], s60 offen offset:1024 sc1
  buffer_load_dwordx4 a[24:27], v2, s[32:35], s60 offen offset:2048 sc1
  buffer_load_dwordx4 a[28:31], v2, s[32:35], s60 offen offset:3072 sc1
  s_add_u32 s60, s60, 4096
  buffer_load_dwordx4 a[32:35], v2, s[32:35], s60 offen offset:0 sc1
  buffer_load_dwordx4 a[36:39], v2, s[32:35], s60 offen offset:1024 sc1
  buffer_load_dwordx4 a[40:43], v2, s[32:35], s60 offen offset:2048 sc1
  buffer_load_dwordx4 a[44:47], v2, s[32:35], s60 offen offset:3072 sc1
  s_add_u32 s60, s60, 4096
  buffer_load_dwordx4 a[48:51], v2, s[32:35], s60 offen offset:0 sc1
  buffer_load_dwordx4 a[52:55], v2, s[32:35], s60 offen offset:1024 sc1
  buffer_load_dwordx4 a[56:59], v2, s[32:35], s60 offen offset:2048 sc1
  buffer_load_dwordx4 a[60:63], v2, s[32:35], s60 offen offset:3072 sc1
  s_add_u32 s60, s60, 4096
  buffer_load_dwordx4 a[64:67], v2, s[32:35], s60 offen offset:0 sc1
  buffer_load_dwordx4 a[68:71], v2, s[32:35], s60 offen offset:1024 sc1
  buffer_load_dwordx4 a[72:75], v2, s[32:35], s60 offen offset:2048 sc1
  buffer_load_dwordx4 a[76:79], v2, s[32:35], s60 offen offset:3072 sc1
  s_add_u32 s60, s60, 4096
  buffer_load_dwordx4 a[80:83], v2, s[32:35], s60 offen offset:0 sc1
  buffer_load_dwordx4 a[84:87], v2, s[32:35], s60 offen offset:1024 sc1
  buffer_load_dwordx4 a[88:91], v2, s[32:35], s60 offen offset:2048 sc1
  buffer_load_dwordx4 a[92:95], v2, s[32:35], s60 offen offset:3072 sc1
  s_add_u32 s60, s60, 4096
  buffer_load_dwordx4 a[96:99], v2, s[32:35], s60 offen offset:0 sc1
  buffer_load_dwordx4 a[100:103], v2, s[32:35], s60 offen offset:1024 sc1
  buffer_load_dwordx4 a[104:107], v2, s[32:35], s60 offen offset:2048 sc1
  buffer_load_dwordx4 a[108:111], v2, s[32:35], s60 offen offset:3072 sc1
  ds_read_b128 v[128:131], v2 offset:0
  ds_read_b128 v[132:135], v2 offset:1024
  ds_read_b128 v[136:139], v2 offset:2048
  ds_read_b128 v[140:143], v2 offset:3072
  ds_read_b128 v[144:147], v2 offset:4096
  ds_read_b128 v[148:151], v2 offset:5120
  ds_read_b128 v[152:155], v2 offset:6144
  ds_read_b128 v[156:159], v2 offset:7168
  s_waitcnt vmcnt(27) lgkmcnt(7)
  v_mfma_f32_32x32x16_bf16 v[64:79], v[128:131], a[0:3], 0
  ds_read_b128 v[128:131], v2 offset:8192
  s_waitcnt lgkmcnt(7)
  v_mfma_f32_32x32x16_bf16 v[80:95], v[132:135], a[0:3], 0
  ds_read_b128 v[132:135], v2 offset:9216
  s_waitcnt lgkmcnt(7)
  v_mfma_f32_32x32x16_bf16 v[96:111], v[136:139], a[0:3], 0
  ds_read_b128 v[136:139], v2 offset:10240
  s_waitcnt lgkmcnt(7)
  v_mfma_f32_32x32x16_bf16 v[112:127], v[140:143], a[0:3], 0
  ds_read_b128 v[140:143], v2 offset:11264
  s_waitcnt vmcnt(26) lgkmcnt(7)
  v_mfma_f32_32x32x16_bf16 v[64:79], v[144:147], a[4:7], v[64:79]
  ds_read_b128 v[144:147], v2 offset:12288
  s_waitcnt lgkmcnt(7)
  v_mfma_f32_32x32x16_bf16 v[80:95], v[148:151], a[4:7], v[80:95]
  ds_read_b128 v[148:151], v2 offset:13312
  s_waitcnt lgkmcnt(7)
  v_mfma_f32_32x32x16_bf16 v[96:111], v[152:155], a[4:7], v[96:111]
  ds_read_b128 v[152:155], v2 offset:14336
  s_waitcnt lgkmcnt(7)
  v_mfma_f32_32x32x16_bf16 v[112:127], v[156:159], a[4:7], v[112:127]
  ds_read_b128 v[156:159], v2 offset:15360
  s_waitcnt vmcnt(25) lgkmcnt(7)
  v_mfma_f32_32x32x16_bf16 v[64:79], v[128:131], a[8:11], v[64:79]
  ds_read_b128 v[128:131], v2 offset:16384
  s_waitcnt lgkmcnt(7)
  v_mfma_f32_32x32x16_bf16 v[80:95], v[132:135], a[8:11], v[80:95]
  ds_read_b128 v[132:135], v2 offset:17408
  s_waitcnt lgkmcnt(7)
  v_mfma_f32_32x32x16_bf16 v[96:111], v[136:139], a[8:11], v[96:111]
  ds_read_b128 v[136:139], v2 offset:18432
  s_waitcnt lgkmcnt(7)
  v_mfma_f32_32x32x16_bf16 v[112:127], v[140:143], a[8:11], v[112:127]
  ds_read_b128 v[140:143], v2 offset:19456
  s_waitcnt vmcnt(24) lgkmcnt(7)
  v_mfma_f32_32x32x16_bf16 v[64:79], v[144:147], a[12:15], v[64:79]
  ds_read_b128 v[144:147], v2 offset:20480
  s_waitcnt lgkmcnt(7)
  v_mfma_f32_32x32x16_bf16 v[80:95], v[148:151], a[12:15], v[80:95]
  ds_read_b128 v[148:151], v2 offset:21504
  s_waitcnt lgkmcnt(7)
  v_mfma_f32_32x32x16_bf16 v[96:111], v[152:155], a[12:15], v[96:111]
  ds_read_b128 v[152:155], v2 offset:22528
  s_waitcnt lgkmcnt(7)
  v_mfma_f32_32x32x16_bf16 v[112:127], v[156:159], a[12:15], v[112:127]
  ds_read_b128 v[156:159], v2 offset:23552
  s_waitcnt vmcnt(23) lgkmcnt(7)
  v_mfma_f32_32x32x16_bf16 v[64:79], v[128:131], a[16:19], v[64:79]
  ds_read_b128 v[128:131], v2 offset:24576
  s_waitcnt lgkmcnt(7)
  v_mfma_f32_32x32x16_bf16 v[80:95], v[132:135], a[16:19], v[80:95]
  ds_read_b128 v[132:135], v2 offset:25600
  s_waitcnt lgkmcnt(7)
  v_mfma_f32_32x32x16_bf16 v[96:111], v[136:139], a[16:19], v[96:111]
  ds_read_b128 v[136:139], v2 offset:26624
  s_waitcnt lgkmcnt(7)
  v_mfma_f32_32x32x16_bf16 v[112:127], v[140:143], a[16:19], v[112:127]
  ds_read_b128 v[140:143], v2 offset:27648
  s_waitcnt vmcnt(22) lgkmcnt(7)
  v_mfma_f32_32x32x16_bf16 v[64:79], v[144:147], a[20:23], v[64:79]
  ds_read_b128 v[144:147], v2 offset:28672
  s_waitcnt lgkmcnt(7)
  v_mfma_f32_32x32x16_bf16 v[80:95], v[148:151], a[20:23], v[80:95]
  ds_read_b128 v[148:151], v2 offset:29696
  s_waitcnt lgkmcnt(7)
  v_mfma_f32_32x32x16_bf16 v[96:111], v[152:155], a[20:23], v[96:111]
  ds_read_b128 v[152:155], v2 offset:30720
  s_waitcnt lgkmcnt(7)
  v_mfma_f32_32x32x16_bf16 v[112:127], v[156:159], a[20:23], v[112:127]
  ds_read_b128 v[156:159], v2 offset:31744
  s_waitcnt vmcnt(21) lgkmcnt(7)
  v_mfma_f32_32x32x16_bf16 v[64:79], v[128:131], a[24:27], v[64:79]
  ds_read_b128 v[128:131], v2 offset:32768
  s_waitcnt lgkmcnt(7)
  v_mfma_f32_32x32x16_bf16 v[80:95], v[132:135], a[24:27], v[80:95]
  ds_read_b128 v[132:135], v2 offset:33792
  s_waitcnt lgkmcnt(7)
  v_mfma_f32_32x32x16_bf16 v[96:111], v[136:139], a[24:27], v[96:111]
  ds_read_b128 v[136:139], v2 offset:34816
  s_waitcnt lgkmcnt(7)
  v_mfma_f32_32x32x16_bf16 v[112:127], v[140:143], a[24:27], v[112:127]
  ds_read_b128 v[140:143], v2 offset:35840
  s_waitcnt vmcnt(20) lgkmcnt(7)
  v_mfma_f32_32x32x16_bf16 v[64:79], v[144:147], a[28:31], v[64:79]
  ds_read_b128 v[144:147], v2 offset:36864
  s_waitcnt lgkmcnt(7)
  v_mfma_f32_32x32x16_bf16 v[80:95], v[148:151], a[28:31], v[80:95]
  ds_read_b128 v[148:151], v2 offset:37888
  s_waitcnt lgkmcnt(7)
  v_mfma_f32_32x32x16_bf16 v[96:111], v[152:155], a[28:31], v[96:111]
  ds_read_b128 v[152:155], v2 offset:38912
  s_waitcnt lgkmcnt(7)
  v_mfma_f32_32x32x16_bf16 v[112:127], v[156:159], a[28:31], v[112:127]
  ds_read_b128 v[156:159], v2 offset:39936
  s_waitcnt vmcnt(19) lgkmcnt(7)
  v_mfma_f32_32x32x16_bf16 v[64:79], v[128:131], a[32:35], v[64:79]
  ds_read_b128 v[128:131], v2 offset:40960
  s_waitcnt lgkmcnt(7)
  v_mfma_f32_32x32x16_bf16 v[80:95], v[132:135], a[32:35], v[80:95]
  ds_read_b128 v[132:135], v2 offset:41984
  s_waitcnt lgkmcnt(7)
  v_mfma_f32_32x32x16_bf16 v[96:111], v[136:139], a[32:35], v[96:111]
  ds_read_b128 v[136:139], v2 offset:43008
  s_waitcnt lgkmcnt(7)
  v_mfma_f32_32x32x16_bf16 v[112:127], v[140:143], a[32:35], v[112:127]
  ds_read_b128 v[140:143], v2 offset:44032
  s_waitcnt vmcnt(18) lgkmcnt(7)
  v_mfma_f32_32x32x16_bf16 v[64:79], v[144:147], a[36:39], v[64:79]
  ds_read_b128 v[144:147], v2 offset:45056
  s_waitcnt lgkmcnt(7)
  v_mfma_f32_32x32x16_bf16 v[80:95], v[148:151], a[36:39], v[80:95]
  ds_read_b128 v[148:151], v2 offset:46080
  s_waitcnt lgkmcnt(7)
  v_mfma_f32_32x32x16_bf16 v[96:111], v[152:155], a[36:39], v[96:111]
  ds_read_b128 v[152:155], v2 offset:47104
  s_waitcnt lgkmcnt(7)
  v_mfma_f32_32x32x16_bf16 v[112:127], v[156:159], a[36:39], v[112:127]
  ds_read_b128 v[156:159], v2 offset:48128
  s_waitcnt vmcnt(17) lgkmcnt(7)
  v_mfma_f32_32x32x16_bf16 v[64:79], v[128:131], a[40:43], v[64:79]
  ds_read_b128 v[128:131], v2 offset:49152
  s_waitcnt lgkmcnt(7)
  v_mfma_f32_32x32x16_bf16 v[80:95], v[132:135], a[40:43], v[80:95]
  ds_read_b128 v[132:135], v2 offset:50176
  s_waitcnt lgkmcnt(7)
  v_mfma_f32_32x32x16_bf16 v[96:111], v[136:139], a[40:43], v[96:111]
  ds_read_b128 v[136:139], v2 offset:51200
  s_waitcnt lgkmcnt(7)
  v_mfma_f32_32x32x16_bf16 v[112:127], v[140:143], a[40:43], v[112:127]
  ds_read_b128 v[140:143], v2 offset:52224
  s_waitcnt vmcnt(16) lgkmcnt(7)
  v_mfma_f32_32x32x16_bf16 v[64:79], v[144:147], a[44:47], v[64:79]
  ds_read_b128 v[144:147], v2 offset:53248
  s_waitcnt lgkmcnt(7)
  v_mfma_f32_32x32x16_bf16 v[80:95], v[148:151], a[44:47], v[80:95]
  ds_read_b128 v[148:151], v2 offset:54272
  s_waitcnt lgkmcnt(7)
  v_mfma_f32_32x32x16_bf16 v[96:111], v[152:155], a[44:47], v[96:111]
  ds_read_b128 v[152:155], v2 offset:55296
  s_waitcnt lgkmcnt(7)
  v_mfma_f32_32x32x16_bf16 v[112:127], v[156:159], a[44:47], v[112:127]
  ds_read_b128 v[156:159], v2 offset:56320
  s_waitcnt vmcnt(15) lgkmcnt(7)
  v_mfma_f32_32x32x16_bf16 v[64:79], v[128:131], a[48:51], v[64:79]
  ds_read_b128 v[128:131], v2 offset:57344
  s_waitcnt lgkmcnt(7)
  v_mfma_f32_32x32x16_bf16 v[80:95], v[132:135], a[48:51], v[80:95]
  ds_read_b128 v[132:135], v2 offset:58368
  s_waitcnt lgkmcnt(7)
  v_mfma_f32_32x32x16_bf16 v[96:111], v[136:139], a[48:51], v[96:111]
  ds_read_b128 v[136:139], v2 offset:59392
  s_waitcnt lgkmcnt(7)
  v_mfma_f32_32x32x16_bf16 v[112:127], v[140:143], a[48:51], v[112:127]
  ds_read_b128 v[140:143], v2 offset:60416
  s_waitcnt vmcnt(14) lgkmcnt(7)
  v_mfma_f32_32x32x16_bf16 v[64:79], v[144:147], a[52:55], v[64:79]
  ds_read_b128 v[144:147], v2 offset:61440
  s_waitcnt lgkmcnt(7)
  v_mfma_f32_32x32x16_bf16 v[80:95], v[148:151], a[52:55], v[80:95]
  ds_read_b128 v[148:151], v2 offset:62464
  s_waitcnt lgkmcnt(7)
  v_mfma_f32_32x32x16_bf16 v[96:111], v[152:155], a[52:55], v[96:111]
  ds_read_b128 v[152:155], v2 offset:63488
  s_waitcnt lgkmcnt(7)
  v_mfma_f32_32x32x16_bf16 v[112:127], v[156:159], a[52:55], v[112:127]
  ds_read_b128 v[156:159], v2 offset:64512
  s_waitcnt vmcnt(13) lgkmcnt(7)
  v_mfma_f32_32x32x16_bf16 v[64:79], v[128:131], a[56:59], v[64:79]
  ds_read_b128 v[128:131], v3 offset:0
  s_waitcnt lgkmcnt(7)
  v_mfma_f32_32x32x16_bf16 v[80:95], v[132:135], a[56:59], v[80:95]
  ds_read_b128 v[132:135], v3 offset:1024
  s_waitcnt lgkmcnt(7)
  v_mfma_f32_32x32x16_bf16 v[96:111], v[136:139], a[56:59], v[96:111]
  ds_read_b128 v[136:139], v3 offset:2048
  s_waitcnt lgkmcnt(7)
  v_mfma_f32_32x32x16_bf16 v[112:127], v[140:143], a[56:59], v[112:127]
  ds_read_b128 v[140:143], v3 offset:3072
  s_waitcnt vmcnt(12) lgkmcnt(7)
  v_mfma_f32_32x32x16_bf16 v[64:79], v[144:147], a[60:63], v[64:79]
  ds_read_b128 v[144:147], v3 offset:4096
  s_waitcnt lgkmcnt(7)
  v_mfma_f32_32x32x16_bf16 v[80:95], v[148:151], a[60:63], v[80:95]
  ds_read_b128 v[148:151], v3 offset:5120
  s_waitcnt lgkmcnt(7)
  v_mfma_f32_32x32x16_bf16 v[96:111], v[152:155], a[60:63], v[96:111]
  ds_read_b128 v[152:155], v3 offset:6144
  s_waitcnt lgkmcnt(7)
  v_mfma_f32_32x32x16_bf16 v[112:127], v[156:159], a[60:63], v[112:127]
  ds_read_b128 v[156:159], v3 offset:7168
  s_waitcnt vmcnt(11) lgkmcnt(7)
  v_mfma_f32_32x32x16_bf16 v[64:79], v[128:131], a[64:67], v[64:79]
  ds_read_b128 v[128:131], v3 offset:8192
  s_waitcnt lgkmcnt(7)
  v_mfma_f32_32x32x16_bf16 v[80:95], v[132:135], a[64:67], v[80:95]
  ds_read_b128 v[132:135], v3 offset:9216
  s_waitcnt lgkmcnt(7)
  v_mfma_f32_32x32x16_bf16 v[96:111], v[136:139], a[64:67], v[96:111]
  ds_read_b128 v[136:139], v3 offset:10240
  s_waitcnt lgkmcnt(7)
  v_mfma_f32_32x32x16_bf16 v[112:127], v[140:143], a[64:67], v[112:127]
  ds_read_b128 v[140:143], v3 offset:11264
  s_waitcnt vmcnt(10) lgkmcnt(7)
  v_mfma_f32_32x32x16_bf16 v[64:79], v[144:147], a[68:71], v[64:79]
  ds_read_b128 v[144:147], v3 offset:12288
  s_waitcnt lgkmcnt(7)
  v_mfma_f32_32x32x16_bf16 v[80:95], v[148:151], a[68:71], v[80:95]
  ds_read_b128 v[148:151], v3 offset:13312
  s_waitcnt lgkmcnt(7)
  v_mfma_f32_32x32x16_bf16 v[96:111], v[152:155], a[68:71], v[96:111]
  ds_read_b128 v[152:155], v3 offset:14336
  s_waitcnt lgkmcnt(7)
  v_mfma_f32_32x32x16_bf16 v[112:127], v[156:159], a[68:71], v[112:127]
  ds_read_b128 v[156:159], v3 offset:15360
  s_waitcnt vmcnt(9) lgkmcnt(7)
  v_mfma_f32_32x32x16_bf16 v[64:79], v[128:131], a[72:75], v[64:79]
  ds_read_b128 v[128:131], v3 offset:16384
  s_waitcnt lgkmcnt(7)
  v_mfma_f32_32x32x16_bf16 v[80:95], v[132:135], a[72:75], v[80:95]
  ds_read_b128 v[132:135], v3 offset:17408
  s_waitcnt lgkmcnt(7)
  v_mfma_f32_32x32x16_bf16 v[96:111], v[136:139], a[72:75], v[96:111]
  ds_read_b128 v[136:139], v3 offset:18432
  s_waitcnt lgkmcnt(7)
  v_mfma_f32_32x32x16_bf16 v[112:127], v[140:143], a[72:75], v[112:127]
  ds_read_b128 v[140:143], v3 offset:19456
  s_waitcnt vmcnt(8) lgkmcnt(7)
  v_mfma_f32_32x32x16_bf16 v[64:79], v[144:147], a[76:79], v[64:79]
  ds_read_b128 v[144:147], v3 offset:20480
  s_waitcnt lgkmcnt(7)
  v_mfma_f32_32x32x16_bf16 v[80:95], v[148:151], a[76:79], v[80:95]
  ds_read_b128 v[148:151], v3 offset:21504
  s_waitcnt lgkmcnt(7)
  v_mfma_f32_32x32x16_bf16 v[96:111], v[152:155], a[76:79], v[96:111]
  ds_read_b128 v[152:155], v3 offset:22528
  s_waitcnt lgkmcnt(7)
  v_mfma_f32_32x32x16_bf16 v[112:127], v[156:159], a[76:79], v[112:127]
  ds_read_b128 v[156:159], v3 offset:23552
  s_waitcnt vmcnt(7) lgkmcnt(7)
  v_mfma_f32_32x32x16_bf16 v[64:79], v[128:131], a[80:83], v[64:79]
  ds_read_b128 v[128:131], v3 offset:24576
  s_waitcnt lgkmcnt(7)
  v_mfma_f32_32x32x16_bf16 v[80:95], v[132:135], a[80:83], v[80:95]
  ds_read_b128 v[132:135], v3 offset:25600
  s_waitcnt lgkmcnt(7)
  v_mfma_f32_32x32x16_bf16 v[96:111], v[136:139], a[80:83], v[96:111]
  ds_read_b128 v[136:139], v3 offset:26624
  s_waitcnt lgkmcnt(7)
  v_mfma_f32_32x32x16_bf16 v[112:127], v[140:143], a[80:83], v[112:127]
  ds_read_b128 v[140:143], v3 offset:27648
  s_waitcnt vmcnt(6) lgkmcnt(7)
  v_mfma_f32_32x32x16_bf16 v[64:79], v[144:147], a[84:87], v[64:79]
  ds_read_b128 v[144:147], v3 offset:28672
  s_waitcnt lgkmcnt(7)
  v_mfma_f32_32x32x16_bf16 v[80:95], v[148:151], a[84:87], v[80:95]
  ds_read_b128 v[148:151], v3 offset:29696
  s_waitcnt lgkmcnt(7)
  v_mfma_f32_32x32x16_bf16 v[96:111], v[152:155], a[84:87], v[96:111]
  ds_read_b128 v[152:155], v3 offset:30720
  s_waitcnt lgkmcnt(7)
  v_mfma_f32_32x32x16_bf16 v[112:127], v[156:159], a[84:87], v[112:127]
  ds_read_b128 v[156:159], v3 offset:31744
  s_waitcnt vmcnt(5) lgkmcnt(7)
  v_mfma_f32_32x32x16_bf16 v[64:79], v[128:131], a[88:91], v[64:79]
  ds_read_b128 v[128:131], v3 offset:32768
  s_waitcnt lgkmcnt(7)
  v_mfma_f32_32x32x16_bf16 v[80:95], v[132:135], a[88:91], v[80:95]
  ds_read_b128 v[132:135], v3 offset:33792
  s_waitcnt lgkmcnt(7)
  v_mfma_f32_32x32x16_bf16 v[96:111], v[136:139], a[88:91], v[96:111]
  ds_read_b128 v[136:139], v3 offset:34816
  s_waitcnt lgkmcnt(7)
  v_mfma_f32_32x32x16_bf16 v[112:127], v[140:143], a[88:91], v[112:127]
  ds_read_b128 v[140:143], v3 offset:35840
  s_waitcnt vmcnt(4) lgkmcnt(7)
  v_mfma_f32_32x32x16_bf16 v[64:79], v[144:147], a[92:95], v[64:79]
  ds_read_b128 v[144:147], v3 offset:36864
  s_waitcnt lgkmcnt(7)
  v_mfma_f32_32x32x16_bf16 v[80:95], v[148:151], a[92:95], v[80:95]
  ds_read_b128 v[148:151], v3 offset:37888
  s_waitcnt lgkmcnt(7)
  v_mfma_f32_32x32x16_bf16 v[96:111], v[152:155], a[92:95], v[96:111]
  ds_read_b128 v[152:155], v3 offset:38912
  s_waitcnt lgkmcnt(7)
  v_mfma_f32_32x32x16_bf16 v[112:127], v[156:159], a[92:95], v[112:127]
  ds_read_b128 v[156:159], v3 offset:39936
  s_waitcnt vmcnt(3) lgkmcnt(7)
  v_mfma_f32_32x32x16_bf16 v[64:79], v[128:131], a[96:99], v[64:79]
  ds_read_b128 v[128:131], v3 offset:40960
  s_waitcnt lgkmcnt(7)
  v_mfma_f32_32x32x16_bf16 v[80:95], v[132:135], a[96:99], v[80:95]
  ds_read_b128 v[132:135], v3 offset:41984
  s_waitcnt lgkmcnt(7)
  v_mfma_f32_32x32x16_bf16 v[96:111], v[136:139], a[96:99], v[96:111]
  ds_read_b128 v[136:139], v3 offset:43008
  s_waitcnt lgkmcnt(7)
  v_mfma_f32_32x32x16_bf16 v[112:127], v[140:143], a[96:99], v[112:127]
  ds_read_b128 v[140:143], v3 offset:44032
  s_waitcnt vmcnt(2) lgkmcnt(7)
  v_mfma_f32_32x32x16_bf16 v[64:79], v[144:147], a[100:103], v[64:79]
  ds_read_b128 v[144:147], v3 offset:45056
  s_waitcnt lgkmcnt(7)
  v_mfma_f32_32x32x16_bf16 v[80:95], v[148:151], a[100:103], v[80:95]
  ds_read_b128 v[148:151], v3 offset:46080
  s_waitcnt lgkmcnt(7)
  v_mfma_f32_32x32x16_bf16 v[96:111], v[152:155], a[100:103], v[96:111]
  ds_read_b128 v[152:155], v3 offset:47104
  s_waitcnt lgkmcnt(7)
  v_mfma_f32_32x32x16_bf16 v[112:127], v[156:159], a[100:103], v[112:127]
  ds_read_b128 v[156:159], v3 offset:48128
  s_waitcnt vmcnt(1) lgkmcnt(7)
  v_mfma_f32_32x32x16_bf16 v[64:79], v[128:131], a[104:107], v[64:79]
  s_waitcnt lgkmcnt(6)
  v_mfma_f32_32x32x16_bf16 v[80:95], v[132:135], a[104:107], v[80:95]
  s_waitcnt lgkmcnt(5)
  v_mfma_f32_32x32x16_bf16 v[96:111], v[136:139], a[104:107], v[96:111]
  s_waitcnt lgkmcnt(4)
  v_mfma_f32_32x32x16_bf16 v[112:127], v[140:143], a[104:107], v[112:127]
  s_waitcnt vmcnt(0) lgkmcnt(3)
  v_mfma_f32_32x32x16_bf16 v[64:79], v[144:147], a[108:111], v[64:79]
  s_waitcnt lgkmcnt(2)
  v_mfma_f32_32x32x16_bf16 v[80:95], v[148:151], a[108:111], v[80:95]
  s_waitcnt lgkmcnt(1)
  v_mfma_f32_32x32x16_bf16 v[96:111], v[152:155], a[108:111], v[96:111]
  s_waitcnt lgkmcnt(0)
  v_mfma_f32_32x32x16_bf16 v[112:127], v[156:159], a[108:111], v[112:127]
  s_nop 15
  s_lshl_b32 s61, s68, 6
  s_add_u32 s61, s61, s51
  s_lshl_b32 s61, s61, 16
  s_lshl_b32 s52, s67, 14
  s_add_u32 s61, s61, s52
  s_add_u32 s61, s61, 83886080
  buffer_store_dwordx4 v[64:67], v2, s[32:35], s61 offen offset:0 sc1
  buffer_store_dwordx4 v[68:71], v2, s[32:35], s61 offen offset:1024 sc1
  buffer_store_dwordx4 v[72:75], v2, s[32:35], s61 offen offset:2048 sc1
  buffer_store_dwordx4 v[76:79], v2, s[32:35], s61 offen offset:3072 sc1
  s_add_u32 s61, s61, 4096
  buffer_store_dwordx4 v[80:83], v2, s[32:35], s61 offen offset:0 sc1
  buffer_store_dwordx4 v[84:87], v2, s[32:35], s61 offen offset:1024 sc1
  buffer_store_dwordx4 v[88:91], v2, s[32:35], s61 offen offset:2048 sc1
  buffer_store_dwordx4 v[92:95], v2, s[32:35], s61 offen offset:3072 sc1
  s_add_u32 s61, s61, 4096
  buffer_store_dwordx4 v[96:99], v2, s[32:35], s61 offen offset:0 sc1
  buffer_store_dwordx4 v[100:103], v2, s[32:35], s61 offen offset:1024 sc1
  buffer_store_dwordx4 v[104:107], v2, s[32:35], s61 offen offset:2048 sc1
  buffer_store_dwordx4 v[108:111], v2, s[32:35], s61 offen offset:3072 sc1
  s_add_u32 s61, s61, 4096
  buffer_store_dwordx4 v[112:115], v2, s[32:35], s61 offen offset:0 sc1
  buffer_store_dwordx4 v[116:119], v2, s[32:35], s61 offen offset:1024 sc1
  buffer_store_dwordx4 v[120:123], v2, s[32:35], s61 offen offset:2048 sc1
  buffer_store_dwordx4 v[124:127], v2, s[32:35], s61 offen offset:3072 sc1
  s_lshl_b32 s56, s48, 2
  s_lshl_b32 s57, s49, 7
  s_add_u32 s56, s56, s57
  s_add_u32 s56, s56, 16384
  s_lshr_b32 s57, s51, 2
  s_add_u32 s57, s57, 1
  s_waitcnt vmcnt(0)
  s_cmp_eq_u32 s50, 0
  s_cbranch_scc1 Lsig_74
  v_mov_b32 v4, s57
  v_mov_b32 v5, 0
  s_mov_b64 exec, 1
  buffer_store_dword v4, v5, s[32:35], s56 offen sc1
  s_mov_b64 exec, -1
Lsig_74:
  s_add_u32 s51, s51, 4
  s_cmp_lt_u32 s51, 64
  s_cbranch_scc1 LOOP_DOWN
  s_waitcnt vmcnt(0)
  s_endpgm
ROLE_RED:
  s_mov_b32 s36, s4
  s_mov_b32 s37, s5
  s_mov_b32 s38, 2097152
  s_mov_b32 s39, 0x00020000
  s_mov_b32 s40, s26
  s_mov_b32 s41, s27
  s_mov_b32 s42, 2097152
  s_mov_b32 s43, 0x00020000
  s_lshl_b32 s66, s49, 2
  s_add_u32 s66, s66, s48
  v_and_b32 v6, 31, v1
  v_lshlrev_b32 v6, 10, v6
  v_lshrrev_b32 v7, 5, v1
  v_lshl_add_u32 v6, v7, 4, v6
  s_cmp_lg_u32 s48, 0
  s_cbranch_scc1 Lwi_75
  v_mov_b32 v4, 0
  s_mov_b32 s56, 128
  s_mov_b32 s57, 47
  s_cmp_eq_u32 s50, 0
  s_cbranch_scc1 Lwaitd_77
  s_mov_b32 s52, 0
  s_mov_b32 s54, 1
  s_mov_b32 s55, 0
Lwait_76:
  buffer_load_dword v5, v4, s[44:47], s56 offen sc1
  s_add_u32 s52, s52, 1
  s_cmp_gt_u32 s52, 65536
  s_cbranch_scc1 Lwaitd_77
  s_waitcnt vmcnt(0)
  v_cmp_gt_u32 vcc, v5, s57
  s_and_b64 vcc, vcc, s[54:55]
  s_cmp_eq_u64 vcc, s[54:55]
  s_cbranch_scc1 Lwaitd_77
  s_sleep 2
  s_branch Lwait_76
Lwaitd_77:
  s_waitcnt vmcnt(0)
Lwi_75:
  s_barrier
LOOP_RED:
  s_lshr_b32 s51, s66, 4
  s_and_b32 s67, s66, 15
  s_lshr_b32 s68, s67, 2
  s_mul_i32 s68, s68, 12
  s_lshl_b32 s61, s51, 15
  s_lshl_b32 s52, s67, 6
  s_add_u32 s61, s61, s52
  buffer_load_dwordx4 v[8:11], v6, s[36:39], s61 offen
  buffer_load_dwordx4 v[12:15], v6, s[36:39], s61 offen offset:32
  s_add_u32 s69, s68, 8
  s_and_b32 s56, s51, 3
  s_lshl_b32 s56, s56, 2
  s_lshl_b32 s57, s69, 7
  s_add_u32 s56, s56, s57
  s_add_u32 s56, s56, 16384
  s_lshr_b32 s57, s51, 2
  v_min_u32 v4, 3, v1
  v_mul_u32_u24 v4, 128, v4
  s_cmp_eq_u32 s50, 0
  s_cbranch_scc1 Lwaitd_79
  s_mov_b32 s52, 0
  s_mov_b32 s54, 15
  s_mov_b32 s55, 0
Lwait_78:
  buffer_load_dword v5, v4, s[32:35], s56 offen sc1
  s_add_u32 s52, s52, 1
  s_cmp_gt_u32 s52, 65536
  s_cbranch_scc1 Lwaitd_79
  s_waitcnt vmcnt(0)
  v_cmp_gt_u32 vcc, v5, s57
  s_and_b64 vcc, vcc, s[54:55]
  s_cmp_eq_u64 vcc, s[54:55]
  s_cbranch_scc1 Lwaitd_79
  s_sleep 2
  s_branch Lwait_78
Lwaitd_79:
  s_waitcnt vmcnt(0)
  s_lshl_b32 s60, s66, 12
  s_add_u32 s60, s60, 117440512
  buffer_load_dwordx4 v[160:163], v2, s[32:35], s60 offen offset:0 sc1
  buffer_load_dwordx4 v[164:167], v2, s[32:35], s60 offen offset:1024 sc1
  buffer_load_dwordx4 v[168:171], v2, s[32:35], s60 offen offset:2048 sc1
  buffer_load_dwordx4 v[172:175], v2, s[32:35], s60 offen offset:3072 sc1
  s_add_u32 s60, s60, 4194304
  buffer_load_dwordx4 v[176:179], v2, s[32:35], s60 offen offset:0 sc1
  buffer_load_dwordx4 v[180:183], v2, s[32:35], s60 offen offset:1024 sc1
  buffer_load_dwordx4 v[184:187], v2, s[32:35], s60 offen offset:2048 sc1
  buffer_load_dwordx4 v[188:191], v2, s[32:35], s60 offen offset:3072 sc1
  s_add_u32 s60, s60, 4194304
  buffer_load_dwordx4 v[192:195], v2, s[32:35], s60 offen offset:0 sc1
  buffer_load_dwordx4 v[196:199], v2, s[32:35], s60 offen offset:1024 sc1
  buffer_load_dwordx4 v[200:203], v2, s[32:35], s60 offen offset:2048 sc1
  buffer_load_dwordx4 v[204:207], v2, s[32:35], s60 offen offset:3072 sc1
  s_add_u32 s60, s60, 4194304
  buffer_load_dwordx4 v[208:211], v2, s[32:35], s60 offen offset:0 sc1
  buffer_load_dwordx4 v[212:215], v2, s[32:35], s60 offen offset:1024 sc1
  buffer_load_dwordx4 v[216:219], v2, s[32:35], s60 offen offset:2048 sc1
  buffer_load_dwordx4 v[220:223], v2, s[32:35], s60 offen offset:3072 sc1
  s_add_u32 s60, s60, 4194304
  s_and_b32 s56, s51, 3
  s_lshl_b32 s56, s56, 2
  s_lshl_b32 s57, s68, 7
  s_add_u32 s56, s56, s57
  s_add_u32 s56, s56, 16384
  s_lshr_b32 s57, s51, 2
  v_min_u32 v4, 7, v1
  v_mul_u32_u24 v4, 128, v4
  s_cmp_eq_u32 s50, 0
  s_cbranch_scc1 Lwaitd_81
  s_mov_b32 s52, 0
  s_mov_b32 s54, 255
  s_mov_b32 s55, 0
Lwait_80:
  buffer_load_dword v5, v4, s[32:35], s56 offen sc1
  s_add_u32 s52, s52, 1
  s_cmp_gt_u32 s52, 65536
  s_cbranch_scc1 Lwaitd_81
  s_waitcnt vmcnt(0)
  v_cmp_gt_u32 vcc, v5, s57
  s_and_b64 vcc, vcc, s[54:55]
  s_cmp_eq_u64 vcc, s[54:55]
  s_cbranch_scc1 Lwaitd_81
  s_sleep 2
  s_branch Lwait_80
Lwaitd_81:
  s_waitcnt vmcnt(0)
  s_lshl_b32 s60, s66, 12
  s_add_u32 s60, s60, 83886080
  buffer_load_dwordx4 v[32:35], v2, s[32:35], s60 offen offset:0 sc1
  buffer_load_dwordx4 v[36:39], v2, s[32:35], s60 offen offset:1024 sc1
  buffer_load_dwordx4 v[40:43], v2, s[32:35], s60 offen offset:2048 sc1
  buffer_load_dwordx4 v[44:47], v2, s[32:35], s60 offen offset:3072 sc1
  s_add_u32 s60, s60, 4194304
  buffer_load_dwordx4 v[48:51], v2, s[32:35], s60 offen offset:0 sc1
  buffer_load_dwordx4 v[52:55], v2, s[32:35], s60 offen offset:1024 sc1
  buffer_load_dwordx4 v[56:59], v2, s[32:35], s60 offen offset:2048 sc1
  buffer_load_dwordx4 v[60:63], v2, s[32:35], s60 offen offset:3072 sc1
  s_add_u32 s60, s60, 4194304
  buffer_load_dwordx4 v[64:67], v2, s[32:35], s60 offen offset:0 sc1
  buffer_load_dwordx4 v[68:71], v2, s[32:35], s60 offen offset:1024 sc1
  buffer_load_dwordx4 v[72:75], v2, s[32:35], s60 offen offset:2048 sc1
  buffer_load_dwordx4 v[76:79], v2, s[32:35], s60 offen offset:3072 sc1
  s_add_u32 s60, s60, 4194304
  buffer_load_dwordx4 v[80:83], v2, s[32:35], s60 offen offset:0 sc1
  buffer_load_dwordx4 v[84:87], v2, s[32:35], s60 offen offset:1024 sc1
  buffer_load_dwordx4 v[88:91], v2, s[32:35], s60 offen offset:2048 sc1
  buffer_load_dwordx4 v[92:95], v2, s[32:35], s60 offen offset:3072 sc1
  s_add_u32 s60, s60, 4194304
  buffer_load_dwordx4 v[96:99], v2, s[32:35], s60 offen offset:0 sc1
  buffer_load_dwordx4 v[100:103], v2, s[32:35], s60 offen offset:1024 sc1
  buffer_load_dwordx4 v[104:107], v2, s[32:35], s60 offen offset:2048 sc1
  buffer_load_dwordx4 v[108:111], v2, s[32:35], s60 offen offset:3072 sc1
  s_add_u32 s60, s60, 4194304
  buffer_load_dwordx4 v[112:115], v2, s[32:35], s60 offen offset:0 sc1
  buffer_load_dwordx4 v[116:119], v2, s[32:35], s60 offen offset:1024 sc1
  buffer_load_dwordx4 v[120:123], v2, s[32:35], s60 offen offset:2048 sc1
  buffer_load_dwordx4 v[124:127], v2, s[32:35], s60 offen offset:3072 sc1
  s_add_u32 s60, s60, 4194304
  buffer_load_dwordx4 v[128:131], v2, s[32:35], s60 offen offset:0 sc1
  buffer_load_dwordx4 v[132:135], v2, s[32:35], s60 offen offset:1024 sc1
  buffer_load_dwordx4 v[136:139], v2, s[32:35], s60 offen offset:2048 sc1
  buffer_load_dwordx4 v[140:143], v2, s[32:35], s60 offen offset:3072 sc1
  s_add_u32 s60, s60, 4194304
  buffer_load_dwordx4 v[144:147], v2, s[32:35], s60 offen offset:0 sc1
  buffer_load_dwordx4 v[148:151], v2, s[32:35], s60 offen offset:1024 sc1
  buffer_load_dwordx4 v[152:155], v2, s[32:35], s60 offen offset:2048 sc1
  buffer_load_dwordx4 v[156:159], v2, s[32:35], s60 offen offset:3072 sc1
  v_add_f32 v160, v160, v176
  v_add_f32 v161, v161, v177
  v_add_f32 v162, v162, v178
  v_add_f32 v163, v163, v179
  v_add_f32 v164, v164, v180
  v_add_f32 v165, v165, v181
  v_add_f32 v166, v166, v182
  v_add_f32 v167, v167, v183
  v_add_f32 v168, v168, v184
  v_add_f32 v169, v169, v185
  v_add_f32 v170, v170, v186
  v_add_f32 v171, v171, v187
  v_add_f32 v172, v172, v188
  v_add_f32 v173, v173, v189
  v_add_f32 v174, v174, v190
  v_add_f32 v175, v175, v191
  v_add_f32 v160, v160, v192
  v_add_f32 v161, v161, v193
  v_add_f32 v162, v162, v194
  v_add_f32 v163, v163, v195
  v_add_f32 v164, v164, v196
  v_add_f32 v165, v165, v197
  v_add_f32 v166, v166, v198
  v_add_f32 v167, v167, v199
  v_add_f32 v168, v168, v200
  v_add_f32 v169, v169, v201
  v_add_f32 v170, v170, v202
  v_add_f32 v171, v171, v203
  v_add_f32 v172, v172, v204
  v_add_f32 v173, v173, v205
  v_add_f32 v174, v174, v206
  v_add_f32 v175, v175, v207
  v_add_f32 v160, v160, v208
  v_add_f32 v161, v161, v209
  v_add_f32 v162, v162, v210
  v_add_f32 v163, v163, v211
  v_add_f32 v164, v164, v212
  v_add_f32 v165, v165, v213
  v_add_f32 v166, v166, v214
  v_add_f32 v167, v167, v215
  v_add_f32 v168, v168, v216
  v_add_f32 v169, v169, v217
  v_add_f32 v170, v170, v218
  v_add_f32 v171, v171, v219
  v_add_f32 v172, v172, v220
  v_add_f32 v173, v173, v221
  v_add_f32 v174, v174, v222
  v_add_f32 v175, v175, v223
  s_waitcnt vmcnt(24)
  v_add_f32 v32, v32, v48
  v_add_f32 v33, v33, v49
  v_add_f32 v34, v34, v50
  v_add_f32 v35, v35, v51
  v_add_f32 v36, v36, v52
  v_add_f32 v37, v37, v53
  v_add_f32 v38, v38, v54
  v_add_f32 v39, v39, v55
  v_add_f32 v40, v40, v56
  v_add_f32 v41, v41, v57
  v_add_f32 v42, v42, v58
  v_add_f32 v43, v43, v59
  v_add_f32 v44, v44, v60
  v_add_f32 v45, v45, v61
  v_add_f32 v46, v46, v62
  v_add_f32 v47, v47, v63
  s_waitcnt vmcnt(20)
  v_add_f32 v32, v32, v64
  v_add_f32 v33, v33, v65
  v_add_f32 v34, v34, v66
  v_add_f32 v35, v35, v67
  v_add_f32 v36, v36, v68
  v_add_f32 v37, v37, v69
  v_add_f32 v38, v38, v70
  v_add_f32 v39, v39, v71
  v_add_f32 v40, v40, v72
  v_add_f32 v41, v41, v73
  v_add_f32 v42, v42, v74
  v_add_f32 v43, v43, v75
  v_add_f32 v44, v44, v76
  v_add_f32 v45, v45, v77
  v_add_f32 v46, v46, v78
  v_add_f32 v47, v47, v79
  s_waitcnt vmcnt(16)
  v_add_f32 v32, v32, v80
  v_add_f32 v33, v33, v81
  v_add_f32 v34, v34, v82
  v_add_f32 v35, v35, v83
  v_add_f32 v36, v36, v84
  v_add_f32 v37, v37, v85
  v_add_f32 v38, v38, v86
  v_add_f32 v39, v39, v87
  v_add_f32 v40, v40, v88
  v_add_f32 v41, v41, v89
  v_add_f32 v42, v42, v90
  v_add_f32 v43, v43, v91
  v_add_f32 v44, v44, v92
  v_add_f32 v45, v45, v93
  v_add_f32 v46, v46, v94
  v_add_f32 v47, v47, v95
  s_waitcnt vmcnt(12)
  v_add_f32 v32, v32, v96
  v_add_f32 v33, v33, v97
  v_add_f32 v34, v34, v98
  v_add_f32 v35, v35, v99
  v_add_f32 v36, v36, v100
  v_add_f32 v37, v37, v101
  v_add_f32 v38, v38, v102
  v_add_f32 v39, v39, v103
  v_add_f32 v40, v40, v104
  v_add_f32 v41, v41, v105
  v_add_f32 v42, v42, v106
  v_add_f32 v43, v43, v107
  v_add_f32 v44, v44, v108
  v_add_f32 v45, v45, v109
  v_add_f32 v46, v46, v110
  v_add_f32 v47, v47, v111
  s_waitcnt vmcnt(8)
  v_add_f32 v32, v32, v112
  v_add_f32 v33, v33, v113
  v_add_f32 v34, v34, v114
  v_add_f32 v35, v35, v115
  v_add_f32 v36, v36, v116
  v_add_f32 v37, v37, v117
  v_add_f32 v38, v38, v118
  v_add_f32 v39, v39, v119
  v_add_f32 v40, v40, v120
  v_add_f32 v41, v41, v121
  v_add_f32 v42, v42, v122
  v_add_f32 v43, v43, v123
  v_add_f32 v44, v44, v124
  v_add_f32 v45, v45, v125
  v_add_f32 v46, v46, v126
  v_add_f32 v47, v47, v127
  s_waitcnt vmcnt(4)
  v_add_f32 v32, v32, v128
  v_add_f32 v33, v33, v129
  v_add_f32 v34, v34, v130
  v_add_f32 v35, v35, v131
  v_add_f32 v36, v36, v132
  v_add_f32 v37, v37, v133
  v_add_f32 v38, v38, v134
  v_add_f32 v39, v39, v135
  v_add_f32 v40, v40, v136
  v_add_f32 v41, v41, v137
  v_add_f32 v42, v42, v138
  v_add_f32 v43, v43, v139
  v_add_f32 v44, v44, v140
  v_add_f32 v45, v45, v141
  v_add_f32 v46, v46, v142
  v_add_f32 v47, v47, v143
  s_waitcnt vmcnt(0)
  v_add_f32 v32, v32, v144
  v_add_f32 v33, v33, v145
  v_add_f32 v34, v34, v146
  v_add_f32 v35, v35, v147
  v_add_f32 v36, v36, v148
  v_add_f32 v37, v37, v149
  v_add_f32 v38, v38, v150
  v_add_f32 v39, v39, v151
  v_add_f32 v40, v40, v152
  v_add_f32 v41, v41, v153
  v_add_f32 v42, v42, v154
  v_add_f32 v43, v43, v155
  v_add_f32 v44, v44, v156
  v_add_f32 v45, v45, v157
  v_add_f32 v46, v46, v158
  v_add_f32 v47, v47, v159
  v_cvt_pk_bf16_f32 v48, v32, v33
  v_cvt_pk_bf16_f32 v56, v160, v161
  v_cvt_pk_bf16_f32 v49, v34, v35
  v_cvt_pk_bf16_f32 v57, v162, v163
  v_cvt_pk_bf16_f32 v50, v36, v37
  v_cvt_pk_bf16_f32 v58, v164, v165
  v_cvt_pk_bf16_f32 v51, v38, v39
  v_cvt_pk_bf16_f32 v59, v166, v167
  v_cvt_pk_bf16_f32 v52, v40, v41
  v_cvt_pk_bf16_f32 v60, v168, v169
  v_cvt_pk_bf16_f32 v53, v42, v43
  v_cvt_pk_bf16_f32 v61, v170, v171
  v_cvt_pk_bf16_f32 v54, v44, v45
  v_cvt_pk_bf16_f32 v62, v172, v173
  v_cvt_pk_bf16_f32 v55, v46, v47
  v_cvt_pk_bf16_f32 v63, v174, v175
  s_nop 1
  v_permlane32_swap_b32 v48, v50
  v_permlane32_swap_b32 v49, v51
  v_permlane32_swap_b32 v52, v54
  v_permlane32_swap_b32 v53, v55
  v_permlane32_swap_b32 v56, v58
  v_permlane32_swap_b32 v57, v59
  v_permlane32_swap_b32 v60, v62
  v_permlane32_swap_b32 v61, v63
  s_waitcnt vmcnt(0)
  s_nop 1
  v_lshlrev_b32 v80, 16, v48
  v_and_b32 v81, 0xffff0000, v48
  v_lshlrev_b32 v82, 16, v8
  v_and_b32 v83, 0xffff0000, v8
  v_add_f32 v80, v80, v82
  v_add_f32 v81, v81, v83
  v_cvt_pk_bf16_f32 v80, v80, v81
  v_lshlrev_b32 v82, 16, v56
  v_and_b32 v83, 0xffff0000, v56
  v_and_b32 v81, 0xffff0000, v80
  v_lshlrev_b32 v80, 16, v80
  v_add_f32 v80, v80, v82
  v_add_f32 v81, v81, v83
  v_cvt_pk_bf16_f32 v16, v80, v81
  v_lshlrev_b32 v80, 16, v49
  v_and_b32 v81, 0xffff0000, v49
  v_lshlrev_b32 v82, 16, v9
  v_and_b32 v83, 0xffff0000, v9
  v_add_f32 v80, v80, v82
  v_add_f32 v81, v81, v83
  v_cvt_pk_bf16_f32 v80, v80, v81
  v_lshlrev_b32 v82, 16, v57
  v_and_b32 v83, 0xffff0000, v57
  v_and_b32 v81, 0xffff0000, v80
  v_lshlrev_b32 v80, 16, v80
  v_add_f32 v80, v80, v82
  v_add_f32 v81, v81, v83
  v_cvt_pk_bf16_f32 v17, v80, v81
  v_lshlrev_b32 v80, 16, v50
  v_and_b32 v81, 0xffff0000, v50
  v_lshlrev_b32 v82, 16, v10
  v_and_b32 v83, 0xffff0000, v10
  v_add_f32 v80, v80, v82
  v_add_f32 v81, v81, v83
  v_cvt_pk_bf16_f32 v80, v80, v81
  v_lshlrev_b32 v82, 16, v58
  v_and_b32 v83, 0xffff0000, v58
  v_and_b32 v81, 0xffff0000, v80
  v_lshlrev_b32 v80, 16, v80
  v_add_f32 v80, v80, v82
  v_add_f32 v81, v81, v83
  v_cvt_pk_bf16_f32 v18, v80, v81
  v_lshlrev_b32 v80, 16, v51
  v_and_b32 v81, 0xffff0000, v51
  v_lshlrev_b32 v82, 16, v11
  v_and_b32 v83, 0xffff0000, v11
  v_add_f32 v80, v80, v82
  v_add_f32 v81, v81, v83
  v_cvt_pk_bf16_f32 v80, v80, v81
  v_lshlrev_b32 v82, 16, v59
  v_and_b32 v83, 0xffff0000, v59
  v_and_b32 v81, 0xffff0000, v80
  v_lshlrev_b32 v80, 16, v80
  v_add_f32 v80, v80, v82
  v_add_f32 v81, v81, v83
  v_cvt_pk_bf16_f32 v19, v80, v81
  v_lshlrev_b32 v80, 16, v52
  v_and_b32 v81, 0xffff0000, v52
  v_lshlrev_b32 v82, 16, v12
  v_and_b32 v83, 0xffff0000, v12
  v_add_f32 v80, v80, v82
  v_add_f32 v81, v81, v83
  v_cvt_pk_bf16_f32 v80, v80, v81
  v_lshlrev_b32 v82, 16, v60
  v_and_b32 v83, 0xffff0000, v60
  v_and_b32 v81, 0xffff0000, v80
  v_lshlrev_b32 v80, 16, v80
  v_add_f32 v80, v80, v82
  v_add_f32 v81, v81, v83
  v_cvt_pk_bf16_f32 v20, v80, v81
  v_lshlrev_b32 v80, 16, v53
  v_and_b32 v81, 0xffff0000, v53
  v_lshlrev_b32 v82, 16, v13
  v_and_b32 v83, 0xffff0000, v13
  v_add_f32 v80, v80, v82
  v_add_f32 v81, v81, v83
  v_cvt_pk_bf16_f32 v80, v80, v81
  v_lshlrev_b32 v82, 16, v61
  v_and_b32 v83, 0xffff0000, v61
  v_and_b32 v81, 0xffff0000, v80
  v_lshlrev_b32 v80, 16, v80
  v_add_f32 v80, v80, v82
  v_add_f32 v81, v81, v83
  v_cvt_pk_bf16_f32 v21, v80, v81
  v_lshlrev_b32 v80, 16, v54
  v_and_b32 v81, 0xffff0000, v54
  v_lshlrev_b32 v82, 16, v14
  v_and_b32 v83, 0xffff0000, v14
  v_add_f32 v80, v80, v82
  v_add_f32 v81, v81, v83
  v_cvt_pk_bf16_f32 v80, v80, v81
  v_lshlrev_b32 v82, 16, v62
  v_and_b32 v83, 0xffff0000, v62
  v_and_b32 v81, 0xffff0000, v80
  v_lshlrev_b32 v80, 16, v80
  v_add_f32 v80, v80, v82
  v_add_f32 v81, v81, v83
  v_cvt_pk_bf16_f32 v22, v80, v81
  v_lshlrev_b32 v80, 16, v55
  v_and_b32 v81, 0xffff0000, v55
  v_lshlrev_b32 v82, 16, v15
  v_and_b32 v83, 0xffff0000, v15
  v_add_f32 v80, v80, v82
  v_add_f32 v81, v81, v83
  v_cvt_pk_bf16_f32 v80, v80, v81
  v_lshlrev_b32 v82, 16, v63
  v_and_b32 v83, 0xffff0000, v63
  v_and_b32 v81, 0xffff0000, v80
  v_lshlrev_b32 v80, 16, v80
  v_add_f32 v80, v80, v82
  v_add_f32 v81, v81, v83
  v_cvt_pk_bf16_f32 v23, v80, v81
  buffer_store_dwordx4 v[16:19], v6, s[40:43], s61 offen
  buffer_store_dwordx4 v[20:23], v6, s[40:43], s61 offen offset:32
  s_add_u32 s66, s66, 208
  s_cmp_lt_u32 s66, 1024
  s_cbranch_scc1 LOOP_RED
  s_waitcnt vmcnt(0)
  s_endpgm
ROLE_TEAM:
  s_lshl_b32 s52, s49, 2
  s_add_u32 s52, s52, s48
  s_lshl_b32 s68, s52, 11
  s_add_u32 s68, s68, 4194304
  s_add_u32 s53, s68, 262144
  v_mov_b64 v[16:17], -1
  v_mov_b64 v[18:19], -1
  buffer_store_dwordx4 v[16:19], v2, s[32:35], s68 offen offset:0
  buffer_store_dwordx4 v[16:19], v2, s[32:35], s53 offen offset:0
  buffer_store_dwordx4 v[16:19], v2, s[32:35], s68 offen offset:1024
  buffer_store_dwordx4 v[16:19], v2, s[32:35], s53 offen offset:1024
  s_lshl_b32 s53, s52, 7
  s_add_u32 s53, s53, 3145728
  s_mov_b64 exec, 0xff
  buffer_store_dwordx4 v[16:19], v2, s[32:35], s53 offen
  s_mov_b64 exec, -1
  s_nop 1
  s_cmp_lt_u32 s48, 2
  s_cselect_b32 s36, s8, s10
  s_cselect_b32 s37, s9, s11
  s_mov_b32 s38, 4194304
  s_mov_b32 s39, 0x00020000
  s_mov_b32 s40, s12
  s_mov_b32 s41, s13
  s_mov_b32 s42, 4194304
  s_mov_b32 s43, 0x00020000
  s_mov_b32 s96, s14
  s_mov_b32 s97, s15
  s_mov_b32 s98, 4194304
  s_mov_b32 s99, 0x00020000
  v_and_b32 v8, 15, v1
  v_lshrrev_b32 v7, 5, v1
  v_lshlrev_b32 v7, 4, v7
  v_bfe_u32 v10, v1, 4, 1
  v_lshl_add_u32 v7, v10, 2, v7
  v_lshlrev_b32 v4, 14, v7
  v_lshl_add_u32 v5, v8, 2, v4
  v_lshl_add_u32 v4, v8, 3, v4
  v_lshlrev_b32 v6, 10, v7
  v_lshl_add_u32 v6, v8, 4, v6
  s_mul_i32 s52, s48, 30720
  s_add_u32 s52, s52, 40960
  v_add_u32 v9, s52, v2
  s_lshl_b32 s52, s49, 8
  s_and_b32 s53, s48, 1
  s_lshl_b32 s53, s53, 7
  s_add_u32 s53, s53, s52
  s_lshl_b32 s54, s48, 6
  s_add_u32 s54, s54, s52
  s_lshl_b32 s55, s49, 17
  s_lshl_b32 s56, s48, 8
  s_add_u32 s55, s55, s56
  s_lshl_b32 s58, s48, 1
  s_xor_b32 s58, s58, 0
  s_lshl_b32 s58, s58, 19
  s_add_u32 s58, s58, s54
  s_add_u32 s57, s58, 0
  buffer_load_dword v16, v5, s[40:43], s57 offen
  s_add_u32 s57, s58, 8192
  buffer_load_dword v17, v5, s[40:43], s57 offen
  s_add_u32 s57, s58, 16384
  buffer_load_dword v18, v5, s[40:43], s57 offen
  s_add_u32 s57, s58, 24576
  buffer_load_dword v19, v5, s[40:43], s57 offen
  s_add_u32 s57, s58, 131072
  buffer_load_dword v20, v5, s[40:43], s57 offen
  s_add_u32 s57, s58, 139264
  buffer_load_dword v21, v5, s[40:43], s57 offen
  s_add_u32 s57, s58, 147456
  buffer_load_dword v22, v5, s[40:43], s57 offen
  s_add_u32 s57, s58, 155648
  buffer_load_dword v23, v5, s[40:43], s57 offen
  s_add_u32 s57, s58, 524288
  buffer_load_dword v24, v5, s[40:43], s57 offen
  s_add_u32 s57, s58, 532480
  buffer_load_dword v25, v5, s[40:43], s57 offen
  s_add_u32 s57, s58, 540672
  buffer_load_dword v26, v5, s[40:43], s57 offen
  s_add_u32 s57, s58, 548864
  buffer_load_dword v27, v5, s[40:43], s57 offen
  s_add_u32 s57, s58, 655360
  buffer_load_dword v28, v5, s[40:43], s57 offen
  s_add_u32 s57, s58, 663552
  buffer_load_dword v29, v5, s[40:43], s57 offen
  s_add_u32 s57, s58, 671744
  buffer_load_dword v30, v5, s[40:43], s57 offen
  s_add_u32 s57, s58, 679936
  buffer_load_dword v31, v5, s[40:43], s57 offen
  s_lshl_b32 s58, s48, 1
  s_xor_b32 s58, s58, 0
  s_lshl_b32 s58, s58, 19
  s_add_u32 s58, s58, s54
  s_add_u32 s57, s58, 32768
  buffer_load_dword v32, v5, s[40:43], s57 offen
  s_add_u32 s57, s58, 40960
  buffer_load_dword v33, v5, s[40:43], s57 offen
  s_add_u32 s57, s58, 49152
  buffer_load_dword v34, v5, s[40:43], s57 offen
  s_add_u32 s57, s58, 57344
  buffer_load_dword v35, v5, s[40:43], s57 offen
  s_add_u32 s57, s58, 163840
  buffer_load_dword v36, v5, s[40:43], s57 offen
  s_add_u32 s57, s58, 172032
  buffer_load_dword v37, v5, s[40:43], s57 offen
  s_add_u32 s57, s58, 180224
  buffer_load_dword v38, v5, s[40:43], s57 offen
  s_add_u32 s57, s58, 188416
  buffer_load_dword v39, v5, s[40:43], s57 offen
  s_add_u32 s57, s58, 557056
  buffer_load_dword v40, v5, s[40:43], s57 offen
  s_add_u32 s57, s58, 565248
  buffer_load_dword v41, v5, s[40:43], s57 offen
  s_add_u32 s57, s58, 573440
  buffer_load_dword v42, v5, s[40:43], s57 offen
  s_add_u32 s57, s58, 581632
  buffer_load_dword v43, v5, s[40:43], s57 offen
  s_add_u32 s57, s58, 688128
  buffer_load_dword v44, v5, s[40:43], s57 offen
  s_add_u32 s57, s58, 696320
  buffer_load_dword v45, v5, s[40:43], s57 offen
  s_add_u32 s57, s58, 704512
  buffer_load_dword v46, v5, s[40:43], s57 offen
  s_add_u32 s57, s58, 712704
  buffer_load_dword v47, v5, s[40:43], s57 offen
  s_lshl_b32 s58, s48, 1
  s_xor_b32 s58, s58, 2
  s_lshl_b32 s58, s58, 19
  s_add_u32 s58, s58, s54
  s_add_u32 s57, s58, 0
  buffer_load_dword v48, v5, s[40:43], s57 offen
  s_add_u32 s57, s58, 8192
  buffer_load_dword v49, v5, s[40:43], s57 offen
  s_add_u32 s57, s58, 16384
  buffer_load_dword v50, v5, s[40:43], s57 offen
  s_add_u32 s57, s58, 24576
  buffer_load_dword v51, v5, s[40:43], s57 offen
  s_add_u32 s57, s58, 131072
  buffer_load_dword v52, v5, s[40:43], s57 offen
  s_add_u32 s57, s58, 139264
  buffer_load_dword v53, v5, s[40:43], s57 offen
  s_add_u32 s57, s58, 147456
  buffer_load_dword v54, v5, s[40:43], s57 offen
  s_add_u32 s57, s58, 155648
  buffer_load_dword v55, v5, s[40:43], s57 offen
  s_add_u32 s57, s58, 524288
  buffer_load_dword v56, v5, s[40:43], s57 offen
  s_add_u32 s57, s58, 532480
  buffer_load_dword v57, v5, s[40:43], s57 offen
  s_add_u32 s57, s58, 540672
  buffer_load_dword v58, v5, s[40:43], s57 offen
  s_add_u32 s57, s58, 548864
  buffer_load_dword v59, v5, s[40:43], s57 offen
  s_add_u32 s57, s58, 655360
  buffer_load_dword v60, v5, s[40:43], s57 offen
  s_add_u32 s57, s58, 663552
  buffer_load_dword v61, v5, s[40:43], s57 offen
  s_add_u32 s57, s58, 671744
  buffer_load_dword v62, v5, s[40:43], s57 offen
  s_add_u32 s57, s58, 679936
  buffer_load_dword v63, v5, s[40:43], s57 offen
  s_waitcnt vmcnt(32)
  v_perm_b32 v12, v17, v16, s64
  v_perm_b32 v13, v21, v20, s64
  v_perm_b32 v14, v19, v18, s64
  v_perm_b32 v15, v23, v22, s64
  v_accvgpr_write_b32 a176, v12
  v_accvgpr_write_b32 a177, v13
  v_accvgpr_write_b32 a178, v14
  v_accvgpr_write_b32 a179, v15
  v_perm_b32 v12, v25, v24, s64
  v_perm_b32 v13, v29, v28, s64
  v_perm_b32 v14, v27, v26, s64
  v_perm_b32 v15, v31, v30, s64
  v_accvgpr_write_b32 a180, v12
  v_accvgpr_write_b32 a181, v13
  v_accvgpr_write_b32 a182, v14
  v_accvgpr_write_b32 a183, v15
  v_perm_b32 v12, v17, v16, s65
  v_perm_b32 v13, v21, v20, s65
  v_perm_b32 v14, v19, v18, s65
  v_perm_b32 v15, v23, v22, s65
  v_accvgpr_write_b32 a184, v12
  v_accvgpr_write_b32 a185, v13
  v_accvgpr_write_b32 a186, v14
  v_accvgpr_write_b32 a187, v15
  v_perm_b32 v12, v25, v24, s65
  v_perm_b32 v13, v29, v28, s65
  v_perm_b32 v14, v27, v26, s65
  v_perm_b32 v15, v31, v30, s65
  v_accvgpr_write_b32 a188, v12
  v_accvgpr_write_b32 a189, v13
  v_accvgpr_write_b32 a190, v14
  v_accvgpr_write_b32 a191, v15
  s_lshl_b32 s58, s48, 1
  s_xor_b32 s58, s58, 2
  s_lshl_b32 s58, s58, 19
  s_add_u32 s58, s58, s54
  s_add_u32 s57, s58, 32768
  buffer_load_dword v64, v5, s[40:43], s57 offen
  s_add_u32 s57, s58, 40960
  buffer_load_dword v65, v5, s[40:43], s57 offen
  s_add_u32 s57, s58, 49152
  buffer_load_dword v66, v5, s[40:43], s57 offen
  s_add_u32 s57, s58, 57344
  buffer_load_dword v67, v5, s[40:43], s57 offen
  s_add_u32 s57, s58, 163840
  buffer_load_dword v68, v5, s[40:43], s57 offen
  s_add_u32 s57, s58, 172032
  buffer_load_dword v69, v5, s[40:43], s57 offen
  s_add_u32 s57, s58, 180224
  buffer_load_dword v70, v5, s[40:43], s57 offen
  s_add_u32 s57, s58, 188416
  buffer_load_dword v71, v5, s[40:43], s57 offen
  s_add_u32 s57, s58, 557056
  buffer_load_dword v72, v5, s[40:43], s57 offen
  s_add_u32 s57, s58, 565248
  buffer_load_dword v73, v5, s[40:43], s57 offen
  s_add_u32 s57, s58, 573440
  buffer_load_dword v74, v5, s[40:43], s57 offen
  s_add_u32 s57, s58, 581632
  buffer_load_dword v75, v5, s[40:43], s57 offen
  s_add_u32 s57, s58, 688128
  buffer_load_dword v76, v5, s[40:43], s57 offen
  s_add_u32 s57, s58, 696320
  buffer_load_dword v77, v5, s[40:43], s57 offen
  s_add_u32 s57, s58, 704512
  buffer_load_dword v78, v5, s[40:43], s57 offen
  s_add_u32 s57, s58, 712704
  buffer_load_dword v79, v5, s[40:43], s57 offen
  s_waitcnt vmcnt(32)
  v_perm_b32 v12, v33, v32, s64
  v_perm_b32 v13, v37, v36, s64
  v_perm_b32 v14, v35, v34, s64
  v_perm_b32 v15, v39, v38, s64
  v_accvgpr_write_b32 a192, v12
  v_accvgpr_write_b32 a193, v13
  v_accvgpr_write_b32 a194, v14
  v_accvgpr_write_b32 a195, v15
  v_perm_b32 v12, v41, v40, s64
  v_perm_b32 v13, v45, v44, s64
  v_perm_b32 v14, v43, v42, s64
  v_perm_b32 v15, v47, v46, s64
  v_accvgpr_write_b32 a196, v12
  v_accvgpr_write_b32 a197, v13
  v_accvgpr_write_b32 a198, v14
  v_accvgpr_write_b32 a199, v15
  v_perm_b32 v12, v33, v32, s65
  v_perm_b32 v13, v37, v36, s65
  v_perm_b32 v14, v35, v34, s65
  v_perm_b32 v15, v39, v38, s65
  v_accvgpr_write_b32 a200, v12
  v_accvgpr_write_b32 a201, v13
  v_accvgpr_write_b32 a202, v14
  v_accvgpr_write_b32 a203, v15
  v_perm_b32 v12, v41, v40, s65
  v_perm_b32 v13, v45, v44, s65
  v_perm_b32 v14, v43, v42, s65
  v_perm_b32 v15, v47, v46, s65
  v_accvgpr_write_b32 a204, v12
  v_accvgpr_write_b32 a205, v13
  v_accvgpr_write_b32 a206, v14
  v_accvgpr_write_b32 a207, v15
  s_barrier
  s_cmp_lg_u32 s48, 0
  s_cbranch_scc1 Ltarr_82
  v_mov_b32 v12, 16
  s_lshl_b32 s59, s63, 16
  s_add_u32 s59, s59, 1
  v_mov_b32 v13, s59
  s_mov_b64 exec, 1
  buffer_atomic_add v13, v12, s[44:47], 0 offen
  s_mov_b64 exec, -1
  s_nop 1
Ltarr_82:
  s_lshl_b32 s58, s48, 1
  s_xor_b32 s58, s58, 4
  s_lshl_b32 s58, s58, 19
  s_add_u32 s58, s58, s54
  s_add_u32 s57, s58, 0
  buffer_load_dword v80, v5, s[40:43], s57 offen
  s_add_u32 s57, s58, 8192
  buffer_load_dword v81, v5, s[40:43], s57 offen
  s_add_u32 s57, s58, 16384
  buffer_load_dword v82, v5, s[40:43], s57 offen
  s_add_u32 s57, s58, 24576
  buffer_load_dword v83, v5, s[40:43], s57 offen
  s_add_u32 s57, s58, 131072
  buffer_load_dword v84, v5, s[40:43], s57 offen
  s_add_u32 s57, s58, 139264
  buffer_load_dword v85, v5, s[40:43], s57 offen
  s_add_u32 s57, s58, 147456
  buffer_load_dword v86, v5, s[40:43], s57 offen
  s_add_u32 s57, s58, 155648
  buffer_load_dword v87, v5, s[40:43], s57 offen
  s_add_u32 s57, s58, 524288
  buffer_load_dword v88, v5, s[40:43], s57 offen
  s_add_u32 s57, s58, 532480
  buffer_load_dword v89, v5, s[40:43], s57 offen
  s_add_u32 s57, s58, 540672
  buffer_load_dword v90, v5, s[40:43], s57 offen
  s_add_u32 s57, s58, 548864
  buffer_load_dword v91, v5, s[40:43], s57 offen
  s_add_u32 s57, s58, 655360
  buffer_load_dword v92, v5, s[40:43], s57 offen
  s_add_u32 s57, s58, 663552
  buffer_load_dword v93, v5, s[40:43], s57 offen
  s_add_u32 s57, s58, 671744
  buffer_load_dword v94, v5, s[40:43], s57 offen
  s_add_u32 s57, s58, 679936
  buffer_load_dword v95, v5, s[40:43], s57 offen
  s_waitcnt vmcnt(32)
  v_perm_b32 v12, v49, v48, s64
  v_perm_b32 v13, v53, v52, s64
  v_perm_b32 v14, v51, v50, s64
  v_perm_b32 v15, v55, v54, s64
  v_accvgpr_write_b32 a208, v12
  v_accvgpr_write_b32 a209, v13
  v_accvgpr_write_b32 a210, v14
  v_accvgpr_write_b32 a211, v15
  v_perm_b32 v12, v57, v56, s64
  v_perm_b32 v13, v61, v60, s64
  v_perm_b32 v14, v59, v58, s64
  v_perm_b32 v15, v63, v62, s64
  v_accvgpr_write_b32 a212, v12
  v_accvgpr_write_b32 a213, v13
  v_accvgpr_write_b32 a214, v14
  v_accvgpr_write_b32 a215, v15
  v_perm_b32 v12, v49, v48, s65
  v_perm_b32 v13, v53, v52, s65
  v_perm_b32 v14, v51, v50, s65
  v_perm_b32 v15, v55, v54, s65
  v_accvgpr_write_b32 a216, v12
  v_accvgpr_write_b32 a217, v13
  v_accvgpr_write_b32 a218, v14
  v_accvgpr_write_b32 a219, v15
  v_perm_b32 v12, v57, v56, s65
  v_perm_b32 v13, v61, v60, s65
  v_perm_b32 v14, v59, v58, s65
  v_perm_b32 v15, v63, v62, s65
  v_accvgpr_write_b32 a220, v12
  v_accvgpr_write_b32 a221, v13
  v_accvgpr_write_b32 a222, v14
  v_accvgpr_write_b32 a223, v15
  s_lshl_b32 s58, s48, 1
  s_xor_b32 s58, s58, 4
  s_lshl_b32 s58, s58, 19
  s_add_u32 s58, s58, s54
  s_add_u32 s57, s58, 32768
  buffer_load_dword v96, v5, s[40:43], s57 offen
  s_add_u32 s57, s58, 40960
  buffer_load_dword v97, v5, s[40:43], s57 offen
  s_add_u32 s57, s58, 49152
  buffer_load_dword v98, v5, s[40:43], s57 offen
  s_add_u32 s57, s58, 57344
  buffer_load_dword v99, v5, s[40:43], s57 offen
  s_add_u32 s57, s58, 163840
  buffer_load_dword v100, v5, s[40:43], s57 offen
  s_add_u32 s57, s58, 172032
  buffer_load_dword v101, v5, s[40:43], s57 offen
  s_add_u32 s57, s58, 180224
  buffer_load_dword v102, v5, s[40:43], s57 offen
  s_add_u32 s57, s58, 188416
  buffer_load_dword v103, v5, s[40:43], s57 offen
  s_add_u32 s57, s58, 557056
  buffer_load_dword v104, v5, s[40:43], s57 offen
  s_add_u32 s57, s58, 565248
  buffer_load_dword v105, v5, s[40:43], s57 offen
  s_add_u32 s57, s58, 573440
  buffer_load_dword v106, v5, s[40:43], s57 offen
  s_add_u32 s57, s58, 581632
  buffer_load_dword v107, v5, s[40:43], s57 offen
  s_add_u32 s57, s58, 688128
  buffer_load_dword v108, v5, s[40:43], s57 offen
  s_add_u32 s57, s58, 696320
  buffer_load_dword v109, v5, s[40:43], s57 offen
  s_add_u32 s57, s58, 704512
  buffer_load_dword v110, v5, s[40:43], s57 offen
  s_add_u32 s57, s58, 712704
  buffer_load_dword v111, v5, s[40:43], s57 offen
  s_waitcnt vmcnt(32)
  v_perm_b32 v12, v65, v64, s64
  v_perm_b32 v13, v69, v68, s64
  v_perm_b32 v14, v67, v66, s64
  v_perm_b32 v15, v71, v70, s64
  v_accvgpr_write_b32 a224, v12
  v_accvgpr_write_b32 a225, v13
  v_accvgpr_write_b32 a226, v14
  v_accvgpr_write_b32 a227, v15
  v_perm_b32 v12, v73, v72, s64
  v_perm_b32 v13, v77, v76, s64
  v_perm_b32 v14, v75, v74, s64
  v_perm_b32 v15, v79, v78, s64
  v_accvgpr_write_b32 a228, v12
  v_accvgpr_write_b32 a229, v13
  v_accvgpr_write_b32 a230, v14
  v_accvgpr_write_b32 a231, v15
  v_perm_b32 v12, v65, v64, s65
  v_perm_b32 v13, v69, v68, s65
  v_perm_b32 v14, v67, v66, s65
  v_perm_b32 v15, v71, v70, s65
  v_accvgpr_write_b32 a232, v12
  v_accvgpr_write_b32 a233, v13
  v_accvgpr_write_b32 a234, v14
  v_accvgpr_write_b32 a235, v15
  v_perm_b32 v12, v73, v72, s65
  v_perm_b32 v13, v77, v76, s65
  v_perm_b32 v14, v75, v74, s65
  v_perm_b32 v15, v79, v78, s65
  v_accvgpr_write_b32 a236, v12
  v_accvgpr_write_b32 a237, v13
  v_accvgpr_write_b32 a238, v14
  v_accvgpr_write_b32 a239, v15
  s_lshl_b32 s58, s48, 1
  s_xor_b32 s58, s58, 6
  s_lshl_b32 s58, s58, 19
  s_add_u32 s58, s58, s54
  s_add_u32 s57, s58, 0
  buffer_load_dword v16, v5, s[40:43], s57 offen
  s_add_u32 s57, s58, 8192
  buffer_load_dword v17, v5, s[40:43], s57 offen
  s_add_u32 s57, s58, 16384
  buffer_load_dword v18, v5, s[40:43], s57 offen
  s_add_u32 s57, s58, 24576
  buffer_load_dword v19, v5, s[40:43], s57 offen
  s_add_u32 s57, s58, 131072
  buffer_load_dword v20, v5, s[40:43], s57 offen
  s_add_u32 s57, s58, 139264
  buffer_load_dword v21, v5, s[40:43], s57 offen
  s_add_u32 s57, s58, 147456
  buffer_load_dword v22, v5, s[40:43], s57 offen
  s_add_u32 s57, s58, 155648
  buffer_load_dword v23, v5, s[40:43], s57 offen
  s_add_u32 s57, s58, 524288
  buffer_load_dword v24, v5, s[40:43], s57 offen
  s_add_u32 s57, s58, 532480
  buffer_load_dword v25, v5, s[40:43], s57 offen
  s_add_u32 s57, s58, 540672
  buffer_load_dword v26, v5, s[40:43], s57 offen
  s_add_u32 s57, s58, 548864
  buffer_load_dword v27, v5, s[40:43], s57 offen
  s_add_u32 s57, s58, 655360
  buffer_load_dword v28, v5, s[40:43], s57 offen
  s_add_u32 s57, s58, 663552
  buffer_load_dword v29, v5, s[40:43], s57 offen
  s_add_u32 s57, s58, 671744
  buffer_load_dword v30, v5, s[40:43], s57 offen
  s_add_u32 s57, s58, 679936
  buffer_load_dword v31, v5, s[40:43], s57 offen
  s_waitcnt vmcnt(32)
  v_perm_b32 v12, v81, v80, s64
  v_perm_b32 v13, v85, v84, s64
  v_perm_b32 v14, v83, v82, s64
  v_perm_b32 v15, v87, v86, s64
  v_accvgpr_write_b32 a240, v12
  v_accvgpr_write_b32 a241, v13
  v_accvgpr_write_b32 a242, v14
  v_accvgpr_write_b32 a243, v15
  v_perm_b32 v12, v89, v88, s64
  v_perm_b32 v13, v93, v92, s64
  v_perm_b32 v14, v91, v90, s64
  v_perm_b32 v15, v95, v94, s64
  v_accvgpr_write_b32 a244, v12
  v_accvgpr_write_b32 a245, v13
  v_accvgpr_write_b32 a246, v14
  v_accvgpr_write_b32 a247, v15
  v_perm_b32 v12, v81, v80, s65
  v_perm_b32 v13, v85, v84, s65
  v_perm_b32 v14, v83, v82, s65
  v_perm_b32 v15, v87, v86, s65
  v_accvgpr_write_b32 a248, v12
  v_accvgpr_write_b32 a249, v13
  v_accvgpr_write_b32 a250, v14
  v_accvgpr_write_b32 a251, v15
  v_perm_b32 v12, v89, v88, s65
  v_perm_b32 v13, v93, v92, s65
  v_perm_b32 v14, v91, v90, s65
  v_perm_b32 v15, v95, v94, s65
  v_accvgpr_write_b32 a252, v12
  v_accvgpr_write_b32 a253, v13
  v_accvgpr_write_b32 a254, v14
  v_accvgpr_write_b32 a255, v15
  s_lshl_b32 s58, s48, 1
  s_xor_b32 s58, s58, 6
  s_lshl_b32 s58, s58, 19
  s_add_u32 s58, s58, s54
  s_add_u32 s57, s58, 32768
  buffer_load_dword v32, v5, s[40:43], s57 offen
  s_add_u32 s57, s58, 40960
  buffer_load_dword v33, v5, s[40:43], s57 offen
  s_add_u32 s57, s58, 49152
  buffer_load_dword v34, v5, s[40:43], s57 offen
  s_add_u32 s57, s58, 57344
  buffer_load_dword v35, v5, s[40:43], s57 offen
  s_add_u32 s57, s58, 163840
  buffer_load_dword v36, v5, s[40:43], s57 offen
  s_add_u32 s57, s58, 172032
  buffer_load_dword v37, v5, s[40:43], s57 offen
  s_add_u32 s57, s58, 180224
  buffer_load_dword v38, v5, s[40:43], s57 offen
  s_add_u32 s57, s58, 188416
  buffer_load_dword v39, v5, s[40:43], s57 offen
  s_add_u32 s57, s58, 557056
  buffer_load_dword v40, v5, s[40:43], s57 offen
  s_add_u32 s57, s58, 565248
  buffer_load_dword v41, v5, s[40:43], s57 offen
  s_add_u32 s57, s58, 573440
  buffer_load_dword v42, v5, s[40:43], s57 offen
  s_add_u32 s57, s58, 581632
  buffer_load_dword v43, v5, s[40:43], s57 offen
  s_add_u32 s57, s58, 688128
  buffer_load_dword v44, v5, s[40:43], s57 offen
  s_add_u32 s57, s58, 696320
  buffer_load_dword v45, v5, s[40:43], s57 offen
  s_add_u32 s57, s58, 704512
  buffer_load_dword v46, v5, s[40:43], s57 offen
  s_add_u32 s57, s58, 712704
  buffer_load_dword v47, v5, s[40:43], s57 offen
  s_waitcnt vmcnt(32)
  v_perm_b32 v120, v97, v96, s64
  v_perm_b32 v121, v101, v100, s64
  v_perm_b32 v122, v99, v98, s64
  v_perm_b32 v123, v103, v102, s64
  v_perm_b32 v124, v105, v104, s64
  v_perm_b32 v125, v109, v108, s64
  v_perm_b32 v126, v107, v106, s64
  v_perm_b32 v127, v111, v110, s64
  v_perm_b32 v128, v97, v96, s65
  v_perm_b32 v129, v101, v100, s65
  v_perm_b32 v130, v99, v98, s65
  v_perm_b32 v131, v103, v102, s65
  v_perm_b32 v132, v105, v104, s65
  v_perm_b32 v133, v109, v108, s65
  v_perm_b32 v134, v107, v106, s65
  v_perm_b32 v135, v111, v110, s65
  s_lshl_b32 s58, s48, 1
  s_xor_b32 s58, s58, 0
  s_lshl_b32 s58, s58, 19
  s_add_u32 s58, s58, s53
  s_add_u32 s57, s58, 0
  buffer_load_dwordx2 v[48:49], v4, s[36:39], s57 offen
  s_add_u32 s57, s58, 8192
  buffer_load_dwordx2 v[50:51], v4, s[36:39], s57 offen
  s_add_u32 s57, s58, 16384
  buffer_load_dwordx2 v[52:53], v4, s[36:39], s57 offen
  s_add_u32 s57, s58, 24576
  buffer_load_dwordx2 v[54:55], v4, s[36:39], s57 offen
  s_add_u32 s57, s58, 131072
  buffer_load_dwordx2 v[56:57], v4, s[36:39], s57 offen
  s_add_u32 s57, s58, 139264
  buffer_load_dwordx2 v[58:59], v4, s[36:39], s57 offen
  s_add_u32 s57, s58, 147456
  buffer_load_dwordx2 v[60:61], v4, s[36:39], s57 offen
  s_add_u32 s57, s58, 155648
  buffer_load_dwordx2 v[62:63], v4, s[36:39], s57 offen
  s_add_u32 s57, s58, 524288
  buffer_load_dwordx2 v[64:65], v4, s[36:39], s57 offen
  s_add_u32 s57, s58, 532480
  buffer_load_dwordx2 v[66:67], v4, s[36:39], s57 offen
  s_add_u32 s57, s58, 540672
  buffer_load_dwordx2 v[68:69], v4, s[36:39], s57 offen
  s_add_u32 s57, s58, 548864
  buffer_load_dwordx2 v[70:71], v4, s[36:39], s57 offen
  s_add_u32 s57, s58, 655360
  buffer_load_dwordx2 v[72:73], v4, s[36:39], s57 offen
  s_add_u32 s57, s58, 663552
  buffer_load_dwordx2 v[74:75], v4, s[36:39], s57 offen
  s_add_u32 s57, s58, 671744
  buffer_load_dwordx2 v[76:77], v4, s[36:39], s57 offen
  s_add_u32 s57, s58, 679936
  buffer_load_dwordx2 v[78:79], v4, s[36:39], s57 offen
  s_waitcnt vmcnt(32)
  v_perm_b32 v136, v17, v16, s64
  v_perm_b32 v137, v21, v20, s64
  v_perm_b32 v138, v19, v18, s64
  v_perm_b32 v139, v23, v22, s64
  v_perm_b32 v140, v25, v24, s64
  v_perm_b32 v141, v29, v28, s64
  v_perm_b32 v142, v27, v26, s64
  v_perm_b32 v143, v31, v30, s64
  v_perm_b32 v144, v17, v16, s65
  v_perm_b32 v145, v21, v20, s65
  v_perm_b32 v146, v19, v18, s65
  v_perm_b32 v147, v23, v22, s65
  v_perm_b32 v148, v25, v24, s65
  v_perm_b32 v149, v29, v28, s65
  v_perm_b32 v150, v27, v26, s65
  v_perm_b32 v151, v31, v30, s65
  s_lshl_b32 s58, s48, 1
  s_xor_b32 s58, s58, 0
  s_lshl_b32 s58, s58, 19
  s_add_u32 s58, s58, s53
  s_add_u32 s57, s58, 32768
  buffer_load_dwordx2 v[80:81], v4, s[36:39], s57 offen
  s_add_u32 s57, s58, 40960
  buffer_load_dwordx2 v[82:83], v4, s[36:39], s57 offen
  s_add_u32 s57, s58, 49152
  buffer_load_dwordx2 v[84:85], v4, s[36:39], s57 offen
  s_add_u32 s57, s58, 57344
  buffer_load_dwordx2 v[86:87], v4, s[36:39], s57 offen
  s_add_u32 s57, s58, 163840
  buffer_load_dwordx2 v[88:89], v4, s[36:39], s57 offen
  s_add_u32 s57, s58, 172032
  buffer_load_dwordx2 v[90:91], v4, s[36:39], s57 offen
  s_add_u32 s57, s58, 180224
  buffer_load_dwordx2 v[92:93], v4, s[36:39], s57 offen
  s_add_u32 s57, s58, 188416
  buffer_load_dwordx2 v[94:95], v4, s[36:39], s57 offen
  s_add_u32 s57, s58, 557056
  buffer_load_dwordx2 v[96:97], v4, s[36:39], s57 offen
  s_add_u32 s57, s58, 565248
  buffer_load_dwordx2 v[98:99], v4, s[36:39], s57 offen
  s_add_u32 s57, s58, 573440
  buffer_load_dwordx2 v[100:101], v4, s[36:39], s57 offen
  s_add_u32 s57, s58, 581632
  buffer_load_dwordx2 v[102:103], v4, s[36:39], s57 offen
  s_add_u32 s57, s58, 688128
  buffer_load_dwordx2 v[104:105], v4, s[36:39], s57 offen
  s_add_u32 s57, s58, 696320
  buffer_load_dwordx2 v[106:107], v4, s[36:39], s57 offen
  s_add_u32 s57, s58, 704512
  buffer_load_dwordx2 v[108:109], v4, s[36:39], s57 offen
  s_add_u32 s57, s58, 712704
  buffer_load_dwordx2 v[110:111], v4, s[36:39], s57 offen
  s_waitcnt vmcnt(32)
  v_perm_b32 v152, v33, v32, s64
  v_perm_b32 v153, v37, v36, s64
  v_perm_b32 v154, v35, v34, s64
  v_perm_b32 v155, v39, v38, s64
  v_perm_b32 v156, v41, v40, s64
  v_perm_b32 v157, v45, v44, s64
  v_perm_b32 v158, v43, v42, s64
  v_perm_b32 v159, v47, v46, s64
  v_perm_b32 v160, v33, v32, s65
  v_perm_b32 v161, v37, v36, s65
  v_perm_b32 v162, v35, v34, s65
  v_perm_b32 v163, v39, v38, s65
  v_perm_b32 v164, v41, v40, s65
  v_perm_b32 v165, v45, v44, s65
  v_perm_b32 v166, v43, v42, s65
  v_perm_b32 v167, v47, v46, s65
  s_lshl_b32 s58, s48, 1
  s_xor_b32 s58, s58, 2
  s_lshl_b32 s58, s58, 19
  s_add_u32 s58, s58, s53
  s_add_u32 s57, s58, 0
  buffer_load_dwordx2 v[16:17], v4, s[36:39], s57 offen
  s_add_u32 s57, s58, 8192
  buffer_load_dwordx2 v[18:19], v4, s[36:39], s57 offen
  s_add_u32 s57, s58, 16384
  buffer_load_dwordx2 v[20:21], v4, s[36:39], s57 offen
  s_add_u32 s57, s58, 24576
  buffer_load_dwordx2 v[22:23], v4, s[36:39], s57 offen
  s_add_u32 s57, s58, 131072
  buffer_load_dwordx2 v[24:25], v4, s[36:39], s57 offen
  s_add_u32 s57, s58, 139264
  buffer_load_dwordx2 v[26:27], v4, s[36:39], s57 offen
  s_add_u32 s57, s58, 147456
  buffer_load_dwordx2 v[28:29], v4, s[36:39], s57 offen
  s_add_u32 s57, s58, 155648
  buffer_load_dwordx2 v[30:31], v4, s[36:39], s57 offen
  s_add_u32 s57, s58, 524288
  buffer_load_dwordx2 v[32:33], v4, s[36:39], s57 offen
  s_add_u32 s57, s58, 532480
  buffer_load_dwordx2 v[34:35], v4, s[36:39], s57 offen
  s_add_u32 s57, s58, 540672
  buffer_load_dwordx2 v[36:37], v4, s[36:39], s57 offen
  s_add_u32 s57, s58, 548864
  buffer_load_dwordx2 v[38:39], v4, s[36:39], s57 offen
  s_add_u32 s57, s58, 655360
  buffer_load_dwordx2 v[40:41], v4, s[36:39], s57 offen
  s_add_u32 s57, s58, 663552
  buffer_load_dwordx2 v[42:43], v4, s[36:39], s57 offen
  s_add_u32 s57, s58, 671744
  buffer_load_dwordx2 v[44:45], v4, s[36:39], s57 offen
  s_add_u32 s57, s58, 679936
  buffer_load_dwordx2 v[46:47], v4, s[36:39], s57 offen
  s_waitcnt vmcnt(32)
  v_perm_b32 v12, v50, v48, s64
  v_perm_b32 v13, v58, v56, s64
  v_perm_b32 v14, v54, v52, s64
  v_perm_b32 v15, v62, v60, s64
  ds_write_b128 v9, v[12:15] offset:0
  s_waitcnt lgkmcnt(0)
  v_perm_b32 v12, v66, v64, s64
  v_perm_b32 v13, v74, v72, s64
  v_perm_b32 v14, v70, v68, s64
  v_perm_b32 v15, v78, v76, s64
  ds_write_b128 v9, v[12:15] offset:1024
  s_waitcnt lgkmcnt(0)
  v_perm_b32 v12, v50, v48, s65
  v_perm_b32 v13, v58, v56, s65
  v_perm_b32 v14, v54, v52, s65
  v_perm_b32 v15, v62, v60, s65
  v_accvgpr_write_b32 a0, v12
  v_accvgpr_write_b32 a1, v13
  v_accvgpr_write_b32 a2, v14
  v_accvgpr_write_b32 a3, v15
  v_perm_b32 v12, v66, v64, s65
  v_perm_b32 v13, v74, v72, s65
  v_perm_b32 v14, v70, v68, s65
  v_perm_b32 v15, v78, v76, s65
  v_accvgpr_write_b32 a4, v12
  v_accvgpr_write_b32 a5, v13
  v_accvgpr_write_b32 a6, v14
  v_accvgpr_write_b32 a7, v15
  v_perm_b32 v12, v51, v49, s64
  v_perm_b32 v13, v59, v57, s64
  v_perm_b32 v14, v55, v53, s64
  v_perm_b32 v15, v63, v61, s64
  ds_write_b128 v9, v[12:15] offset:2048
  s_waitcnt lgkmcnt(0)
  v_perm_b32 v12, v67, v65, s64
  v_perm_b32 v13, v75, v73, s64
  v_perm_b32 v14, v71, v69, s64
  v_perm_b32 v15, v79, v77, s64
  ds_write_b128 v9, v[12:15] offset:3072
  s_waitcnt lgkmcnt(0)
  v_perm_b32 v12, v51, v49, s65
  v_perm_b32 v13, v59, v57, s65
  v_perm_b32 v14, v55, v53, s65
  v_perm_b32 v15, v63, v61, s65
  v_accvgpr_write_b32 a8, v12
  v_accvgpr_write_b32 a9, v13
  v_accvgpr_write_b32 a10, v14
  v_accvgpr_write_b32 a11, v15
  v_perm_b32 v12, v67, v65, s65
  v_perm_b32 v13, v75, v73, s65
  v_perm_b32 v14, v71, v69, s65
  v_perm_b32 v15, v79, v77, s65
  v_accvgpr_write_b32 a12, v12
  v_accvgpr_write_b32 a13, v13
  v_accvgpr_write_b32 a14, v14
  v_accvgpr_write_b32 a15, v15
  s_lshl_b32 s58, s48, 1
  s_xor_b32 s58, s58, 2
  s_lshl_b32 s58, s58, 19
  s_add_u32 s58, s58, s53
  s_add_u32 s57, s58, 32768
  buffer_load_dwordx2 v[48:49], v4, s[36:39], s57 offen
  s_add_u32 s57, s58, 40960
  buffer_load_dwordx2 v[50:51], v4, s[36:39], s57 offen
  s_add_u32 s57, s58, 49152
  buffer_load_dwordx2 v[52:53], v4, s[36:39], s57 offen
  s_add_u32 s57, s58, 57344
  buffer_load_dwordx2 v[54:55], v4, s[36:39], s57 offen
  s_add_u32 s57, s58, 163840
  buffer_load_dwordx2 v[56:57], v4, s[36:39], s57 offen
  s_add_u32 s57, s58, 172032
  buffer_load_dwordx2 v[58:59], v4, s[36:39], s57 offen
  s_add_u32 s57, s58, 180224
  buffer_load_dwordx2 v[60:61], v4, s[36:39], s57 offen
  s_add_u32 s57, s58, 188416
  buffer_load_dwordx2 v[62:63], v4, s[36:39], s57 offen
  s_add_u32 s57, s58, 557056
  buffer_load_dwordx2 v[64:65], v4, s[36:39], s57 offen
  s_add_u32 s57, s58, 565248
  buffer_load_dwordx2 v[66:67], v4, s[36:39], s57 offen
  s_add_u32 s57, s58, 573440
  buffer_load_dwordx2 v[68:69], v4, s[36:39], s57 offen
  s_add_u32 s57, s58, 581632
  buffer_load_dwordx2 v[70:71], v4, s[36:39], s57 offen
  s_add_u32 s57, s58, 688128
  buffer_load_dwordx2 v[72:73], v4, s[36:39], s57 offen
  s_add_u32 s57, s58, 696320
  buffer_load_dwordx2 v[74:75], v4, s[36:39], s57 offen
  s_add_u32 s57, s58, 704512
  buffer_load_dwordx2 v[76:77], v4, s[36:39], s57 offen
  s_add_u32 s57, s58, 712704
  buffer_load_dwordx2 v[78:79], v4, s[36:39], s57 offen
  s_waitcnt vmcnt(32)
  v_perm_b32 v12, v82, v80, s64
  v_perm_b32 v13, v90, v88, s64
  v_perm_b32 v14, v86, v84, s64
  v_perm_b32 v15, v94, v92, s64
  ds_write_b128 v9, v[12:15] offset:4096
  s_waitcnt lgkmcnt(0)
  v_perm_b32 v12, v98, v96, s64
  v_perm_b32 v13, v106, v104, s64
  v_perm_b32 v14, v102, v100, s64
  v_perm_b32 v15, v110, v108, s64
  ds_write_b128 v9, v[12:15] offset:5120
  s_waitcnt lgkmcnt(0)
  v_perm_b32 v12, v82, v80, s65
  v_perm_b32 v13, v90, v88, s65
  v_perm_b32 v14, v86, v84, s65
  v_perm_b32 v15, v94, v92, s65
  v_accvgpr_write_b32 a16, v12
  v_accvgpr_write_b32 a17, v13
  v_accvgpr_write_b32 a18, v14
  v_accvgpr_write_b32 a19, v15
  v_perm_b32 v12, v98, v96, s65
  v_perm_b32 v13, v106, v104, s65
  v_perm_b32 v14, v102, v100, s65
  v_perm_b32 v15, v110, v108, s65
  v_accvgpr_write_b32 a20, v12
  v_accvgpr_write_b32 a21, v13
  v_accvgpr_write_b32 a22, v14
  v_accvgpr_write_b32 a23, v15
  v_perm_b32 v12, v83, v81, s64
  v_perm_b32 v13, v91, v89, s64
  v_perm_b32 v14, v87, v85, s64
  v_perm_b32 v15, v95, v93, s64
  ds_write_b128 v9, v[12:15] offset:6144
  s_waitcnt lgkmcnt(0)
  v_perm_b32 v12, v99, v97, s64
  v_perm_b32 v13, v107, v105, s64
  v_perm_b32 v14, v103, v101, s64
  v_perm_b32 v15, v111, v109, s64
  ds_write_b128 v9, v[12:15] offset:7168
  s_waitcnt lgkmcnt(0)
  v_perm_b32 v12, v83, v81, s65
  v_perm_b32 v13, v91, v89, s65
  v_perm_b32 v14, v87, v85, s65
  v_perm_b32 v15, v95, v93, s65
  v_accvgpr_write_b32 a24, v12
  v_accvgpr_write_b32 a25, v13
  v_accvgpr_write_b32 a26, v14
  v_accvgpr_write_b32 a27, v15
  v_perm_b32 v12, v99, v97, s65
  v_perm_b32 v13, v107, v105, s65
  v_perm_b32 v14, v103, v101, s65
  v_perm_b32 v15, v111, v109, s65
  v_accvgpr_write_b32 a28, v12
  v_accvgpr_write_b32 a29, v13
  v_accvgpr_write_b32 a30, v14
  v_accvgpr_write_b32 a31, v15
  s_lshl_b32 s58, s48, 1
  s_xor_b32 s58, s58, 4
  s_lshl_b32 s58, s58, 19
  s_add_u32 s58, s58, s53
  s_add_u32 s57, s58, 0
  buffer_load_dwordx2 v[80:81], v4, s[36:39], s57 offen
  s_add_u32 s57, s58, 8192
  buffer_load_dwordx2 v[82:83], v4, s[36:39], s57 offen
  s_add_u32 s57, s58, 16384
  buffer_load_dwordx2 v[84:85], v4, s[36:39], s57 offen
  s_add_u32 s57, s58, 24576
  buffer_load_dwordx2 v[86:87], v4, s[36:39], s57 offen
  s_add_u32 s57, s58, 131072
  buffer_load_dwordx2 v[88:89], v4, s[36:39], s57 offen
  s_add_u32 s57, s58, 139264
  buffer_load_dwordx2 v[90:91], v4, s[36:39], s57 offen
  s_add_u32 s57, s58, 147456
  buffer_load_dwordx2 v[92:93], v4, s[36:39], s57 offen
  s_add_u32 s57, s58, 155648
  buffer_load_dwordx2 v[94:95], v4, s[36:39], s57 offen
  s_add_u32 s57, s58, 524288
  buffer_load_dwordx2 v[96:97], v4, s[36:39], s57 offen
  s_add_u32 s57, s58, 532480
  buffer_load_dwordx2 v[98:99], v4, s[36:39], s57 offen
  s_add_u32 s57, s58, 540672
  buffer_load_dwordx2 v[100:101], v4, s[36:39], s57 offen
  s_add_u32 s57, s58, 548864
  buffer_load_dwordx2 v[102:103], v4, s[36:39], s57 offen
  s_add_u32 s57, s58, 655360
  buffer_load_dwordx2 v[104:105], v4, s[36:39], s57 offen
  s_add_u32 s57, s58, 663552
  buffer_load_dwordx2 v[106:107], v4, s[36:39], s57 offen
  s_add_u32 s57, s58, 671744
  buffer_load_dwordx2 v[108:109], v4, s[36:39], s57 offen
  s_add_u32 s57, s58, 679936
  buffer_load_dwordx2 v[110:111], v4, s[36:39], s57 offen
  s_waitcnt vmcnt(32)
  v_perm_b32 v12, v18, v16, s64
  v_perm_b32 v13, v26, v24, s64
  v_perm_b32 v14, v22, v20, s64
  v_perm_b32 v15, v30, v28, s64
  ds_write_b128 v9, v[12:15] offset:8192
  s_waitcnt lgkmcnt(0)
  v_perm_b32 v12, v34, v32, s64
  v_perm_b32 v13, v42, v40, s64
  v_perm_b32 v14, v38, v36, s64
  v_perm_b32 v15, v46, v44, s64
  ds_write_b128 v9, v[12:15] offset:9216
  s_waitcnt lgkmcnt(0)
  v_perm_b32 v12, v18, v16, s65
  v_perm_b32 v13, v26, v24, s65
  v_perm_b32 v14, v22, v20, s65
  v_perm_b32 v15, v30, v28, s65
  v_accvgpr_write_b32 a32, v12
  v_accvgpr_write_b32 a33, v13
  v_accvgpr_write_b32 a34, v14
  v_accvgpr_write_b32 a35, v15
  v_perm_b32 v12, v34, v32, s65
  v_perm_b32 v13, v42, v40, s65
  v_perm_b32 v14, v38, v36, s65
  v_perm_b32 v15, v46, v44, s65
  v_accvgpr_write_b32 a36, v12
  v_accvgpr_write_b32 a37, v13
  v_accvgpr_write_b32 a38, v14
  v_accvgpr_write_b32 a39, v15
  v_perm_b32 v12, v19, v17, s64
  v_perm_b32 v13, v27, v25, s64
  v_perm_b32 v14, v23, v21, s64
  v_perm_b32 v15, v31, v29, s64
  ds_write_b128 v9, v[12:15] offset:10240
  s_waitcnt lgkmcnt(0)
  v_perm_b32 v12, v35, v33, s64
  v_perm_b32 v13, v43, v41, s64
  v_perm_b32 v14, v39, v37, s64
  v_perm_b32 v15, v47, v45, s64
  ds_write_b128 v9, v[12:15] offset:11264
  s_waitcnt lgkmcnt(0)
  v_perm_b32 v12, v19, v17, s65
  v_perm_b32 v13, v27, v25, s65
  v_perm_b32 v14, v23, v21, s65
  v_perm_b32 v15, v31, v29, s65
  v_accvgpr_write_b32 a40, v12
  v_accvgpr_write_b32 a41, v13
  v_accvgpr_write_b32 a42, v14
  v_accvgpr_write_b32 a43, v15
  v_perm_b32 v12, v35, v33, s65
  v_perm_b32 v13, v43, v41, s65
  v_perm_b32 v14, v39, v37, s65
  v_perm_b32 v15, v47, v45, s65
  v_accvgpr_write_b32 a44, v12
  v_accvgpr_write_b32 a45, v13
  v_accvgpr_write_b32 a46, v14
  v_accvgpr_write_b32 a47, v15
  s_lshl_b32 s58, s48, 1
  s_xor_b32 s58, s58, 4
  s_lshl_b32 s58, s58, 19
  s_add_u32 s58, s58, s53
  s_add_u32 s57, s58, 32768
  buffer_load_dwordx2 v[16:17], v4, s[36:39], s57 offen
  s_add_u32 s57, s58, 40960
  buffer_load_dwordx2 v[18:19], v4, s[36:39], s57 offen
  s_add_u32 s57, s58, 49152
  buffer_load_dwordx2 v[20:21], v4, s[36:39], s57 offen
  s_add_u32 s57, s58, 57344
  buffer_load_dwordx2 v[22:23], v4, s[36:39], s57 offen
  s_add_u32 s57, s58, 163840
  buffer_load_dwordx2 v[24:25], v4, s[36:39], s57 offen
  s_add_u32 s57, s58, 172032
  buffer_load_dwordx2 v[26:27], v4, s[36:39], s57 offen
  s_add_u32 s57, s58, 180224
  buffer_load_dwordx2 v[28:29], v4, s[36:39], s57 offen
  s_add_u32 s57, s58, 188416
  buffer_load_dwordx2 v[30:31], v4, s[36:39], s57 offen
  s_add_u32 s57, s58, 557056
  buffer_load_dwordx2 v[32:33], v4, s[36:39], s57 offen
  s_add_u32 s57, s58, 565248
  buffer_load_dwordx2 v[34:35], v4, s[36:39], s57 offen
  s_add_u32 s57, s58, 573440
  buffer_load_dwordx2 v[36:37], v4, s[36:39], s57 offen
  s_add_u32 s57, s58, 581632
  buffer_load_dwordx2 v[38:39], v4, s[36:39], s57 offen
  s_add_u32 s57, s58, 688128
  buffer_load_dwordx2 v[40:41], v4, s[36:39], s57 offen
  s_add_u32 s57, s58, 696320
  buffer_load_dwordx2 v[42:43], v4, s[36:39], s57 offen
  s_add_u32 s57, s58, 704512
  buffer_load_dwordx2 v[44:45], v4, s[36:39], s57 offen
  s_add_u32 s57, s58, 712704
  buffer_load_dwordx2 v[46:47], v4, s[36:39], s57 offen
  s_waitcnt vmcnt(32)
  v_perm_b32 v12, v50, v48, s64
  v_perm_b32 v13, v58, v56, s64
  v_perm_b32 v14, v54, v52, s64
  v_perm_b32 v15, v62, v60, s64
  v_accvgpr_write_b32 a48, v12
  v_accvgpr_write_b32 a49, v13
  v_accvgpr_write_b32 a50, v14
  v_accvgpr_write_b32 a51, v15
  v_perm_b32 v12, v66, v64, s64
  v_perm_b32 v13, v74, v72, s64
  v_perm_b32 v14, v70, v68, s64
  v_perm_b32 v15, v78, v76, s64
  v_accvgpr_write_b32 a52, v12
  v_accvgpr_write_b32 a53, v13
  v_accvgpr_write_b32 a54, v14
  v_accvgpr_write_b32 a55, v15
  v_perm_b32 v12, v50, v48, s65
  v_perm_b32 v13, v58, v56, s65
  v_perm_b32 v14, v54, v52, s65
  v_perm_b32 v15, v62, v60, s65
  v_accvgpr_write_b32 a56, v12
  v_accvgpr_write_b32 a57, v13
  v_accvgpr_write_b32 a58, v14
  v_accvgpr_write_b32 a59, v15
  v_perm_b32 v12, v66, v64, s65
  v_perm_b32 v13, v74, v72, s65
  v_perm_b32 v14, v70, v68, s65
  v_perm_b32 v15, v78, v76, s65
  v_accvgpr_write_b32 a60, v12
  v_accvgpr_write_b32 a61, v13
  v_accvgpr_write_b32 a62, v14
  v_accvgpr_write_b32 a63, v15
  v_perm_b32 v12, v51, v49, s64
  v_perm_b32 v13, v59, v57, s64
  v_perm_b32 v14, v55, v53, s64
  v_perm_b32 v15, v63, v61, s64
  ds_write_b128 v9, v[12:15] offset:12288
  s_waitcnt lgkmcnt(0)
  v_perm_b32 v12, v67, v65, s64
  v_perm_b32 v13, v75, v73, s64
  v_perm_b32 v14, v71, v69, s64
  v_perm_b32 v15, v79, v77, s64
  ds_write_b128 v9, v[12:15] offset:13312
  s_waitcnt lgkmcnt(0)
  v_perm_b32 v12, v51, v49, s65
  v_perm_b32 v13, v59, v57, s65
  v_perm_b32 v14, v55, v53, s65
  v_perm_b32 v15, v63, v61, s65
  v_accvgpr_write_b32 a64, v12
  v_accvgpr_write_b32 a65, v13
  v_accvgpr_write_b32 a66, v14
  v_accvgpr_write_b32 a67, v15
  v_perm_b32 v12, v67, v65, s65
  v_perm_b32 v13, v75, v73, s65
  v_perm_b32 v14, v71, v69, s65
  v_perm_b32 v15, v79, v77, s65
  v_accvgpr_write_b32 a68, v12
  v_accvgpr_write_b32 a69, v13
  v_accvgpr_write_b32 a70, v14
  v_accvgpr_write_b32 a71, v15
  s_lshl_b32 s58, s48, 1
  s_xor_b32 s58, s58, 6
  s_lshl_b32 s58, s58, 19
  s_add_u32 s58, s58, s53
  s_add_u32 s57, s58, 0
  buffer_load_dwordx2 v[48:49], v4, s[36:39], s57 offen
  s_add_u32 s57, s58, 8192
  buffer_load_dwordx2 v[50:51], v4, s[36:39], s57 offen
  s_add_u32 s57, s58, 16384
  buffer_load_dwordx2 v[52:53], v4, s[36:39], s57 offen
  s_add_u32 s57, s58, 24576
  buffer_load_dwordx2 v[54:55], v4, s[36:39], s57 offen
  s_add_u32 s57, s58, 131072
  buffer_load_dwordx2 v[56:57], v4, s[36:39], s57 offen
  s_add_u32 s57, s58, 139264
  buffer_load_dwordx2 v[58:59], v4, s[36:39], s57 offen
  s_add_u32 s57, s58, 147456
  buffer_load_dwordx2 v[60:61], v4, s[36:39], s57 offen
  s_add_u32 s57, s58, 155648
  buffer_load_dwordx2 v[62:63], v4, s[36:39], s57 offen
  s_add_u32 s57, s58, 524288
  buffer_load_dwordx2 v[64:65], v4, s[36:39], s57 offen
  s_add_u32 s57, s58, 532480
  buffer_load_dwordx2 v[66:67], v4, s[36:39], s57 offen
  s_add_u32 s57, s58, 540672
  buffer_load_dwordx2 v[68:69], v4, s[36:39], s57 offen
  s_add_u32 s57, s58, 548864
  buffer_load_dwordx2 v[70:71], v4, s[36:39], s57 offen
  s_add_u32 s57, s58, 655360
  buffer_load_dwordx2 v[72:73], v4, s[36:39], s57 offen
  s_add_u32 s57, s58, 663552
  buffer_load_dwordx2 v[74:75], v4, s[36:39], s57 offen
  s_add_u32 s57, s58, 671744
  buffer_load_dwordx2 v[76:77], v4, s[36:39], s57 offen
  s_add_u32 s57, s58, 679936
  buffer_load_dwordx2 v[78:79], v4, s[36:39], s57 offen
  s_waitcnt vmcnt(32)
  v_perm_b32 v12, v82, v80, s64
  v_perm_b32 v13, v90, v88, s64
  v_perm_b32 v14, v86, v84, s64
  v_perm_b32 v15, v94, v92, s64
  ds_write_b128 v9, v[12:15] offset:14336
  s_waitcnt lgkmcnt(0)
  v_perm_b32 v12, v98, v96, s64
  v_perm_b32 v13, v106, v104, s64
  v_perm_b32 v14, v102, v100, s64
  v_perm_b32 v15, v110, v108, s64
  ds_write_b128 v9, v[12:15] offset:15360
  s_waitcnt lgkmcnt(0)
  v_perm_b32 v12, v82, v80, s65
  v_perm_b32 v13, v90, v88, s65
  v_perm_b32 v14, v86, v84, s65
  v_perm_b32 v15, v94, v92, s65
  v_accvgpr_write_b32 a72, v12
  v_accvgpr_write_b32 a73, v13
  v_accvgpr_write_b32 a74, v14
  v_accvgpr_write_b32 a75, v15
  v_perm_b32 v12, v98, v96, s65
  v_perm_b32 v13, v106, v104, s65
  v_perm_b32 v14, v102, v100, s65
  v_perm_b32 v15, v110, v108, s65
  v_accvgpr_write_b32 a76, v12
  v_accvgpr_write_b32 a77, v13
  v_accvgpr_write_b32 a78, v14
  v_accvgpr_write_b32 a79, v15
  v_perm_b32 v12, v83, v81, s64
  v_perm_b32 v13, v91, v89, s64
  v_perm_b32 v14, v87, v85, s64
  v_perm_b32 v15, v95, v93, s64
  ds_write_b128 v9, v[12:15] offset:16384
  s_waitcnt lgkmcnt(0)
  v_perm_b32 v12, v99, v97, s64
  v_perm_b32 v13, v107, v105, s64
  v_perm_b32 v14, v103, v101, s64
  v_perm_b32 v15, v111, v109, s64
  ds_write_b128 v9, v[12:15] offset:17408
  s_waitcnt lgkmcnt(0)
  v_perm_b32 v12, v83, v81, s65
  v_perm_b32 v13, v91, v89, s65
  v_perm_b32 v14, v87, v85, s65
  v_perm_b32 v15, v95, v93, s65
  v_accvgpr_write_b32 a80, v12
  v_accvgpr_write_b32 a81, v13
  v_accvgpr_write_b32 a82, v14
  v_accvgpr_write_b32 a83, v15
  v_perm_b32 v12, v99, v97, s65
  v_perm_b32 v13, v107, v105, s65
  v_perm_b32 v14, v103, v101, s65
  v_perm_b32 v15, v111, v109, s65
  v_accvgpr_write_b32 a84, v12
  v_accvgpr_write_b32 a85, v13
  v_accvgpr_write_b32 a86, v14
  v_accvgpr_write_b32 a87, v15
  s_lshl_b32 s58, s48, 1
  s_xor_b32 s58, s58, 6
  s_lshl_b32 s58, s58, 19
  s_add_u32 s58, s58, s53
  s_add_u32 s57, s58, 32768
  buffer_load_dwordx2 v[80:81], v4, s[36:39], s57 offen
  s_add_u32 s57, s58, 40960
  buffer_load_dwordx2 v[82:83], v4, s[36:39], s57 offen
  s_add_u32 s57, s58, 49152
  buffer_load_dwordx2 v[84:85], v4, s[36:39], s57 offen
  s_add_u32 s57, s58, 57344
  buffer_load_dwordx2 v[86:87], v4, s[36:39], s57 offen
  s_add_u32 s57, s58, 163840
  buffer_load_dwordx2 v[88:89], v4, s[36:39], s57 offen
  s_add_u32 s57, s58, 172032
  buffer_load_dwordx2 v[90:91], v4, s[36:39], s57 offen
  s_add_u32 s57, s58, 180224
  buffer_load_dwordx2 v[92:93], v4, s[36:39], s57 offen
  s_add_u32 s57, s58, 188416
  buffer_load_dwordx2 v[94:95], v4, s[36:39], s57 offen
  s_add_u32 s57, s58, 557056
  buffer_load_dwordx2 v[96:97], v4, s[36:39], s57 offen
  s_add_u32 s57, s58, 565248
  buffer_load_dwordx2 v[98:99], v4, s[36:39], s57 offen
  s_add_u32 s57, s58, 573440
  buffer_load_dwordx2 v[100:101], v4, s[36:39], s57 offen
  s_add_u32 s57, s58, 581632
  buffer_load_dwordx2 v[102:103], v4, s[36:39], s57 offen
  s_add_u32 s57, s58, 688128
  buffer_load_dwordx2 v[104:105], v4, s[36:39], s57 offen
  s_add_u32 s57, s58, 696320
  buffer_load_dwordx2 v[106:107], v4, s[36:39], s57 offen
  s_add_u32 s57, s58, 704512
  buffer_load_dwordx2 v[108:109], v4, s[36:39], s57 offen
  s_add_u32 s57, s58, 712704
  buffer_load_dwordx2 v[110:111], v4, s[36:39], s57 offen
  s_waitcnt vmcnt(32)
  v_perm_b32 v12, v18, v16, s64
  v_perm_b32 v13, v26, v24, s64
  v_perm_b32 v14, v22, v20, s64
  v_perm_b32 v15, v30, v28, s64
  ds_write_b128 v9, v[12:15] offset:18432
  s_waitcnt lgkmcnt(0)
  v_perm_b32 v12, v34, v32, s64
  v_perm_b32 v13, v42, v40, s64
  v_perm_b32 v14, v38, v36, s64
  v_perm_b32 v15, v46, v44, s64
  ds_write_b128 v9, v[12:15] offset:19456
  s_waitcnt lgkmcnt(0)
  v_perm_b32 v12, v18, v16, s65
  v_perm_b32 v13, v26, v24, s65
  v_perm_b32 v14, v22, v20, s65
  v_perm_b32 v15, v30, v28, s65
  v_accvgpr_write_b32 a88, v12
  v_accvgpr_write_b32 a89, v13
  v_accvgpr_write_b32 a90, v14
  v_accvgpr_write_b32 a91, v15
  v_perm_b32 v12, v34, v32, s65
  v_perm_b32 v13, v42, v40, s65
  v_perm_b32 v14, v38, v36, s65
  v_perm_b32 v15, v46, v44, s65
  v_accvgpr_write_b32 a92, v12
  v_accvgpr_write_b32 a93, v13
  v_accvgpr_write_b32 a94, v14
  v_accvgpr_write_b32 a95, v15
  v_perm_b32 v12, v19, v17, s64
  v_perm_b32 v13, v27, v25, s64
  v_perm_b32 v14, v23, v21, s64
  v_perm_b32 v15, v31, v29, s64
  v_accvgpr_write_b32 a96, v12
  v_accvgpr_write_b32 a97, v13
  v_accvgpr_write_b32 a98, v14
  v_accvgpr_write_b32 a99, v15
  v_perm_b32 v12, v35, v33, s64
  v_perm_b32 v13, v43, v41, s64
  v_perm_b32 v14, v39, v37, s64
  v_perm_b32 v15, v47, v45, s64
  v_accvgpr_write_b32 a100, v12
  v_accvgpr_write_b32 a101, v13
  v_accvgpr_write_b32 a102, v14
  v_accvgpr_write_b32 a103, v15
  v_perm_b32 v12, v19, v17, s65
  v_perm_b32 v13, v27, v25, s65
  v_perm_b32 v14, v23, v21, s65
  v_perm_b32 v15, v31, v29, s65
  v_accvgpr_write_b32 a104, v12
  v_accvgpr_write_b32 a105, v13
  v_accvgpr_write_b32 a106, v14
  v_accvgpr_write_b32 a107, v15
  v_perm_b32 v12, v35, v33, s65
  v_perm_b32 v13, v43, v41, s65
  v_perm_b32 v14, v39, v37, s65
  v_perm_b32 v15, v47, v45, s65
  v_accvgpr_write_b32 a108, v12
  v_accvgpr_write_b32 a109, v13
  v_accvgpr_write_b32 a110, v14
  v_accvgpr_write_b32 a111, v15
  s_add_u32 s58, s55, 0
  s_add_u32 s57, s58, 0
  buffer_load_dwordx4 v[16:19], v6, s[96:99], s57 offen
  s_add_u32 s57, s58, 1024
  buffer_load_dwordx4 v[20:23], v6, s[96:99], s57 offen
  s_add_u32 s57, s58, 2048
  buffer_load_dwordx4 v[24:27], v6, s[96:99], s57 offen
  s_add_u32 s57, s58, 3072
  buffer_load_dwordx4 v[28:31], v6, s[96:99], s57 offen
  s_add_u32 s57, s58, 8192
  buffer_load_dwordx4 v[32:35], v6, s[96:99], s57 offen
  s_add_u32 s57, s58, 9216
  buffer_load_dwordx4 v[36:39], v6, s[96:99], s57 offen
  s_add_u32 s57, s58, 10240
  buffer_load_dwordx4 v[40:43], v6, s[96:99], s57 offen
  s_add_u32 s57, s58, 11264
  buffer_load_dwordx4 v[44:47], v6, s[96:99], s57 offen
  s_waitcnt vmcnt(24)
  v_perm_b32 v12, v50, v48, s64
  v_perm_b32 v13, v58, v56, s64
  v_perm_b32 v14, v54, v52, s64
  v_perm_b32 v15, v62, v60, s64
  v_accvgpr_write_b32 a112, v12
  v_accvgpr_write_b32 a113, v13
  v_accvgpr_write_b32 a114, v14
  v_accvgpr_write_b32 a115, v15
  v_perm_b32 v12, v66, v64, s64
  v_perm_b32 v13, v74, v72, s64
  v_perm_b32 v14, v70, v68, s64
  v_perm_b32 v15, v78, v76, s64
  v_accvgpr_write_b32 a116, v12
  v_accvgpr_write_b32 a117, v13
  v_accvgpr_write_b32 a118, v14
  v_accvgpr_write_b32 a119, v15
  v_perm_b32 v12, v50, v48, s65
  v_perm_b32 v13, v58, v56, s65
  v_perm_b32 v14, v54, v52, s65
  v_perm_b32 v15, v62, v60, s65
  v_accvgpr_write_b32 a120, v12
  v_accvgpr_write_b32 a121, v13
  v_accvgpr_write_b32 a122, v14
  v_accvgpr_write_b32 a123, v15
  v_perm_b32 v12, v66, v64, s65
  v_perm_b32 v13, v74, v72, s65
  v_perm_b32 v14, v70, v68, s65
  v_perm_b32 v15, v78, v76, s65
  v_accvgpr_write_b32 a124, v12
  v_accvgpr_write_b32 a125, v13
  v_accvgpr_write_b32 a126, v14
  v_accvgpr_write_b32 a127, v15
  v_perm_b32 v12, v51, v49, s64
  v_perm_b32 v13, v59, v57, s64
  v_perm_b32 v14, v55, v53, s64
  v_perm_b32 v15, v63, v61, s64
  v_accvgpr_write_b32 a128, v12
  v_accvgpr_write_b32 a129, v13
  v_accvgpr_write_b32 a130, v14
  v_accvgpr_write_b32 a131, v15
  v_perm_b32 v12, v67, v65, s64
  v_perm_b32 v13, v75, v73, s64
  v_perm_b32 v14, v71, v69, s64
  v_perm_b32 v15, v79, v77, s64
  v_accvgpr_write_b32 a132, v12
  v_accvgpr_write_b32 a133, v13
  v_accvgpr_write_b32 a134, v14
  v_accvgpr_write_b32 a135, v15
  v_perm_b32 v12, v51, v49, s65
  v_perm_b32 v13, v59, v57, s65
  v_perm_b32 v14, v55, v53, s65
  v_perm_b32 v15, v63, v61, s65
  v_accvgpr_write_b32 a136, v12
  v_accvgpr_write_b32 a137, v13
  v_accvgpr_write_b32 a138, v14
  v_accvgpr_write_b32 a139, v15
  v_perm_b32 v12, v67, v65, s65
  v_perm_b32 v13, v75, v73, s65
  v_perm_b32 v14, v71, v69, s65
  v_perm_b32 v15, v79, v77, s65
  v_accvgpr_write_b32 a140, v12
  v_accvgpr_write_b32 a141, v13
  v_accvgpr_write_b32 a142, v14
  v_accvgpr_write_b32 a143, v15
  s_add_u32 s58, s55, 0
  s_add_u32 s57, s58, 32768
  buffer_load_dwordx4 v[48:51], v6, s[96:99], s57 offen
  s_add_u32 s57, s58, 33792
  buffer_load_dwordx4 v[52:55], v6, s[96:99], s57 offen
  s_add_u32 s57, s58, 34816
  buffer_load_dwordx4 v[56:59], v6, s[96:99], s57 offen
  s_add_u32 s57, s58, 35840
  buffer_load_dwordx4 v[60:63], v6, s[96:99], s57 offen
  s_add_u32 s57, s58, 40960
  buffer_load_dwordx4 v[64:67], v6, s[96:99], s57 offen
  s_add_u32 s57, s58, 41984
  buffer_load_dwordx4 v[68:71], v6, s[96:99], s57 offen
  s_add_u32 s57, s58, 43008
  buffer_load_dwordx4 v[72:75], v6, s[96:99], s57 offen
  s_add_u32 s57, s58, 44032
  buffer_load_dwordx4 v[76:79], v6, s[96:99], s57 offen
  s_waitcnt vmcnt(16)
  v_perm_b32 v12, v82, v80, s64
  v_perm_b32 v13, v90, v88, s64
  v_perm_b32 v14, v86, v84, s64
  v_perm_b32 v15, v94, v92, s64
  v_accvgpr_write_b32 a144, v12
  v_accvgpr_write_b32 a145, v13
  v_accvgpr_write_b32 a146, v14
  v_accvgpr_write_b32 a147, v15
  v_perm_b32 v12, v98, v96, s64
  v_perm_b32 v13, v106, v104, s64
  v_perm_b32 v14, v102, v100, s64
  v_perm_b32 v15, v110, v108, s64
  v_accvgpr_write_b32 a148, v12
  v_accvgpr_write_b32 a149, v13
  v_accvgpr_write_b32 a150, v14
  v_accvgpr_write_b32 a151, v15
  v_perm_b32 v12, v82, v80, s65
  v_perm_b32 v13, v90, v88, s65
  v_perm_b32 v14, v86, v84, s65
  v_perm_b32 v15, v94, v92, s65
  v_accvgpr_write_b32 a152, v12
  v_accvgpr_write_b32 a153, v13
  v_accvgpr_write_b32 a154, v14
  v_accvgpr_write_b32 a155, v15
  v_perm_b32 v12, v98, v96, s65
  v_perm_b32 v13, v106, v104, s65
  v_perm_b32 v14, v102, v100, s65
  v_perm_b32 v15, v110, v108, s65
  v_accvgpr_write_b32 a156, v12
  v_accvgpr_write_b32 a157, v13
  v_accvgpr_write_b32 a158, v14
  v_accvgpr_write_b32 a159, v15
  v_perm_b32 v12, v83, v81, s64
  v_perm_b32 v13, v91, v89, s64
  v_perm_b32 v14, v87, v85, s64
  v_perm_b32 v15, v95, v93, s64
  v_accvgpr_write_b32 a160, v12
  v_accvgpr_write_b32 a161, v13
  v_accvgpr_write_b32 a162, v14
  v_accvgpr_write_b32 a163, v15
  v_perm_b32 v12, v99, v97, s64
  v_perm_b32 v13, v107, v105, s64
  v_perm_b32 v14, v103, v101, s64
  v_perm_b32 v15, v111, v109, s64
  v_accvgpr_write_b32 a164, v12
  v_accvgpr_write_b32 a165, v13
  v_accvgpr_write_b32 a166, v14
  v_accvgpr_write_b32 a167, v15
  v_perm_b32 v12, v83, v81, s65
  v_perm_b32 v13, v91, v89, s65
  v_perm_b32 v14, v87, v85, s65
  v_perm_b32 v15, v95, v93, s65
  v_accvgpr_write_b32 a168, v12
  v_accvgpr_write_b32 a169, v13
  v_accvgpr_write_b32 a170, v14
  v_accvgpr_write_b32 a171, v15
  v_perm_b32 v12, v99, v97, s65
  v_perm_b32 v13, v107, v105, s65
  v_perm_b32 v14, v103, v101, s65
  v_perm_b32 v15, v111, v109, s65
  v_accvgpr_write_b32 a172, v12
  v_accvgpr_write_b32 a173, v13
  v_accvgpr_write_b32 a174, v14
  v_accvgpr_write_b32 a175, v15
  s_add_u32 s58, s55, 65536
  s_add_u32 s57, s58, 0
  buffer_load_dwordx4 v[80:83], v6, s[96:99], s57 offen
  s_add_u32 s57, s58, 1024
  buffer_load_dwordx4 v[84:87], v6, s[96:99], s57 offen
  s_add_u32 s57, s58, 2048
  buffer_load_dwordx4 v[88:91], v6, s[96:99], s57 offen
  s_add_u32 s57, s58, 3072
  buffer_load_dwordx4 v[92:95], v6, s[96:99], s57 offen
  s_add_u32 s57, s58, 8192
  buffer_load_dwordx4 v[96:99], v6, s[96:99], s57 offen
  s_add_u32 s57, s58, 9216
  buffer_load_dwordx4 v[100:103], v6, s[96:99], s57 offen
  s_add_u32 s57, s58, 10240
  buffer_load_dwordx4 v[104:107], v6, s[96:99], s57 offen
  s_add_u32 s57, s58, 11264
  buffer_load_dwordx4 v[108:111], v6, s[96:99], s57 offen
  s_waitcnt vmcnt(16)
  v_perm_b32 v168, v20, v16, s64
  v_perm_b32 v169, v36, v32, s64
  v_perm_b32 v170, v28, v24, s64
  v_perm_b32 v171, v44, v40, s64
  v_perm_b32 v184, v20, v16, s65
  v_perm_b32 v185, v36, v32, s65
  v_perm_b32 v186, v28, v24, s65
  v_perm_b32 v187, v44, v40, s65
  v_perm_b32 v200, v21, v17, s64
  v_perm_b32 v201, v37, v33, s64
  v_perm_b32 v202, v29, v25, s64
  v_perm_b32 v203, v45, v41, s64
  v_perm_b32 v216, v21, v17, s65
  v_perm_b32 v217, v37, v33, s65
  v_perm_b32 v218, v29, v25, s65
  v_perm_b32 v219, v45, v41, s65
  v_perm_b32 v232, v22, v18, s64
  v_perm_b32 v233, v38, v34, s64
  v_perm_b32 v234, v30, v26, s64
  v_perm_b32 v235, v46, v42, s64
  v_perm_b32 v248, v22, v18, s65
  v_perm_b32 v249, v38, v34, s65
  v_perm_b32 v250, v30, v26, s65
  v_perm_b32 v251, v46, v42, s65
  v_perm_b32 v12, v23, v19, s64
  v_perm_b32 v13, v39, v35, s64
  v_perm_b32 v14, v31, v27, s64
  v_perm_b32 v15, v47, v43, s64
  ds_write_b128 v9, v[12:15] offset:22528
  s_waitcnt lgkmcnt(0)
  v_perm_b32 v12, v23, v19, s65
  v_perm_b32 v13, v39, v35, s65
  v_perm_b32 v14, v31, v27, s65
  v_perm_b32 v15, v47, v43, s65
  ds_write_b128 v9, v[12:15] offset:26624
  s_waitcnt lgkmcnt(0)
  s_add_u32 s58, s55, 65536
  s_add_u32 s57, s58, 32768
  buffer_load_dwordx4 v[16:19], v6, s[96:99], s57 offen
  s_add_u32 s57, s58, 33792
  buffer_load_dwordx4 v[20:23], v6, s[96:99], s57 offen
  s_add_u32 s57, s58, 34816
  buffer_load_dwordx4 v[24:27], v6, s[96:99], s57 offen
  s_add_u32 s57, s58, 35840
  buffer_load_dwordx4 v[28:31], v6, s[96:99], s57 offen
  s_add_u32 s57, s58, 40960
  buffer_load_dwordx4 v[32:35], v6, s[96:99], s57 offen
  s_add_u32 s57, s58, 41984
  buffer_load_dwordx4 v[36:39], v6, s[96:99], s57 offen
  s_add_u32 s57, s58, 43008
  buffer_load_dwordx4 v[40:43], v6, s[96:99], s57 offen
  s_add_u32 s57, s58, 44032
  buffer_load_dwordx4 v[44:47], v6, s[96:99], s57 offen
  s_waitcnt vmcnt(16)
  v_perm_b32 v172, v52, v48, s64
  v_perm_b32 v173, v68, v64, s64
  v_perm_b32 v174, v60, v56, s64
  v_perm_b32 v175, v76, v72, s64
  v_perm_b32 v188, v52, v48, s65
  v_perm_b32 v189, v68, v64, s65
  v_perm_b32 v190, v60, v56, s65
  v_perm_b32 v191, v76, v72, s65
  v_perm_b32 v204, v53, v49, s64
  v_perm_b32 v205, v69, v65, s64
  v_perm_b32 v206, v61, v57, s64
  v_perm_b32 v207, v77, v73, s64
  v_perm_b32 v220, v53, v49, s65
  v_perm_b32 v221, v69, v65, s65
  v_perm_b32 v222, v61, v57, s65
  v_perm_b32 v223, v77, v73, s65
  v_perm_b32 v236, v54, v50, s64
  v_perm_b32 v237, v70, v66, s64
  v_perm_b32 v238, v62, v58, s64
  v_perm_b32 v239, v78, v74, s64
  v_perm_b32 v252, v54, v50, s65
  v_perm_b32 v253, v70, v66, s65
  v_perm_b32 v254, v62, v58, s65
  v_perm_b32 v255, v78, v74, s65
  v_perm_b32 v12, v55, v51, s64
  v_perm_b32 v13, v71, v67, s64
  v_perm_b32 v14, v63, v59, s64
  v_perm_b32 v15, v79, v75, s64
  ds_write_b128 v9, v[12:15] offset:23552
  s_waitcnt lgkmcnt(0)
  v_perm_b32 v12, v55, v51, s65
  v_perm_b32 v13, v71, v67, s65
  v_perm_b32 v14, v63, v59, s65
  v_perm_b32 v15, v79, v75, s65
  ds_write_b128 v9, v[12:15] offset:27648
  s_waitcnt lgkmcnt(0)
  s_getpc_b64 s[54:55]
Lpc_83:
  s_add_u32 s54, s54, TEAM_SETUP2-Lpc_83
  s_addc_u32 s55, s55, 0
  v_lshlrev_b32 v4, 3, v2
  v_add_u32 v5, 0, v4
  v_min_u32 v5, TEAM_FOREIGN-TEAM_SETUP2-4, v5
  v_mov_b32 v11, s55
  v_add_co_u32 v10, vcc, s54, v5
  s_nop 1
  v_addc_co_u32 v11, vcc, 0, v11, vcc
  global_load_dword v6, v[10:11], off
  s_waitcnt vmcnt(8)
  v_perm_b32 v176, v84, v80, s64
  v_perm_b32 v177, v100, v96, s64
  v_perm_b32 v178, v92, v88, s64
  v_perm_b32 v179, v108, v104, s64
  v_perm_b32 v192, v84, v80, s65
  v_perm_b32 v193, v100, v96, s65
  v_perm_b32 v194, v92, v88, s65
  v_perm_b32 v195, v108, v104, s65
  v_perm_b32 v208, v85, v81, s64
  v_perm_b32 v209, v101, v97, s64
  v_perm_b32 v210, v93, v89, s64
  v_perm_b32 v211, v109, v105, s64
  v_perm_b32 v224, v85, v81, s65
  v_perm_b32 v225, v101, v97, s65
  v_perm_b32 v226, v93, v89, s65
  v_perm_b32 v227, v109, v105, s65
  v_perm_b32 v240, v86, v82, s64
  v_perm_b32 v241, v102, v98, s64
  v_perm_b32 v242, v94, v90, s64
  v_perm_b32 v243, v110, v106, s64
  v_perm_b32 v12, v86, v82, s65
  v_perm_b32 v13, v102, v98, s65
  v_perm_b32 v14, v94, v90, s65
  v_perm_b32 v15, v110, v106, s65
  ds_write_b128 v9, v[12:15] offset:20480
  s_waitcnt lgkmcnt(0)
  v_perm_b32 v12, v87, v83, s64
  v_perm_b32 v13, v103, v99, s64
  v_perm_b32 v14, v95, v91, s64
  v_perm_b32 v15, v111, v107, s64
  ds_write_b128 v9, v[12:15] offset:24576
  s_waitcnt lgkmcnt(0)
  v_perm_b32 v12, v87, v83, s65
  v_perm_b32 v13, v103, v99, s65
  v_perm_b32 v14, v95, v91, s65
  v_perm_b32 v15, v111, v107, s65
  ds_write_b128 v9, v[12:15] offset:28672
  s_waitcnt lgkmcnt(0)
  s_waitcnt vmcnt(0)
  v_perm_b32 v180, v20, v16, s64
  v_perm_b32 v181, v36, v32, s64
  v_perm_b32 v182, v28, v24, s64
  v_perm_b32 v183, v44, v40, s64
  v_perm_b32 v196, v20, v16, s65
  v_perm_b32 v197, v36, v32, s65
  v_perm_b32 v198, v28, v24, s65
  v_perm_b32 v199, v44, v40, s65
  v_perm_b32 v212, v21, v17, s64
  v_perm_b32 v213, v37, v33, s64
  v_perm_b32 v214, v29, v25, s64
  v_perm_b32 v215, v45, v41, s64
  v_perm_b32 v228, v21, v17, s65
  v_perm_b32 v229, v37, v33, s65
  v_perm_b32 v230, v29, v25, s65
  v_perm_b32 v231, v45, v41, s65
  v_perm_b32 v244, v22, v18, s64
  v_perm_b32 v245, v38, v34, s64
  v_perm_b32 v246, v30, v26, s64
  v_perm_b32 v247, v46, v42, s64
  v_perm_b32 v12, v22, v18, s65
  v_perm_b32 v13, v38, v34, s65
  v_perm_b32 v14, v30, v26, s65
  v_perm_b32 v15, v46, v42, s65
  ds_write_b128 v9, v[12:15] offset:21504
  s_waitcnt lgkmcnt(0)
  v_perm_b32 v12, v23, v19, s64
  v_perm_b32 v13, v39, v35, s64
  v_perm_b32 v14, v31, v27, s64
  v_perm_b32 v15, v47, v43, s64
  ds_write_b128 v9, v[12:15] offset:25600
  s_waitcnt lgkmcnt(0)
  v_perm_b32 v12, v23, v19, s65
  v_perm_b32 v13, v39, v35, s65
  v_perm_b32 v14, v31, v27, s65
  v_perm_b32 v15, v47, v43, s65
  ds_write_b128 v9, v[12:15] offset:29696
  s_waitcnt lgkmcnt(0)
  s_waitcnt vmcnt(0)
TEAM_SETUP2:
  s_mov_b32 s36, s6
  s_mov_b32 s37, s7
  s_mov_b32 s38, 8192
  s_mov_b32 s39, 0x00020000
  v_bfe_u32 v72, v1, 2, 2
  v_lshlrev_b32 v72, 11, v72
  v_and_b32 v73, 1, v1
  v_lshl_add_u32 v72, v73, 10, v72
  v_bfe_u32 v73, v1, 1, 1
  v_lshl_add_u32 v72, v73, 5, v72
  v_lshrrev_b32 v73, 4, v1
  v_lshl_add_u32 v72, v73, 6, v72
  s_lshl_b32 s53, s48, 8
  buffer_load_dwordx2 v[16:17], v72, s[36:39], s53 offen offset:0
  buffer_load_dwordx2 v[18:19], v72, s[36:39], s53 offen offset:16
  buffer_load_dwordx2 v[20:21], v72, s[36:39], s53 offen offset:8
  buffer_load_dwordx2 v[22:23], v72, s[36:39], s53 offen offset:24
  v_bfe_u32 v74, v1, 1, 1
  v_mov_b32 v75, 0x4444
  v_mov_b32 v76, 0xeeee
  v_cmp_eq_u32 vcc, 1, v74
  s_nop 1
  v_cndmask_b32 v3, v75, v76, vcc
  s_mov_b32 s69, -1
  s_mov_b32 s70, 0x3e0293ee
  s_mov_b32 s72, -1
  s_mov_b32 s73, 0
  s_mov_b32 s74, 0x000f000f
  s_mov_b32 s75, 0
  s_mov_b32 s83, 0x3f803f80
  s_mov_b32 s76, 0x33333333
  s_mov_b32 s77, 0x33333333
  s_lshl_b32 s52, s49, 2
  s_add_u32 s52, s52, s48
  s_lshl_b32 s68, s52, 11
  s_add_u32 s68, s68, 4194304
  v_lshrrev_b32 v74, 2, v1
  v_lshlrev_b32 v74, 11, v74
  v_and_b32 v75, 3, v1
  v_lshl_add_u32 v74, v75, 4, v74
  s_lshl_b32 s53, s48, 16
  s_lshl_b32 s54, s49, 6
  s_add_u32 s53, s53, s54
  s_add_u32 s53, s53, 4194304
  v_add_u32 v5, s53, v74
  s_lshr_b32 s53, s52, 4
  s_lshl_b32 s53, s53, 10
  s_and_b32 s54, s52, 3
  s_lshl_b32 s54, s54, 8
  s_add_u32 s53, s53, s54
  s_bfe_u32 s54, s52, 0x20002
  s_lshl_b32 s54, s54, 6
  s_add_u32 s53, s53, s54
  v_bfe_u32 v74, v1, 1, 1
  v_lshlrev_b32 v74, 5, v74
  v_and_b32 v75, 1, v1
  v_lshl_add_u32 v74, v75, 3, v74
  v_bfe_u32 v75, v1, 4, 1
  v_lshl_add_u32 v74, v75, 4, v74
  v_add_u32 v6, s53, v74
  v_bfe_u32 v74, v1, 2, 2
  v_lshlrev_b32 v74, 5, v74
  v_and_b32 v75, 1, v1
  v_lshl_add_u32 v74, v75, 4, v74
  v_bfe_u32 v75, v1, 1, 1
  v_lshl_add_u32 v74, v75, 3, v74
  v_lshrrev_b32 v75, 4, v1
  v_mul_u32_u24 v75, 576, v75
  v_add_u32 v74, v74, v75
  s_and_b32 s53, s48, 1
  s_lshl_b32 s53, s53, 7
  s_lshr_b32 s54, s48, 1
  s_mul_i32 s54, s54, 2304
  s_add_u32 s53, s53, s54
  s_add_u32 s53, s53, 34816
  v_add_u32 v7, s53, v74
  v_lshrrev_b32 v74, 4, v1
  v_lshlrev_b32 v75, 4, v74
  v_bfe_u32 v76, v1, 2, 2
  v_mul_u32_u24 v76, 576, v76
  v_add_u32 v75, v75, v76
  v_and_b32 v76, 1, v1
  v_mul_u32_u24 v77, 288, v76
  v_add_u32 v75, v75, v77
  v_add_u32 v8, 34816, v75
  v_lshlrev_b32 v75, 4, v76
  v_bfe_u32 v76, v1, 2, 2
  v_lshl_add_u32 v75, v76, 6, v75
  v_bfe_u32 v76, v1, 4, 1
  v_lshl_add_u32 v75, v76, 5, v75
  v_lshrrev_b32 v76, 5, v1
  v_lshl_add_u32 v75, v76, 8, v75
  s_lshl_b32 s53, s48, 9
  s_add_u32 s53, s53, 32768
  v_add_u32 v11, s53, v75
  v_lshlrev_b32 v75, 9, v74
  v_and_b32 v76, 15, v1
  v_lshl_add_u32 v75, v76, 4, v75
  v_add_u32 v9, 0, v75
  v_lshrrev_b32 v75, 5, v1
  v_lshlrev_b32 v75, 9, v75
  v_bfe_u32 v76, v1, 3, 1
  v_lshl_add_u32 v75, v76, 8, v75
  v_bfe_u32 v76, v1, 2, 1
  v_lshl_add_u32 v75, v76, 6, v75
  v_and_b32 v76, 3, v1
  v_lshl_add_u32 v75, v76, 4, v75
  v_bfe_u32 v76, v1, 4, 1
  v_lshl_add_u32 v78, v76, 7, v75
  v_lshlrev_b32 v75, 9, v74
  v_and_b32 v76, 15, v1
  v_lshl_add_u32 v75, v76, 5, v75
  s_lshl_b32 s53, s48, 11
  s_add_u32 s53, s53, 8192
  v_add_u32 v10, s53, v75
  s_mul_i32 s53, s48, 30720
  s_add_u32 s53, s53, 40960
  v_add_u32 v12, s53, v2
  v_mov_b32 v4, 0
  s_lshl_b32 s78, s49, 19
  s_and_b32 s53, s48, 1
  s_lshl_b32 s53, s53, 12
  s_add_u32 s78, s78, s53
  s_lshr_b32 s53, s48, 1
  s_mul_i32 s53, s53, 16777216
  s_add_u32 s78, s78, s53
  s_add_u32 s78, s78, 16777216
  s_lshl_b32 s82, s48, 12
  s_add_u32 s82, s82, 0
  s_lshl_b32 s79, s49, 17
  s_add_u32 s80, s79, 134217728
  s_lshl_b32 s53, s48, 9
  s_add_u32 s80, s80, s53
  s_lshl_b32 s62, s49, 7
  s_add_u32 s62, s62, 0
  s_lshl_b32 s79, s49, 18
  s_add_u32 s79, s79, 8351488
  s_lshl_b32 s81, s49, 7
  s_add_u32 s81, s81, 24576
  s_cmp_eq_u32 s50, 0
  s_cselect_b32 s71, 64, 0
  s_cmp_eq_u32 s48, 0
  s_cselect_b32 s98, 1, 0
  s_mov_b32 s99, 0
  s_cmp_ge_u32 s48, 2
  s_cselect_b32 s100, -1, 0
  s_mov_b32 s101, s100
  s_cmp_lt_u32 s48, 2
  s_cselect_b64 vcc, -1, 0
  s_nop 1
  v_cndmask_b32 v1, v2, v78, vcc
  v_mov_b32 v74, 128
  v_mov_b32 v75, 16
  v_cmp_eq_u32 vcc, 0, v2
  s_nop 1
  v_cndmask_b32 v74, v75, v74, vcc
  s_mov_b32 s52, 0
Ltbarp_84:
  buffer_load_dword v75, v74, s[44:47], 0 offen sc1
  s_add_u32 s52, s52, 1
  s_cmp_gt_u32 s52, 65536
  s_cbranch_scc1 Ltbard_85
  s_waitcnt vmcnt(0)
  v_readlane_b32 s53, v75, 1
  v_readlane_b32 s54, v75, 0
  s_lshr_b32 s63, s53, 16
  s_and_b32 s53, s53, 0xffff
  s_cmp_lt_u32 s53, 32
  s_cbranch_scc1 Ltbarp_84
  s_cmp_eq_u32 s50, 0
  s_cbranch_scc1 Ltbard_85
  s_cmp_lt_u32 s54, 48
  s_cbranch_scc1 Ltbarp_84
Ltbard_85:
  s_waitcnt vmcnt(0)
  s_mov_b32 s51, 0
  s_mov_b32 s66, 0
  s_mov_b32 s67, 3145728
  s_cmp_lt_u32 s51, s71
  s_cbranch_scc1 Lkv0_86
  v_bfe_u32 v33, v2, 2, 4
  v_and_b32 v32, 64, v2
  v_lshl_add_u32 v33, v32, 6, v33
  s_mov_b32 s52, 0
  s_branch Lkve_88
Lkvr_87:
  buffer_load_dword v4, v33, s[32:35], s62 offen sc1
  s_add_u32 s52, s52, 1
  s_cmp_gt_u32 s52, 65536
  s_cbranch_scc1 Lkvd_89
  s_waitcnt vmcnt(0)
Lkve_88:
  v_lshlrev_b32 v32, 2, v4
  s_nop 0
  v_readlane_b32 s71, v32, 0
  v_readlane_b32 s54, v32, 1
  s_add_u32 s54, s54, 1
  s_min_u32 s71, s71, s54
  v_readlane_b32 s54, v32, 2
  s_add_u32 s54, s54, 2
  s_min_u32 s71, s71, s54
  v_readlane_b32 s54, v32, 3
  s_add_u32 s54, s54, 3
  s_min_u32 s71, s71, s54
  v_readlane_b32 s54, v32, 4
  s_add_u32 s54, s54, 0
  s_min_u32 s71, s71, s54
  v_readlane_b32 s54, v32, 5
  s_add_u32 s54, s54, 1
  s_min_u32 s71, s71, s54
  v_readlane_b32 s54, v32, 6
  s_add_u32 s54, s54, 2
  s_min_u32 s71, s71, s54
  v_readlane_b32 s54, v32, 7
  s_add_u32 s54, s54, 3
  s_min_u32 s71, s71, s54
  s_cmp_lt_u32 s51, s71
  s_cbranch_scc0 Lkvr_87
Lkvd_89:
Lkv0_86:
  s_mov_b32 m0, s82
  s_nop 0
  buffer_load_dwordx4 v1, s[32:35], s78 offen offset:0 sc1 lds
  buffer_load_dwordx4 v1, s[32:35], s78 offen offset:1024 sc1 lds
  buffer_load_dwordx4 v1, s[32:35], s78 offen offset:2048 sc1 lds
  buffer_load_dwordx4 v1, s[32:35], s78 offen offset:3072 sc1 lds
  s_add_u32 s78, s78, 8192
  s_xor_b32 s82, s82, 16384
  s_waitcnt vmcnt(0)
  s_barrier
  ds_read_b128 v[72:75], v12 offset:0
  ds_read_b128 v[76:79], v12 offset:1024
  ds_read_b128 v[80:83], v12 offset:2048
  ds_read_b128 v[84:87], v12 offset:3072
  ds_read_b128 v[88:91], v12 offset:4096
  ds_read_b128 v[92:95], v12 offset:5120
  ds_read_b128 v[96:99], v12 offset:6144
  ds_read_b128 v[100:103], v12 offset:7168
  ds_read_b128 v[104:107], v12 offset:8192
  ds_read_b128 v[108:111], v12 offset:9216
  ds_read_b128 v[112:115], v12 offset:10240
  ds_read_b128 v[116:119], v12 offset:11264
  v_mov_b64 v[48:49], 0
  v_mov_b64 v[50:51], 0
  v_mov_b64 v[52:53], 0
  v_mov_b64 v[54:55], 0
  v_mov_b64 v[56:57], 0
  v_mov_b64 v[58:59], 0
  v_mov_b64 v[60:61], 0
  v_mov_b64 v[62:63], 0
  v_mov_b64 v[64:65], 0
  v_mov_b64 v[66:67], 0
  v_mov_b64 v[68:69], 0
  v_mov_b64 v[70:71], 0
  s_lshl_b32 s53, s48, 11
  s_add_u32 s53, s53, 32768
  v_add_u32 v0, s53, v2
  v_xor_b32 v13, 2048, v0
  v_xor_b32 v14, 4096, v0
  v_xor_b32 v15, 6144, v0
  s_waitcnt lgkmcnt(0)
  s_cmp_lg_u32 s63, 0
  s_cbranch_scc1 TEAM_FOREIGN
TEAM_STEP:
  ds_write_b128 v0, v[16:19]
  ds_write_b128 v0, v[20:23] offset:1024
  s_xor_b32 s56, s68, 262144
  s_add_u32 s59, s51, 1
  s_min_u32 s59, s59, 62
  s_mov_b32 m0, s82
  s_cmp_lt_u32 s59, s71
  s_cbranch_scc0 TEAM_KVSLOW
TEAM_KVGO:
  v_smfmac_f32_16x16x64_bf16 v[48:51], v[16:19], v[72:79], v3
  v_smfmac_f32_16x16x64_bf16 v[52:55], v[16:19], a[0:7], v3
  v_smfmac_f32_16x16x64_bf16 v[56:59], v[16:19], v[80:87], v3
  v_smfmac_f32_16x16x64_bf16 v[60:63], v[16:19], a[8:15], v3
  v_smfmac_f32_16x16x64_bf16 v[64:67], v[16:19], a[176:183], v3
  s_waitcnt lgkmcnt(0)
  s_barrier
  ds_read_b128 v[24:27], v13 offset:0
  ds_read_b128 v[28:31], v13 offset:1024
  ds_read_b128 v[32:35], v14 offset:0
  ds_read_b128 v[36:39], v14 offset:1024
  v_smfmac_f32_16x16x64_bf16 v[48:51], v[20:23], v[88:95], v3
  ds_read_b128 v[72:75], v12 offset:12288
  v_smfmac_f32_16x16x64_bf16 v[52:55], v[20:23], a[16:23], v3
  ds_read_b128 v[76:79], v12 offset:13312
  v_smfmac_f32_16x16x64_bf16 v[56:59], v[20:23], v[96:103], v3
  ds_read_b128 v[80:83], v12 offset:14336
  v_smfmac_f32_16x16x64_bf16 v[60:63], v[20:23], a[24:31], v3
  ds_read_b128 v[84:87], v12 offset:15360
  s_waitcnt vmcnt(0)
  ds_read_b128 v[40:43], v15 offset:0
  ds_read_b128 v[44:47], v15 offset:1024
  v_smfmac_f32_16x16x64_bf16 v[68:71], v[16:19], a[184:191], v3
  ds_read_b128 v[88:91], v12 offset:16384
  v_smfmac_f32_16x16x64_bf16 v[64:67], v[20:23], a[192:199], v3
  ds_read_b128 v[92:95], v12 offset:17408
  v_smfmac_f32_16x16x64_bf16 v[68:71], v[20:23], a[200:207], v3
  ds_read_b128 v[96:99], v12 offset:18432
  s_waitcnt lgkmcnt(12)
  v_smfmac_f32_16x16x64_bf16 v[48:51], v[24:27], v[104:111], v3
  ds_read_b128 v[100:103], v12 offset:19456
  v_smfmac_f32_16x16x64_bf16 v[52:55], v[24:27], a[32:39], v3
  ds_read_b128 v[104:107], v9 offset:0
  v_smfmac_f32_16x16x64_bf16 v[56:59], v[24:27], v[112:119], v3
  ds_read_b128 v[108:111], v9 offset:256
  v_smfmac_f32_16x16x64_bf16 v[60:63], v[24:27], a[40:47], v3
  s_waitcnt lgkmcnt(6)
  s_barrier
  v_smfmac_f32_16x16x64_bf16 v[48:51], v[28:31], a[48:55], v3
  buffer_load_dwordx4 v1, s[32:35], s78 offen offset:0 sc1 lds
  v_smfmac_f32_16x16x64_bf16 v[52:55], v[28:31], a[56:63], v3
  v_mov_b32 v0, s51
  v_smfmac_f32_16x16x64_bf16 v[56:59], v[28:31], v[72:79], v3
  ds_read_b128 v[72:75], v9 offset:2048
  v_smfmac_f32_16x16x64_bf16 v[60:63], v[28:31], a[64:71], v3
  ds_read_b128 v[76:79], v9 offset:2304
  v_smfmac_f32_16x16x64_bf16 v[48:51], v[32:35], v[80:87], v3
  ds_read_b128 v[80:83], v9 offset:4096
  v_smfmac_f32_16x16x64_bf16 v[52:55], v[32:35], a[72:79], v3
  ds_read_b128 v[84:87], v9 offset:4352
  s_waitcnt lgkmcnt(8)
  v_smfmac_f32_16x16x64_bf16 v[56:59], v[32:35], v[88:95], v3
  ds_read_b128 v[88:91], v9 offset:6144
  v_smfmac_f32_16x16x64_bf16 v[60:63], v[32:35], a[80:87], v3
  ds_read_b128 v[92:95], v9 offset:6400
  s_waitcnt lgkmcnt(8)
  v_smfmac_f32_16x16x64_bf16 v[48:51], v[36:39], v[96:103], v3
  ds_read_b128 v[96:99], v10
  v_smfmac_f32_16x16x64_bf16 v[52:55], v[36:39], a[88:95], v3
  ds_read_b128 v[100:103], v10 offset:16
  v_smfmac_f32_16x16x64_bf16 v[56:59], v[36:39], a[96:103], v3
  buffer_load_dwordx4 v1, s[32:35], s78 offen offset:1024 sc1 lds
  v_smfmac_f32_16x16x64_bf16 v[60:63], v[36:39], a[104:111], v3
  v_mov_b32 v13, 0
  v_smfmac_f32_16x16x64_bf16 v[48:51], v[40:43], a[112:119], v3
  buffer_load_dwordx4 v1, s[32:35], s78 offen offset:2048 sc1 lds
  v_smfmac_f32_16x16x64_bf16 v[52:55], v[40:43], a[120:127], v3
  v_mov_b32 v116, -1
  v_smfmac_f32_16x16x64_bf16 v[56:59], v[40:43], a[128:135], v3
  buffer_load_dwordx4 v1, s[32:35], s78 offen offset:3072 sc1 lds
  v_smfmac_f32_16x16x64_bf16 v[60:63], v[40:43], a[136:143], v3
  s_mov_b64 exec, s[98:99]
  buffer_store_dword v0, v13, s[32:35], s81 offen sc1
  s_mov_b64 exec, -1
  v_smfmac_f32_16x16x64_bf16 v[48:51], v[44:47], a[144:151], v3
  buffer_store_dword v116, v2, s[32:35], s56 offen offset:0
  v_smfmac_f32_16x16x64_bf16 v[52:55], v[44:47], a[152:159], v3
  v_lshrrev_b32 v117, 8, v2
  v_smfmac_f32_16x16x64_bf16 v[56:59], v[44:47], a[160:167], v3
  buffer_store_dword v116, v2, s[32:35], s56 offen offset:1024
  v_smfmac_f32_16x16x64_bf16 v[60:63], v[44:47], a[168:175], v3
  v_mul_u32_u24 v117, 64, v117
  v_smfmac_f32_16x16x64_bf16 v[64:67], v[24:27], a[208:215], v3
  v_smfmac_f32_16x16x64_bf16 v[68:71], v[24:27], a[216:223], v3
  v_sub_u32 v117, v7, v117
  v_add_f32 v48, v48, v50
  v_add_f32 v49, v49, v51
  v_add_f32 v52, v52, v54
  v_add_f32 v53, v53, v55
  v_add_f32 v56, v56, v58
  v_add_f32 v57, v57, v59
  v_add_f32 v60, v60, v62
  v_add_f32 v61, v61, v63
  v_cvt_pk_bf16_f32 v112, v48, v52
  v_cvt_pk_bf16_f32 v113, v56, v60
  v_cvt_pk_bf16_f32 v114, v49, v53
  v_cvt_pk_bf16_f32 v115, v57, v61
  ds_write_b64 v7, v[112:113]
  ds_write_b64 v7, v[114:115] offset:288
  v_smfmac_f32_16x16x64_bf16 v[64:67], v[28:31], a[224:231], v3
  s_mov_b64 exec, s[100:101]
  buffer_store_dwordx2 v[112:113], v117, s[32:35], s79 offen sc1
  buffer_store_dwordx2 v[114:115], v117, s[32:35], s79 offen offset:256 sc1
  s_mov_b64 exec, -1
  v_smfmac_f32_16x16x64_bf16 v[68:71], v[28:31], a[232:239], v3
  v_bfe_u32 v0, v2, 2, 4
  v_smfmac_f32_16x16x64_bf16 v[64:67], v[32:35], a[240:247], v3
  v_and_b32 v13, 64, v2
  v_smfmac_f32_16x16x64_bf16 v[68:71], v[32:35], a[248:255], v3
  v_lshl_add_u32 v0, v13, 6, v0
  s_waitcnt lgkmcnt(0)
  s_barrier
  ds_read_b128 v[16:19], v8 offset:0
  ds_read_b128 v[116:119], v8 offset:2304
  ds_read_b128 v[20:23], v8 offset:64
  ds_read_b128 v[60:63], v8 offset:2368
  ds_read_b128 v[24:27], v8 offset:128
  ds_read_b128 v[32:35], v8 offset:2432
  ds_read_b128 v[28:31], v8 offset:192
  v_smfmac_f32_16x16x64_bf16 v[64:67], v[36:39], v[120:127], v3
  v_smfmac_f32_16x16x64_bf16 v[68:71], v[36:39], v[128:135], v3
  ds_read_b128 v[36:39], v8 offset:2496
  v_smfmac_f32_16x16x64_bf16 v[64:67], v[40:43], v[136:143], v3
  s_add_u32 s59, s59, 1
  s_cmp_ge_u32 s59, s71
  s_cselect_b64 exec, -1, 0
  buffer_load_dword v4, v0, s[32:35], s62 offen sc1
  s_mov_b64 exec, -1
  v_smfmac_f32_16x16x64_bf16 v[68:71], v[40:43], v[144:151], v3
  v_smfmac_f32_16x16x64_bf16 v[64:67], v[44:47], v[152:159], v3
  v_smfmac_f32_16x16x64_bf16 v[68:71], v[44:47], v[160:167], v3
  s_waitcnt lgkmcnt(0)
  v_mfma_f32_16x16x32_bf16 v[52:55], v[104:107], v[16:19], 0
  s_add_u32 s78, s78, 8192
  s_xor_b32 s82, s82, 16384
  v_mfma_f32_16x16x32_bf16 v[56:59], v[108:111], v[16:19], 0
  s_add_u32 s79, s79, 4096
  s_nop 0
  v_mfma_f32_16x16x32_bf16 v[48:51], v[116:119], v[16:19], 0
  v_add_f32 v64, v64, v66
  v_add_f32 v65, v65, v67
  v_mfma_f32_16x16x32_bf16 v[52:55], v[72:75], v[20:23], v[52:55]
  v_add_f32 v68, v68, v70
  v_add_f32 v69, v69, v71
  v_mfma_f32_16x16x32_bf16 v[56:59], v[76:79], v[20:23], v[56:59]
  v_cvt_pk_bf16_f32 v14, v64, v65
  v_cvt_pk_bf16_f32 v15, v68, v69
  v_mfma_f32_16x16x32_bf16 v[48:51], v[60:63], v[20:23], v[48:51]
  v_lshrrev_b32 v13, 1, v2
  buffer_store_dwordx2 v[14:15], v13, s[32:35], s80 offen sc1
  v_mfma_f32_16x16x32_bf16 v[52:55], v[80:83], v[24:27], v[52:55]
  v_mov_b32 v40, v14
  v_mov_b32 v41, 0
  v_mfma_f32_16x16x32_bf16 v[56:59], v[84:87], v[24:27], v[56:59]
  v_mov_b64 v[42:43], 0
  v_mov_b32 v44, v15
  v_mfma_f32_16x16x32_bf16 v[48:51], v[32:35], v[24:27], v[48:51]
  v_mov_b32 v45, 0
  v_mov_b64 v[46:47], 0
  v_mfma_f32_16x16x32_bf16 v[52:55], v[88:91], v[28:31], v[52:55]
  v_xor_b32 v9, 16384, v9
  v_xor_b32 v10, 16384, v10
  v_mfma_f32_16x16x32_bf16 v[56:59], v[92:95], v[28:31], v[56:59]
  v_mfma_f32_16x16x32_bf16 v[48:51], v[36:39], v[28:31], v[48:51]
  s_add_u32 s80, s80, 2048
  v_mov_b32 v16, s83
  v_mov_b32 v17, s83
  s_cmp_ge_u32 s51, 63
  s_cbranch_scc1 TEAM_LAST
  v_mov_b32 v0, v0
  v_mov_b32 v0, v0
  v_mov_b32 v0, v0
  v_max3_f32 v50, v52, v53, v54
  v_max3_f32 v51, v55, v56, v57
  v_max3_f32 v50, v50, v58, v59
  v_max3_f32 v51, v51, v48, v49
  v_max_f32 v50, v50, v51
  v_max_f32 v51, v50, v51
  v_mov_b32 v18, s83
  v_mov_b32 v19, s83
  v_permlane16_swap_b32 v50, v51
  v_max_f32 v60, v50, v51
  v_max_f32 v51, v50, v51
  v_mov_b32 v20, s83
  v_mov_b32 v21, 0
  v_permlane32_swap_b32 v60, v51
  v_max_f32 v50, v60, v51
  v_mul_f32 v50, s70, v50
  v_fma_f32 v52, v52, s70, -v50
  v_fma_f32 v53, v53, s70, -v50
  v_fma_f32 v54, v54, s70, -v50
  v_fma_f32 v55, v55, s70, -v50
  v_fma_f32 v56, v56, s70, -v50
  v_fma_f32 v57, v57, s70, -v50
  v_fma_f32 v58, v58, s70, -v50
  v_fma_f32 v59, v59, s70, -v50
  v_fma_f32 v48, v48, s70, -v50
  v_fma_f32 v49, v49, s70, -v50
  v_exp_f32 v52, v52
  v_exp_f32 v53, v53
  v_exp_f32 v54, v54
  v_exp_f32 v55, v55
  v_exp_f32 v56, v56
  v_exp_f32 v57, v57
  v_exp_f32 v58, v58
  v_exp_f32 v59, v59
  v_exp_f32 v48, v48
  v_exp_f32 v49, v49
  v_cvt_pk_bf16_f32 v116, v52, v53
  v_cvt_pk_bf16_f32 v117, v54, v55
  v_cvt_pk_bf16_f32 v118, v56, v57
  v_cvt_pk_bf16_f32 v119, v58, v59
  v_cvt_pk_bf16_f32 v114, v48, v49
  v_mov_b64 v[22:23], 0
  v_mfma_f32_16x16x32_bf16 v[60:63], v[16:19], v[116:119], 0
  v_mov_b64 v[72:73], 0
  v_mov_b64 v[74:75], 0
  v_mfma_f32_16x16x32_bf16 v[64:67], v[96:99], v[116:119], 0
  v_mov_b64 v[76:77], 0
  v_mov_b64 v[78:79], 0
  v_mfma_f32_16x16x32_bf16 v[60:63], v[20:23], v[114:117], v[60:63]
  v_mov_b64 v[80:81], 0
  v_mov_b64 v[82:83], 0
  v_mfma_f32_16x16x32_bf16 v[68:71], v[100:103], v[116:119], 0
  v_mov_b64 v[84:85], 0
  v_mov_b64 v[86:87], 0
  v_mfma_f32_16x16x32_bf16 v[64:67], v[40:43], v[114:117], v[64:67]
  v_mov_b64 v[88:89], 0
  v_mov_b64 v[90:91], 0
  v_mfma_f32_16x16x32_bf16 v[68:71], v[44:47], v[114:117], v[68:71]
  v_mov_b64 v[92:93], 0
  v_mov_b64 v[94:95], 0
  v_rcp_f32 v0, v60
  v_mov_b64 v[104:105], 0
  v_mov_b64 v[106:107], 0
  v_mov_b64 v[108:109], 0
  v_mov_b64 v[110:111], 0
  s_nop 1
  v_pk_mul_f32 v[64:65], v[64:65], v[0:1] op_sel_hi:[1,0]
  v_pk_mul_f32 v[66:67], v[66:67], v[0:1] op_sel_hi:[1,0]
  v_pk_mul_f32 v[68:69], v[68:69], v[0:1] op_sel_hi:[1,0]
  v_pk_mul_f32 v[70:71], v[70:71], v[0:1] op_sel_hi:[1,0]
  v_cvt_pk_bf16_f32 v16, v64, v68
  v_cvt_pk_bf16_f32 v17, v65, v69
  v_cvt_pk_bf16_f32 v18, v66, v70
  v_cvt_pk_bf16_f32 v19, v67, v71
  s_mov_b64 exec, s[76:77]
  ds_write_b128 v11, v[16:19]
  s_mov_b64 exec, -1
  v_bfe_u32 v0, v2, 5, 3
  v_and_b32 v13, 16, v2
  v_mov_b32 v36, 0x3f80
  v_lshlrev_b32 v13, v13, v36
  v_cmp_eq_u32 vcc, 0, v0
  v_mov_b64 v[64:65], 0
  v_mov_b64 v[66:67], 0
  v_cndmask_b32 v32, 0, v13, vcc
  v_cmp_eq_u32 vcc, 1, v0
  v_mov_b64 v[68:69], 0
  v_mov_b64 v[70:71], 0
  v_cndmask_b32 v33, 0, v13, vcc
  s_waitcnt lgkmcnt(0)
  s_barrier
  ds_read_b128 v[24:27], v2 offset:32768
  ds_read_b128 v[28:31], v2 offset:33792
  ds_read_b128 v[96:99], v12 offset:20480
  ds_read_b128 v[100:103], v12 offset:21504
  ds_read_b128 v[112:115], v12 offset:22528
  ds_read_b128 v[116:119], v12 offset:23552
  s_waitcnt lgkmcnt(5)
  v_smfmac_f32_16x16x64_bf16 v[72:75], v[24:27], v[168:175], v3
  s_waitcnt lgkmcnt(4)
  s_add_u32 s56, s66, 32768
  v_smfmac_f32_16x16x64_bf16 v[72:75], v[28:31], v[176:183], v3
  ds_read_b128 v[48:51], v12 offset:24576
  v_smfmac_f32_16x16x64_bf16 v[76:79], v[24:27], v[184:191], v3
  ds_read_b128 v[52:55], v12 offset:25600
  v_smfmac_f32_16x16x64_bf16 v[76:79], v[28:31], v[192:199], v3
  ds_read_b128 v[56:59], v12 offset:26624
  v_smfmac_f32_16x16x64_bf16 v[80:83], v[24:27], v[200:207], v3
  ds_read_b128 v[60:63], v12 offset:27648
  v_smfmac_f32_16x16x64_bf16 v[80:83], v[28:31], v[208:215], v3
  ds_read_b128 v[16:19], v12 offset:28672
  v_smfmac_f32_16x16x64_bf16 v[84:87], v[24:27], v[216:223], v3
  ds_read_b128 v[20:23], v12 offset:29696
  v_add_f32 v72, v72, v74
  v_smfmac_f32_16x16x64_bf16 v[84:87], v[28:31], v[224:231], v3
  v_add_f32 v73, v73, v75
  v_smfmac_f32_16x16x64_bf16 v[88:91], v[24:27], v[232:239], v3
  v_add_f32 v76, v76, v78
  v_add_f32 v77, v77, v79
  v_smfmac_f32_16x16x64_bf16 v[88:91], v[28:31], v[240:247], v3
  v_cvt_pk_bf16_f32 v40, v72, v76
  v_cvt_pk_bf16_f32 v42, v73, v77
  v_smfmac_f32_16x16x64_bf16 v[92:95], v[24:27], v[248:255], v3
  v_add_f32 v80, v80, v82
  v_add_f32 v81, v81, v83
  s_waitcnt lgkmcnt(0)
  v_smfmac_f32_16x16x64_bf16 v[92:95], v[28:31], v[96:103], v3
  v_add_f32 v84, v84, v86
  v_add_f32 v85, v85, v87
  v_smfmac_f32_16x16x64_bf16 v[104:107], v[24:27], v[112:119], v3
  v_cvt_pk_bf16_f32 v41, v80, v84
  v_cvt_pk_bf16_f32 v43, v81, v85
  v_smfmac_f32_16x16x64_bf16 v[104:107], v[28:31], v[48:55], v3
  buffer_store_dwordx4 v[40:43], v5, s[32:35], s66 offen
  v_smfmac_f32_16x16x64_bf16 v[108:111], v[24:27], v[56:63], v3
  v_add_f32 v88, v88, v90
  v_add_f32 v89, v89, v91
  v_smfmac_f32_16x16x64_bf16 v[108:111], v[28:31], v[16:23], v3
  v_add_f32 v92, v92, v94
  v_add_f32 v93, v93, v95
  v_cvt_pk_bf16_f32 v44, v88, v92
  v_cvt_pk_bf16_f32 v46, v89, v93
  v_add_f32 v104, v104, v106
  v_add_f32 v105, v105, v107
  s_nop 1
  v_add_f32 v108, v108, v110
  v_add_f32 v109, v109, v111
  v_cvt_pk_bf16_f32 v45, v104, v108
  v_cvt_pk_bf16_f32 v47, v105, v109
  buffer_store_dwordx4 v[44:47], v5, s[32:35], s56 offen
  v_cmp_eq_u32 vcc, 2, v0
  v_mov_b64 v[48:49], 0
  v_mov_b64 v[50:51], 0
  v_cndmask_b32 v34, 0, v13, vcc
  v_cmp_eq_u32 vcc, 3, v0
  v_mov_b64 v[52:53], 0
  v_mov_b64 v[54:55], 0
  v_cndmask_b32 v35, 0, v13, vcc
  v_mov_b64 v[56:57], 0
  v_mov_b64 v[58:59], 0
  v_mov_b64 v[60:61], 0
  v_mov_b64 v[62:63], 0
  ds_read_b128 v[72:75], v12 offset:0
  ds_read_b128 v[76:79], v12 offset:1024
  ds_read_b128 v[80:83], v12 offset:2048
  ds_read_b128 v[84:87], v12 offset:3072
  ds_read_b128 v[88:91], v12 offset:4096
  ds_read_b128 v[92:95], v12 offset:5120
  ds_read_b128 v[96:99], v12 offset:6144
  ds_read_b128 v[100:103], v12 offset:7168
  ds_read_b128 v[104:107], v12 offset:8192
  ds_read_b128 v[108:111], v12 offset:9216
  ds_read_b128 v[112:115], v12 offset:10240
  ds_read_b128 v[116:119], v12 offset:11264
  buffer_load_dwordx4 v[16:19], v2, s[32:35], s68 offen sc1
  buffer_load_dwordx4 v[20:23], v2, s[32:35], s68 offen offset:1024 sc1
  s_mov_b32 s52, 0
  v_mov_b32 v0, v0
  v_mov_b32 v0, v0
  v_mov_b32 v0, v0
  v_mov_b32 v0, v0
  v_mov_b32 v0, v0
  v_mov_b32 v0, v0
  v_mov_b32 v0, v0
  v_mov_b32 v0, v0
  v_mov_b32 v0, v0
  v_mov_b32 v0, v0
  v_mov_b32 v0, v0
  v_mov_b32 v0, v0
  v_mov_b32 v0, v0
  v_mov_b32 v0, v0
  v_mov_b32 v0, v0
  v_mov_b32 v0, v0
  v_mov_b32 v0, v0
  v_mov_b32 v0, v0
  v_mov_b32 v0, v0
  v_mov_b32 v0, v0
  v_mov_b32 v0, v0
  v_mov_b32 v0, v0
  v_mov_b32 v0, v0
  v_mov_b32 v0, v0
TEAM_RPOLL:
  buffer_load_dwordx4 v[24:27], v2, s[32:35], s68 offen sc1
  buffer_load_dwordx4 v[28:31], v2, s[32:35], s68 offen offset:1024 sc1
  s_waitcnt vmcnt(2)
  v_mfma_f32_16x16x32_bf16 v[36:39], v[32:35], v[16:19], 0
  v_mfma_f32_16x16x32_bf16 v[36:39], v[32:35], v[20:23], v[36:39]
  v_max_u32 v0, v16, v20
  v_cmp_eq_u32 vcc, s69, v0
  s_cbranch_vccz TEAM_ROK
  buffer_load_dwordx4 v[16:19], v2, s[32:35], s68 offen sc1
  buffer_load_dwordx4 v[20:23], v2, s[32:35], s68 offen offset:1024 sc1
  s_waitcnt vmcnt(2)
  v_mfma_f32_16x16x32_bf16 v[36:39], v[32:35], v[24:27], 0
  v_mfma_f32_16x16x32_bf16 v[36:39], v[32:35], v[28:31], v[36:39]
  v_max_u32 v0, v24, v28
  v_cmp_eq_u32 vcc, s69, v0
  s_cbranch_vccz TEAM_ROK
  s_add_u32 s52, s52, 1
  s_cmp_gt_u32 s52, 32768
  s_cbranch_scc0 TEAM_RPOLL
  s_branch TEAM_DONE
TEAM_ROK:
  v_mov_b32 v0, v0
  v_mov_b32 v0, v0
  v_mov_b32 v0, v0
  v_mov_b32 v0, v0
  v_mov_b32 v0, v0
  v_add_f32_dpp v36, v36, v36 row_ror:4 row_mask:0xf bank_mask:0xf
  v_add_f32_dpp v37, v37, v37 row_ror:4 row_mask:0xf bank_mask:0xf
  v_add_f32_dpp v38, v38, v38 row_ror:4 row_mask:0xf bank_mask:0xf
  v_add_f32_dpp v39, v39, v39 row_ror:4 row_mask:0xf bank_mask:0xf
  v_add_f32_dpp v36, v36, v36 row_ror:8 row_mask:0xf bank_mask:0xf
  v_add_f32_dpp v37, v37, v37 row_ror:8 row_mask:0xf bank_mask:0xf
  v_add_f32_dpp v38, v38, v38 row_ror:8 row_mask:0xf bank_mask:0xf
  v_add_f32_dpp v39, v39, v39 row_ror:8 row_mask:0xf bank_mask:0xf
  v_cvt_pk_bf16_f32 v14, v36, v37
  v_cvt_pk_bf16_f32 v15, v38, v39
  s_mov_b64 exec, s[74:75]
  buffer_store_dwordx2 v[14:15], v6, s[32:35], s67 offen
  v_mov_b64 v[36:37], -1
  s_xor_b32 s53, s67, 8192
  buffer_store_dwordx2 v[36:37], v6, s[32:35], s53 offen
  s_mov_b64 exec, -1
  s_xor_b32 s66, s66, 262144
  s_xor_b32 s68, s68, 262144
  s_xor_b32 s67, s67, 8192
  s_add_u32 s51, s51, 1
  s_mov_b32 s52, 0
TEAM_GATHER:
  s_lshl_b32 s55, s48, 11
  s_xor_b32 s54, s67, 8192
  s_add_u32 s54, s54, s55
  s_add_u32 s53, s55, 32768
  v_mov_b32 v32, v32
  v_mov_b32 v32, v32
  v_mov_b32 v32, v32
  v_mov_b32 v32, v32
  v_mov_b32 v32, v32
  v_mov_b32 v32, v32
  v_mov_b32 v32, v32
  v_mov_b32 v32, v32
  v_mov_b32 v32, v32
  v_mov_b32 v32, v32
  v_mov_b32 v32, v32
  v_mov_b32 v32, v32
  v_mov_b32 v32, v32
  v_mov_b32 v32, v32
  v_mov_b32 v32, v32
  v_mov_b32 v32, v32
  v_mov_b32 v32, v32
  v_mov_b32 v32, v32
  v_mov_b32 v32, v32
  v_mov_b32 v32, v32
  v_mov_b32 v32, v32
  v_mov_b32 v32, v32
  v_mov_b32 v32, v32
  v_mov_b32 v32, v32
  v_mov_b32 v32, v32
  v_mov_b32 v32, v32
  v_mov_b32 v32, v32
  v_mov_b32 v32, v32
  v_mov_b32 v32, v32
  v_mov_b32 v32, v32
  v_mov_b32 v32, v32
  v_mov_b32 v32, v32
  buffer_load_dwordx4 v[16:19], v2, s[32:35], s54 offen sc1
  buffer_load_dwordx4 v[20:23], v2, s[32:35], s54 offen offset:1024 sc1
  v_add_u32 v0, s53, v2
  v_xor_b32 v13, 2048, v0
  v_xor_b32 v14, 4096, v0
  v_xor_b32 v15, 6144, v0
  s_waitcnt lgkmcnt(0)
  v_mov_b32 v32, v32
  v_mov_b32 v32, v32
  v_mov_b32 v32, v32
  v_mov_b32 v32, v32
  v_mov_b32 v32, v32
  v_mov_b32 v32, v32
  v_mov_b32 v32, v32
  v_mov_b32 v32, v32
  v_mov_b32 v32, v32
  v_mov_b32 v32, v32
  v_mov_b32 v32, v32
  v_mov_b32 v32, v32
  v_mov_b32 v32, v32
  v_mov_b32 v32, v32
  v_mov_b32 v32, v32
  v_mov_b32 v32, v32
  v_mov_b32 v32, v32
  v_mov_b32 v32, v32
  v_mov_b32 v32, v32
  v_mov_b32 v32, v32
  v_mov_b32 v32, v32
  v_mov_b32 v32, v32
  v_mov_b32 v32, v32
  v_mov_b32 v32, v32
TEAM_GPOLL:
  buffer_load_dwordx4 v[40:43], v2, s[32:35], s54 offen sc1
  buffer_load_dwordx4 v[44:47], v2, s[32:35], s54 offen offset:1024 sc1
  s_waitcnt vmcnt(2)
  v_max3_u32 v32, v16, v18, v20
  v_max_u32 v32, v32, v22
  v_cmp_eq_u32 vcc, s69, v32
  s_cbranch_vccz TEAM_STEP
  buffer_load_dwordx4 v[16:19], v2, s[32:35], s54 offen sc1
  buffer_load_dwordx4 v[20:23], v2, s[32:35], s54 offen offset:1024 sc1
  s_waitcnt vmcnt(2)
  v_max3_u32 v32, v40, v42, v44
  v_max_u32 v32, v32, v46
  v_cmp_eq_u32 vcc, s69, v32
  s_cbranch_vccz TEAM_GOK1
  s_add_u32 s52, s52, 1
  s_cmp_gt_u32 s52, 32768
  s_cbranch_scc0 TEAM_GPOLL
  s_branch TEAM_DONE
TEAM_GOK1:
  v_mov_b64 v[16:17], v[40:41]
  v_mov_b64 v[18:19], v[42:43]
  v_mov_b64 v[20:21], v[44:45]
  v_mov_b64 v[22:23], v[46:47]
  s_nop 0
  s_branch TEAM_STEP
TEAM_KVSLOW:
  v_bfe_u32 v33, v2, 2, 4
  v_and_b32 v32, 64, v2
  v_lshl_add_u32 v33, v32, 6, v33
  s_mov_b32 s52, 0
  s_branch Lkve_91
Lkvr_90:
  buffer_load_dword v4, v33, s[32:35], s62 offen sc1
  s_add_u32 s52, s52, 1
  s_cmp_gt_u32 s52, 65536
  s_cbranch_scc1 Lkvd_92
  s_waitcnt vmcnt(0)
Lkve_91:
  v_lshlrev_b32 v32, 2, v4
  s_nop 0
  v_readlane_b32 s71, v32, 0
  v_readlane_b32 s54, v32, 1
  s_add_u32 s54, s54, 1
  s_min_u32 s71, s71, s54
  v_readlane_b32 s54, v32, 2
  s_add_u32 s54, s54, 2
  s_min_u32 s71, s71, s54
  v_readlane_b32 s54, v32, 3
  s_add_u32 s54, s54, 3
  s_min_u32 s71, s71, s54
  v_readlane_b32 s54, v32, 4
  s_add_u32 s54, s54, 0
  s_min_u32 s71, s71, s54
  v_readlane_b32 s54, v32, 5
  s_add_u32 s54, s54, 1
  s_min_u32 s71, s71, s54
  v_readlane_b32 s54, v32, 6
  s_add_u32 s54, s54, 2
  s_min_u32 s71, s71, s54
  v_readlane_b32 s54, v32, 7
  s_add_u32 s54, s54, 3
  s_min_u32 s71, s71, s54
  s_cmp_lt_u32 s59, s71
  s_cbranch_scc0 Lkvr_90
Lkvd_92:
  s_branch TEAM_KVGO
TEAM_FOREIGN:
  v_add_u32 v5, 2097152, v5
  s_add_u32 s68, s68, 2097152
  s_mov_b32 s67, 3407872
  s_add_u32 s53, s68, 262144
  v_mov_b64 v[24:25], -1
  v_mov_b64 v[26:27], -1
  buffer_store_dwordx4 v[24:27], v2, s[32:35], s68 offen offset:0 sc1
  buffer_store_dwordx4 v[24:27], v2, s[32:35], s53 offen offset:0 sc1
  buffer_store_dwordx4 v[24:27], v2, s[32:35], s68 offen offset:1024 sc1
  buffer_store_dwordx4 v[24:27], v2, s[32:35], s53 offen offset:1024 sc1
  s_lshl_b32 s53, s49, 2
  s_add_u32 s53, s53, s48
  s_lshl_b32 s53, s53, 7
  s_add_u32 s53, s53, 3407872
  s_mov_b64 exec, 0xff
  buffer_store_dwordx4 v[24:27], v2, s[32:35], s53 offen sc1
  s_mov_b64 exec, 1
  v_mov_b32 v28, 20
  v_mov_b32 v29, 1
  s_waitcnt vmcnt(0)
  buffer_atomic_add v29, v28, s[44:47], 0 offen
  s_mov_b32 s52, 0
Lfbar_93:
  buffer_load_dword v29, v28, s[44:47], 0 offen sc1
  s_add_u32 s52, s52, 1
  s_waitcnt vmcnt(0)
  v_readfirstlane_b32 s53, v29
  s_cmp_gt_u32 s52, 65536
  s_cselect_b32 s53, 128, s53
  s_sleep 4
  s_cmp_lt_u32 s53, 128
  s_cbranch_scc1 Lfbar_93
  s_mov_b64 exec, -1
TEAM_STEP_S:
  ds_write_b128 v0, v[16:19]
  ds_write_b128 v0, v[20:23] offset:1024
  s_xor_b32 s56, s68, 262144
  s_add_u32 s59, s51, 1
  s_min_u32 s59, s59, 62
  s_mov_b32 m0, s82
  s_cmp_lt_u32 s59, s71
  s_cbranch_scc0 TEAM_KVSLOW_S
TEAM_KVGO_S:
  v_smfmac_f32_16x16x64_bf16 v[48:51], v[16:19], v[72:79], v3
  v_smfmac_f32_16x16x64_bf16 v[52:55], v[16:19], a[0:7], v3
  v_smfmac_f32_16x16x64_bf16 v[56:59], v[16:19], v[80:87], v3
  v_smfmac_f32_16x16x64_bf16 v[60:63], v[16:19], a[8:15], v3
  v_smfmac_f32_16x16x64_bf16 v[64:67], v[16:19], a[176:183], v3
  s_waitcnt lgkmcnt(0)
  s_barrier
  ds_read_b128 v[24:27], v13 offset:0
  ds_read_b128 v[28:31], v13 offset:1024
  ds_read_b128 v[32:35], v14 offset:0
  ds_read_b128 v[36:39], v14 offset:1024
  v_smfmac_f32_16x16x64_bf16 v[48:51], v[20:23], v[88:95], v3
  ds_read_b128 v[72:75], v12 offset:12288
  v_smfmac_f32_16x16x64_bf16 v[52:55], v[20:23], a[16:23], v3
  ds_read_b128 v[76:79], v12 offset:13312
  v_smfmac_f32_16x16x64_bf16 v[56:59], v[20:23], v[96:103], v3
  ds_read_b128 v[80:83], v12 offset:14336
  v_smfmac_f32_16x16x64_bf16 v[60:63], v[20:23], a[24:31], v3
  ds_read_b128 v[84:87], v12 offset:15360
  s_waitcnt vmcnt(0)
  ds_read_b128 v[40:43], v15 offset:0
  ds_read_b128 v[44:47], v15 offset:1024
  v_smfmac_f32_16x16x64_bf16 v[68:71], v[16:19], a[184:191], v3
  ds_read_b128 v[88:91], v12 offset:16384
  v_smfmac_f32_16x16x64_bf16 v[64:67], v[20:23], a[192:199], v3
  ds_read_b128 v[92:95], v12 offset:17408
  v_smfmac_f32_16x16x64_bf16 v[68:71], v[20:23], a[200:207], v3
  ds_read_b128 v[96:99], v12 offset:18432
  s_waitcnt lgkmcnt(12)
  v_smfmac_f32_16x16x64_bf16 v[48:51], v[24:27], v[104:111], v3
  ds_read_b128 v[100:103], v12 offset:19456
  v_smfmac_f32_16x16x64_bf16 v[52:55], v[24:27], a[32:39], v3
  ds_read_b128 v[104:107], v9 offset:0
  v_smfmac_f32_16x16x64_bf16 v[56:59], v[24:27], v[112:119], v3
  ds_read_b128 v[108:111], v9 offset:256
  v_smfmac_f32_16x16x64_bf16 v[60:63], v[24:27], a[40:47], v3
  s_waitcnt lgkmcnt(6)
  s_barrier
  v_smfmac_f32_16x16x64_bf16 v[48:51], v[28:31], a[48:55], v3
  buffer_load_dwordx4 v1, s[32:35], s78 offen offset:0 sc1 lds
  v_smfmac_f32_16x16x64_bf16 v[52:55], v[28:31], a[56:63], v3
  v_mov_b32 v0, s51
  v_smfmac_f32_16x16x64_bf16 v[56:59], v[28:31], v[72:79], v3
  ds_read_b128 v[72:75], v9 offset:2048
  v_smfmac_f32_16x16x64_bf16 v[60:63], v[28:31], a[64:71], v3
  ds_read_b128 v[76:79], v9 offset:2304
  v_smfmac_f32_16x16x64_bf16 v[48:51], v[32:35], v[80:87], v3
  ds_read_b128 v[80:83], v9 offset:4096
  v_smfmac_f32_16x16x64_bf16 v[52:55], v[32:35], a[72:79], v3
  ds_read_b128 v[84:87], v9 offset:4352
  s_waitcnt lgkmcnt(8)
  v_smfmac_f32_16x16x64_bf16 v[56:59], v[32:35], v[88:95], v3
  ds_read_b128 v[88:91], v9 offset:6144
  v_smfmac_f32_16x16x64_bf16 v[60:63], v[32:35], a[80:87], v3
  ds_read_b128 v[92:95], v9 offset:6400
  s_waitcnt lgkmcnt(8)
  v_smfmac_f32_16x16x64_bf16 v[48:51], v[36:39], v[96:103], v3
  ds_read_b128 v[96:99], v10
  v_smfmac_f32_16x16x64_bf16 v[52:55], v[36:39], a[88:95], v3
  ds_read_b128 v[100:103], v10 offset:16
  v_smfmac_f32_16x16x64_bf16 v[56:59], v[36:39], a[96:103], v3
  buffer_load_dwordx4 v1, s[32:35], s78 offen offset:1024 sc1 lds
  v_smfmac_f32_16x16x64_bf16 v[60:63], v[36:39], a[104:111], v3
  v_mov_b32 v13, 0
  v_smfmac_f32_16x16x64_bf16 v[48:51], v[40:43], a[112:119], v3
  buffer_load_dwordx4 v1, s[32:35], s78 offen offset:2048 sc1 lds
  v_smfmac_f32_16x16x64_bf16 v[52:55], v[40:43], a[120:127], v3
  v_mov_b32 v116, -1
  v_smfmac_f32_16x16x64_bf16 v[56:59], v[40:43], a[128:135], v3
  buffer_load_dwordx4 v1, s[32:35], s78 offen offset:3072 sc1 lds
  v_smfmac_f32_16x16x64_bf16 v[60:63], v[40:43], a[136:143], v3
  s_mov_b64 exec, s[98:99]
  buffer_store_dword v0, v13, s[32:35], s81 offen sc1
  s_mov_b64 exec, -1
  v_smfmac_f32_16x16x64_bf16 v[48:51], v[44:47], a[144:151], v3
  buffer_store_dword v116, v2, s[32:35], s56 offen offset:0 sc1
  v_smfmac_f32_16x16x64_bf16 v[52:55], v[44:47], a[152:159], v3
  v_lshrrev_b32 v117, 8, v2
  v_smfmac_f32_16x16x64_bf16 v[56:59], v[44:47], a[160:167], v3
  buffer_store_dword v116, v2, s[32:35], s56 offen offset:1024 sc1
  v_smfmac_f32_16x16x64_bf16 v[60:63], v[44:47], a[168:175], v3
  v_mul_u32_u24 v117, 64, v117
  v_smfmac_f32_16x16x64_bf16 v[64:67], v[24:27], a[208:215], v3
  v_smfmac_f32_16x16x64_bf16 v[68:71], v[24:27], a[216:223], v3
  v_sub_u32 v117, v7, v117
  v_add_f32 v48, v48, v50
  v_add_f32 v49, v49, v51
  v_add_f32 v52, v52, v54
  v_add_f32 v53, v53, v55
  v_add_f32 v56, v56, v58
  v_add_f32 v57, v57, v59
  v_add_f32 v60, v60, v62
  v_add_f32 v61, v61, v63
  v_cvt_pk_bf16_f32 v112, v48, v52
  v_cvt_pk_bf16_f32 v113, v56, v60
  v_cvt_pk_bf16_f32 v114, v49, v53
  v_cvt_pk_bf16_f32 v115, v57, v61
  ds_write_b64 v7, v[112:113]
  ds_write_b64 v7, v[114:115] offset:288
  v_smfmac_f32_16x16x64_bf16 v[64:67], v[28:31], a[224:231], v3
  s_mov_b64 exec, s[100:101]
  buffer_store_dwordx2 v[112:113], v117, s[32:35], s79 offen sc1
  buffer_store_dwordx2 v[114:115], v117, s[32:35], s79 offen offset:256 sc1
  s_mov_b64 exec, -1
  v_smfmac_f32_16x16x64_bf16 v[68:71], v[28:31], a[232:239], v3
  v_bfe_u32 v0, v2, 2, 4
  v_smfmac_f32_16x16x64_bf16 v[64:67], v[32:35], a[240:247], v3
  v_and_b32 v13, 64, v2
  v_smfmac_f32_16x16x64_bf16 v[68:71], v[32:35], a[248:255], v3
  v_lshl_add_u32 v0, v13, 6, v0
  s_waitcnt lgkmcnt(0)
  s_barrier
  ds_read_b128 v[16:19], v8 offset:0
  ds_read_b128 v[116:119], v8 offset:2304
  ds_read_b128 v[20:23], v8 offset:64
  ds_read_b128 v[60:63], v8 offset:2368
  ds_read_b128 v[24:27], v8 offset:128
  ds_read_b128 v[32:35], v8 offset:2432
  ds_read_b128 v[28:31], v8 offset:192
  v_smfmac_f32_16x16x64_bf16 v[64:67], v[36:39], v[120:127], v3
  v_smfmac_f32_16x16x64_bf16 v[68:71], v[36:39], v[128:135], v3
  ds_read_b128 v[36:39], v8 offset:2496
  v_smfmac_f32_16x16x64_bf16 v[64:67], v[40:43], v[136:143], v3
  s_add_u32 s59, s59, 1
  s_cmp_ge_u32 s59, s71
  s_cselect_b64 exec, -1, 0
  buffer_load_dword v4, v0, s[32:35], s62 offen sc1
  s_mov_b64 exec, -1
  v_smfmac_f32_16x16x64_bf16 v[68:71], v[40:43], v[144:151], v3
  v_smfmac_f32_16x16x64_bf16 v[64:67], v[44:47], v[152:159], v3
  v_smfmac_f32_16x16x64_bf16 v[68:71], v[44:47], v[160:167], v3
  s_waitcnt lgkmcnt(0)
  v_mfma_f32_16x16x32_bf16 v[52:55], v[104:107], v[16:19], 0
  s_add_u32 s78, s78, 8192
  s_xor_b32 s82, s82, 16384
  v_mfma_f32_16x16x32_bf16 v[56:59], v[108:111], v[16:19], 0
  s_add_u32 s79, s79, 4096
  s_nop 0
  v_mfma_f32_16x16x32_bf16 v[48:51], v[116:119], v[16:19], 0
  v_add_f32 v64, v64, v66
  v_add_f32 v65, v65, v67
  v_mfma_f32_16x16x32_bf16 v[52:55], v[72:75], v[20:23], v[52:55]
  v_add_f32 v68, v68, v70
  v_add_f32 v69, v69, v71
  v_mfma_f32_16x16x32_bf16 v[56:59], v[76:79], v[20:23], v[56:59]
  v_cvt_pk_bf16_f32 v14, v64, v65
  v_cvt_pk_bf16_f32 v15, v68, v69
  v_mfma_f32_16x16x32_bf16 v[48:51], v[60:63], v[20:23], v[48:51]
  v_lshrrev_b32 v13, 1, v2
  buffer_store_dwordx2 v[14:15], v13, s[32:35], s80 offen sc1
  v_mfma_f32_16x16x32_bf16 v[52:55], v[80:83], v[24:27], v[52:55]
  v_mov_b32 v40, v14
  v_mov_b32 v41, 0
  v_mfma_f32_16x16x32_bf16 v[56:59], v[84:87], v[24:27], v[56:59]
  v_mov_b64 v[42:43], 0
  v_mov_b32 v44, v15
  v_mfma_f32_16x16x32_bf16 v[48:51], v[32:35], v[24:27], v[48:51]
  v_mov_b32 v45, 0
  v_mov_b64 v[46:47], 0
  v_mfma_f32_16x16x32_bf16 v[52:55], v[88:91], v[28:31], v[52:55]
  v_xor_b32 v9, 16384, v9
  v_xor_b32 v10, 16384, v10
  v_mfma_f32_16x16x32_bf16 v[56:59], v[92:95], v[28:31], v[56:59]
  v_mfma_f32_16x16x32_bf16 v[48:51], v[36:39], v[28:31], v[48:51]
  s_add_u32 s80, s80, 2048
  v_mov_b32 v16, s83
  v_mov_b32 v17, s83
  s_cmp_ge_u32 s51, 63
  s_cbranch_scc1 TEAM_LAST
  v_mov_b32 v0, v0
  v_mov_b32 v0, v0
  v_mov_b32 v0, v0
  v_max3_f32 v50, v52, v53, v54
  v_max3_f32 v51, v55, v56, v57
  v_max3_f32 v50, v50, v58, v59
  v_max3_f32 v51, v51, v48, v49
  v_max_f32 v50, v50, v51
  v_max_f32 v51, v50, v51
  v_mov_b32 v18, s83
  v_mov_b32 v19, s83
  v_permlane16_swap_b32 v50, v51
  v_max_f32 v60, v50, v51
  v_max_f32 v51, v50, v51
  v_mov_b32 v20, s83
  v_mov_b32 v21, 0
  v_permlane32_swap_b32 v60, v51
  v_max_f32 v50, v60, v51
  v_mul_f32 v50, s70, v50
  v_fma_f32 v52, v52, s70, -v50
  v_fma_f32 v53, v53, s70, -v50
  v_fma_f32 v54, v54, s70, -v50
  v_fma_f32 v55, v55, s70, -v50
  v_fma_f32 v56, v56, s70, -v50
  v_fma_f32 v57, v57, s70, -v50
  v_fma_f32 v58, v58, s70, -v50
  v_fma_f32 v59, v59, s70, -v50
  v_fma_f32 v48, v48, s70, -v50
  v_fma_f32 v49, v49, s70, -v50
  v_exp_f32 v52, v52
  v_exp_f32 v53, v53
  v_exp_f32 v54, v54
  v_exp_f32 v55, v55
  v_exp_f32 v56, v56
  v_exp_f32 v57, v57
  v_exp_f32 v58, v58
  v_exp_f32 v59, v59
  v_exp_f32 v48, v48
  v_exp_f32 v49, v49
  v_cvt_pk_bf16_f32 v116, v52, v53
  v_cvt_pk_bf16_f32 v117, v54, v55
  v_cvt_pk_bf16_f32 v118, v56, v57
  v_cvt_pk_bf16_f32 v119, v58, v59
  v_cvt_pk_bf16_f32 v114, v48, v49
  v_mov_b64 v[22:23], 0
  v_mfma_f32_16x16x32_bf16 v[60:63], v[16:19], v[116:119], 0
  v_mov_b64 v[72:73], 0
  v_mov_b64 v[74:75], 0
  v_mfma_f32_16x16x32_bf16 v[64:67], v[96:99], v[116:119], 0
  v_mov_b64 v[76:77], 0
  v_mov_b64 v[78:79], 0
  v_mfma_f32_16x16x32_bf16 v[60:63], v[20:23], v[114:117], v[60:63]
  v_mov_b64 v[80:81], 0
  v_mov_b64 v[82:83], 0
  v_mfma_f32_16x16x32_bf16 v[68:71], v[100:103], v[116:119], 0
  v_mov_b64 v[84:85], 0
  v_mov_b64 v[86:87], 0
  v_mfma_f32_16x16x32_bf16 v[64:67], v[40:43], v[114:117], v[64:67]
  v_mov_b64 v[88:89], 0
  v_mov_b64 v[90:91], 0
  v_mfma_f32_16x16x32_bf16 v[68:71], v[44:47], v[114:117], v[68:71]
  v_mov_b64 v[92:93], 0
  v_mov_b64 v[94:95], 0
  v_rcp_f32 v0, v60
  v_mov_b64 v[104:105], 0
  v_mov_b64 v[106:107], 0
  v_mov_b64 v[108:109], 0
  v_mov_b64 v[110:111], 0
  s_nop 1
  v_pk_mul_f32 v[64:65], v[64:65], v[0:1] op_sel_hi:[1,0]
  v_pk_mul_f32 v[66:67], v[66:67], v[0:1] op_sel_hi:[1,0]
  v_pk_mul_f32 v[68:69], v[68:69], v[0:1] op_sel_hi:[1,0]
  v_pk_mul_f32 v[70:71], v[70:71], v[0:1] op_sel_hi:[1,0]
  v_cvt_pk_bf16_f32 v16, v64, v68
  v_cvt_pk_bf16_f32 v17, v65, v69
  v_cvt_pk_bf16_f32 v18, v66, v70
  v_cvt_pk_bf16_f32 v19, v67, v71
  s_mov_b64 exec, s[76:77]
  ds_write_b128 v11, v[16:19]
  s_mov_b64 exec, -1
  v_bfe_u32 v0, v2, 5, 3
  v_and_b32 v13, 16, v2
  v_mov_b32 v36, 0x3f80
  v_lshlrev_b32 v13, v13, v36
  v_cmp_eq_u32 vcc, 0, v0
  v_mov_b64 v[64:65], 0
  v_mov_b64 v[66:67], 0
  v_cndmask_b32 v32, 0, v13, vcc
  v_cmp_eq_u32 vcc, 1, v0
  v_mov_b64 v[68:69], 0
  v_mov_b64 v[70:71], 0
  v_cndmask_b32 v33, 0, v13, vcc
  s_waitcnt lgkmcnt(0)
  s_barrier
  ds_read_b128 v[24:27], v2 offset:32768
  ds_read_b128 v[28:31], v2 offset:33792
  ds_read_b128 v[96:99], v12 offset:20480
  ds_read_b128 v[100:103], v12 offset:21504
  ds_read_b128 v[112:115], v12 offset:22528
  ds_read_b128 v[116:119], v12 offset:23552
  s_waitcnt lgkmcnt(5)
  v_smfmac_f32_16x16x64_bf16 v[72:75], v[24:27], v[168:175], v3
  s_waitcnt lgkmcnt(4)
  s_add_u32 s56, s66, 32768
  v_smfmac_f32_16x16x64_bf16 v[72:75], v[28:31], v[176:183], v3
  ds_read_b128 v[48:51], v12 offset:24576
  v_smfmac_f32_16x16x64_bf16 v[76:79], v[24:27], v[184:191], v3
  ds_read_b128 v[52:55], v12 offset:25600
  v_smfmac_f32_16x16x64_bf16 v[76:79], v[28:31], v[192:199], v3
  ds_read_b128 v[56:59], v12 offset:26624
  v_smfmac_f32_16x16x64_bf16 v[80:83], v[24:27], v[200:207], v3
  ds_read_b128 v[60:63], v12 offset:27648
  v_smfmac_f32_16x16x64_bf16 v[80:83], v[28:31], v[208:215], v3
  ds_read_b128 v[16:19], v12 offset:28672
  v_smfmac_f32_16x16x64_bf16 v[84:87], v[24:27], v[216:223], v3
  ds_read_b128 v[20:23], v12 offset:29696
  v_add_f32 v72, v72, v74
  v_smfmac_f32_16x16x64_bf16 v[84:87], v[28:31], v[224:231], v3
  v_add_f32 v73, v73, v75
  v_smfmac_f32_16x16x64_bf16 v[88:91], v[24:27], v[232:239], v3
  v_add_f32 v76, v76, v78
  v_add_f32 v77, v77, v79
  v_smfmac_f32_16x16x64_bf16 v[88:91], v[28:31], v[240:247], v3
  v_cvt_pk_bf16_f32 v40, v72, v76
  v_cvt_pk_bf16_f32 v42, v73, v77
  v_smfmac_f32_16x16x64_bf16 v[92:95], v[24:27], v[248:255], v3
  v_add_f32 v80, v80, v82
  v_add_f32 v81, v81, v83
  s_waitcnt lgkmcnt(0)
  v_smfmac_f32_16x16x64_bf16 v[92:95], v[28:31], v[96:103], v3
  v_add_f32 v84, v84, v86
  v_add_f32 v85, v85, v87
  v_smfmac_f32_16x16x64_bf16 v[104:107], v[24:27], v[112:119], v3
  v_cvt_pk_bf16_f32 v41, v80, v84
  v_cvt_pk_bf16_f32 v43, v81, v85
  v_smfmac_f32_16x16x64_bf16 v[104:107], v[28:31], v[48:55], v3
  buffer_store_dwordx4 v[40:43], v5, s[32:35], s66 offen sc1
  v_smfmac_f32_16x16x64_bf16 v[108:111], v[24:27], v[56:63], v3
  v_add_f32 v88, v88, v90
  v_add_f32 v89, v89, v91
  v_smfmac_f32_16x16x64_bf16 v[108:111], v[28:31], v[16:23], v3
  v_add_f32 v92, v92, v94
  v_add_f32 v93, v93, v95
  v_cvt_pk_bf16_f32 v44, v88, v92
  v_cvt_pk_bf16_f32 v46, v89, v93
  v_add_f32 v104, v104, v106
  v_add_f32 v105, v105, v107
  s_nop 1
  v_add_f32 v108, v108, v110
  v_add_f32 v109, v109, v111
  v_cvt_pk_bf16_f32 v45, v104, v108
  v_cvt_pk_bf16_f32 v47, v105, v109
  buffer_store_dwordx4 v[44:47], v5, s[32:35], s56 offen sc1
  v_cmp_eq_u32 vcc, 2, v0
  v_mov_b64 v[48:49], 0
  v_mov_b64 v[50:51], 0
  v_cndmask_b32 v34, 0, v13, vcc
  v_cmp_eq_u32 vcc, 3, v0
  v_mov_b64 v[52:53], 0
  v_mov_b64 v[54:55], 0
  v_cndmask_b32 v35, 0, v13, vcc
  v_mov_b64 v[56:57], 0
  v_mov_b64 v[58:59], 0
  v_mov_b64 v[60:61], 0
  v_mov_b64 v[62:63], 0
  ds_read_b128 v[72:75], v12 offset:0
  ds_read_b128 v[76:79], v12 offset:1024
  ds_read_b128 v[80:83], v12 offset:2048
  ds_read_b128 v[84:87], v12 offset:3072
  ds_read_b128 v[88:91], v12 offset:4096
  ds_read_b128 v[92:95], v12 offset:5120
  ds_read_b128 v[96:99], v12 offset:6144
  ds_read_b128 v[100:103], v12 offset:7168
  ds_read_b128 v[104:107], v12 offset:8192
  ds_read_b128 v[108:111], v12 offset:9216
  ds_read_b128 v[112:115], v12 offset:10240
  ds_read_b128 v[116:119], v12 offset:11264
  buffer_load_dwordx4 v[16:19], v2, s[32:35], s68 offen sc1
  buffer_load_dwordx4 v[20:23], v2, s[32:35], s68 offen offset:1024 sc1
  s_mov_b32 s52, 0
  v_mov_b32 v0, v0
  v_mov_b32 v0, v0
  v_mov_b32 v0, v0
  v_mov_b32 v0, v0
  v_mov_b32 v0, v0
  v_mov_b32 v0, v0
  v_mov_b32 v0, v0
  v_mov_b32 v0, v0
  v_mov_b32 v0, v0
  v_mov_b32 v0, v0
  v_mov_b32 v0, v0
  v_mov_b32 v0, v0
  v_mov_b32 v0, v0
  v_mov_b32 v0, v0
  v_mov_b32 v0, v0
  v_mov_b32 v0, v0
  v_mov_b32 v0, v0
  v_mov_b32 v0, v0
  v_mov_b32 v0, v0
  v_mov_b32 v0, v0
  v_mov_b32 v0, v0
  v_mov_b32 v0, v0
  v_mov_b32 v0, v0
  v_mov_b32 v0, v0
TEAM_RPOLL_S:
  buffer_load_dwordx4 v[24:27], v2, s[32:35], s68 offen sc1
  buffer_load_dwordx4 v[28:31], v2, s[32:35], s68 offen offset:1024 sc1
  s_waitcnt vmcnt(2)
  v_mfma_f32_16x16x32_bf16 v[36:39], v[32:35], v[16:19], 0
  v_mfma_f32_16x16x32_bf16 v[36:39], v[32:35], v[20:23], v[36:39]
  v_max_u32 v0, v16, v20
  v_cmp_eq_u32 vcc, s69, v0
  s_cbranch_vccz TEAM_ROK_S
  buffer_load_dwordx4 v[16:19], v2, s[32:35], s68 offen sc1
  buffer_load_dwordx4 v[20:23], v2, s[32:35], s68 offen offset:1024 sc1
  s_waitcnt vmcnt(2)
  v_mfma_f32_16x16x32_bf16 v[36:39], v[32:35], v[24:27], 0
  v_mfma_f32_16x16x32_bf16 v[36:39], v[32:35], v[28:31], v[36:39]
  v_max_u32 v0, v24, v28
  v_cmp_eq_u32 vcc, s69, v0
  s_cbranch_vccz TEAM_ROK_S
  s_add_u32 s52, s52, 1
  s_cmp_gt_u32 s52, 32768
  s_cbranch_scc0 TEAM_RPOLL_S
  s_branch TEAM_DONE
TEAM_ROK_S:
  v_mov_b32 v0, v0
  v_mov_b32 v0, v0
  v_mov_b32 v0, v0
  v_mov_b32 v0, v0
  v_mov_b32 v0, v0
  v_add_f32_dpp v36, v36, v36 row_ror:4 row_mask:0xf bank_mask:0xf
  v_add_f32_dpp v37, v37, v37 row_ror:4 row_mask:0xf bank_mask:0xf
  v_add_f32_dpp v38, v38, v38 row_ror:4 row_mask:0xf bank_mask:0xf
  v_add_f32_dpp v39, v39, v39 row_ror:4 row_mask:0xf bank_mask:0xf
  v_add_f32_dpp v36, v36, v36 row_ror:8 row_mask:0xf bank_mask:0xf
  v_add_f32_dpp v37, v37, v37 row_ror:8 row_mask:0xf bank_mask:0xf
  v_add_f32_dpp v38, v38, v38 row_ror:8 row_mask:0xf bank_mask:0xf
  v_add_f32_dpp v39, v39, v39 row_ror:8 row_mask:0xf bank_mask:0xf
  v_cvt_pk_bf16_f32 v14, v36, v37
  v_cvt_pk_bf16_f32 v15, v38, v39
  s_mov_b64 exec, s[74:75]
  buffer_store_dwordx2 v[14:15], v6, s[32:35], s67 offen sc1
  v_mov_b64 v[36:37], -1
  s_xor_b32 s53, s67, 8192
  buffer_store_dwordx2 v[36:37], v6, s[32:35], s53 offen sc1
  s_mov_b64 exec, -1
  s_xor_b32 s66, s66, 262144
  s_xor_b32 s68, s68, 262144
  s_xor_b32 s67, s67, 8192
  s_add_u32 s51, s51, 1
  s_mov_b32 s52, 0
TEAM_GATHER_S:
  s_lshl_b32 s55, s48, 11
  s_xor_b32 s54, s67, 8192
  s_add_u32 s54, s54, s55
  s_add_u32 s53, s55, 32768
  v_mov_b32 v32, v32
  v_mov_b32 v32, v32
  v_mov_b32 v32, v32
  v_mov_b32 v32, v32
  v_mov_b32 v32, v32
  v_mov_b32 v32, v32
  v_mov_b32 v32, v32
  v_mov_b32 v32, v32
  v_mov_b32 v32, v32
  v_mov_b32 v32, v32
  v_mov_b32 v32, v32
  v_mov_b32 v32, v32
  v_mov_b32 v32, v32
  v_mov_b32 v32, v32
  v_mov_b32 v32, v32
  v_mov_b32 v32, v32
  v_mov_b32 v32, v32
  v_mov_b32 v32, v32
  v_mov_b32 v32, v32
  v_mov_b32 v32, v32
  v_mov_b32 v32, v32
  v_mov_b32 v32, v32
  v_mov_b32 v32, v32
  v_mov_b32 v32, v32
  v_mov_b32 v32, v32
  v_mov_b32 v32, v32
  v_mov_b32 v32, v32
  v_mov_b32 v32, v32
  v_mov_b32 v32, v32
  v_mov_b32 v32, v32
  v_mov_b32 v32, v32
  v_mov_b32 v32, v32
  buffer_load_dwordx4 v[16:19], v2, s[32:35], s54 offen sc1
  buffer_load_dwordx4 v[20:23], v2, s[32:35], s54 offen offset:1024 sc1
  v_add_u32 v0, s53, v2
  v_xor_b32 v13, 2048, v0
  v_xor_b32 v14, 4096, v0
  v_xor_b32 v15, 6144, v0
  s_waitcnt lgkmcnt(0)
  v_mov_b32 v32, v32
  v_mov_b32 v32, v32
  v_mov_b32 v32, v32
  v_mov_b32 v32, v32
  v_mov_b32 v32, v32
  v_mov_b32 v32, v32
  v_mov_b32 v32, v32
  v_mov_b32 v32, v32
  v_mov_b32 v32, v32
  v_mov_b32 v32, v32
  v_mov_b32 v32, v32
  v_mov_b32 v32, v32
  v_mov_b32 v32, v32
  v_mov_b32 v32, v32
  v_mov_b32 v32, v32
  v_mov_b32 v32, v32
  v_mov_b32 v32, v32
  v_mov_b32 v32, v32
  v_mov_b32 v32, v32
  v_mov_b32 v32, v32
  v_mov_b32 v32, v32
  v_mov_b32 v32, v32
  v_mov_b32 v32, v32
  v_mov_b32 v32, v32
TEAM_GPOLL_S:
  buffer_load_dwordx4 v[40:43], v2, s[32:35], s54 offen sc1
  buffer_load_dwordx4 v[44:47], v2, s[32:35], s54 offen offset:1024 sc1
  s_waitcnt vmcnt(2)
  v_max3_u32 v32, v16, v18, v20
  v_max_u32 v32, v32, v22
  v_cmp_eq_u32 vcc, s69, v32
  s_cbranch_vccz TEAM_STEP_S
  buffer_load_dwordx4 v[16:19], v2, s[32:35], s54 offen sc1
  buffer_load_dwordx4 v[20:23], v2, s[32:35], s54 offen offset:1024 sc1
  s_waitcnt vmcnt(2)
  v_max3_u32 v32, v40, v42, v44
  v_max_u32 v32, v32, v46
  v_cmp_eq_u32 vcc, s69, v32
  s_cbranch_vccz TEAM_GOK1_S
  s_add_u32 s52, s52, 1
  s_cmp_gt_u32 s52, 32768
  s_cbranch_scc0 TEAM_GPOLL_S
  s_branch TEAM_DONE
TEAM_GOK1_S:
  v_mov_b64 v[16:17], v[40:41]
  v_mov_b64 v[18:19], v[42:43]
  v_mov_b64 v[20:21], v[44:45]
  v_mov_b64 v[22:23], v[46:47]
  s_nop 0
  s_branch TEAM_STEP_S
TEAM_KVSLOW_S:
  v_bfe_u32 v33, v2, 2, 4
  v_and_b32 v32, 64, v2
  v_lshl_add_u32 v33, v32, 6, v33
  s_mov_b32 s52, 0
  s_branch Lkve_91_S
Lkvr_90_S:
  buffer_load_dword v4, v33, s[32:35], s62 offen sc1
  s_add_u32 s52, s52, 1
  s_cmp_gt_u32 s52, 65536
  s_cbranch_scc1 Lkvd_92_S
  s_waitcnt vmcnt(0)
Lkve_91_S:
  v_lshlrev_b32 v32, 2, v4
  s_nop 0
  v_readlane_b32 s71, v32, 0
  v_readlane_b32 s54, v32, 1
  s_add_u32 s54, s54, 1
  s_min_u32 s71, s71, s54
  v_readlane_b32 s54, v32, 2
  s_add_u32 s54, s54, 2
  s_min_u32 s71, s71, s54
  v_readlane_b32 s54, v32, 3
  s_add_u32 s54, s54, 3
  s_min_u32 s71, s71, s54
  v_readlane_b32 s54, v32, 4
  s_add_u32 s54, s54, 0
  s_min_u32 s71, s71, s54
  v_readlane_b32 s54, v32, 5
  s_add_u32 s54, s54, 1
  s_min_u32 s71, s71, s54
  v_readlane_b32 s54, v32, 6
  s_add_u32 s54, s54, 2
  s_min_u32 s71, s71, s54
  v_readlane_b32 s54, v32, 7
  s_add_u32 s54, s54, 3
  s_min_u32 s71, s71, s54
  s_cmp_lt_u32 s59, s71
  s_cbranch_scc0 Lkvr_90_S
Lkvd_92_S:
  s_branch TEAM_KVGO_S
TEAM_LAST:
  s_waitcnt vmcnt(0) lgkmcnt(0)
  s_barrier
  s_cmp_lg_u32 s48, 0
  s_cbranch_scc1 TEAM_DONE
  v_mov_b32 v0, 64
  v_mov_b32 v13, 0
  s_mov_b64 exec, 1
  buffer_store_dword v0, v13, s[32:35], s81 offen sc1
  s_mov_b64 exec, -1
TEAM_DONE:
  s_waitcnt vmcnt(0)
  s_endpgm
.section .rodata,"a"
.p2align 6
.amdhsa_kernel parallel_sum__memory_aug_recurrent_mem_tr__glu_gated_geglu__prompt_kernel
  .amdhsa_next_free_vgpr 512
  .amdhsa_next_free_sgpr 102
  .amdhsa_accum_offset 256
  .amdhsa_group_segment_fixed_size 0
  .amdhsa_kernarg_size 112
  .amdhsa_user_sgpr_count 2
  .amdhsa_user_sgpr_kernarg_segment_ptr 1
  .amdhsa_system_sgpr_workgroup_id_x 1
.end_amdhsa_kernel
```
